```python
import torch

def _softmax(x, axis=-1):
    return torch.softmax(x, dim=axis)
def _gelu(x):
    return torch.nn.functional.gelu(x, approximate="tanh")
def _silu(x):
    return torch.nn.functional.silu(x)
def _sigmoid(x):
    return torch.sigmoid(x)
def _layernorm(x, axis=-1, eps=1e-5):
    m = x.mean(dim=axis, keepdim=True)
    v = x.var(dim=axis, keepdim=True, unbiased=False)
    return (x - m) / torch.sqrt(v + eps)
def _scatter_add(tgt, idx, src, axis=0):
    return tgt.clone().index_add_(axis, idx, src)
def _segment_sum(src, seg, n):
    out = torch.zeros((n,) + src.shape[1:], dtype=src.dtype)
    return out.index_add_(0, seg, src)
def _pad(x, pw):
    flat = tuple(v for pair in reversed(pw) for v in pair)
    return torch.nn.functional.pad(x, flat)

kernel_name = 'interleave_layers__ssm_conv_s4__geglu_ffn__prompt'

def setup_inputs():

    _w = (lambda a: (lambda t: t.to(torch.bfloat16) if t.is_floating_point() else t)(torch.as_tensor(a)))
    def _A_setup():
        B, L, D, N = 1, 2048, 512, 128
        A_re = -(lambda _x: torch.exp(torch.as_tensor(_x)))((lambda *s: torch.randn(*s, dtype=torch.bfloat16) * 1.6)(D, N))
        A_im = torch.pi * (lambda *s: torch.randn(*s, dtype=torch.bfloat16) * 0.2)(D, N)
        B_re = (lambda *s: torch.randn(*s, dtype=torch.bfloat16) * 0.2)(D, N)
        B_im = (lambda *s: torch.randn(*s, dtype=torch.bfloat16) * 0.2)(D, N)
        C_re = (lambda *s: torch.randn(*s, dtype=torch.bfloat16) * 0.2)(D, N)
        C_im = (lambda *s: torch.randn(*s, dtype=torch.bfloat16) * 0.2)(D, N)
        log_dt = (lambda *s: torch.randn(*s, dtype=torch.bfloat16) * 0.2)(D) * 0.5 - 4.0
        Dskip = (lambda *s: torch.randn(*s, dtype=torch.bfloat16) * 0.2)(D)
        return {
            "u": _w((lambda *s: torch.randn(*s, dtype=torch.bfloat16) * 0.05)(B, L, D)),
            "A_re": _w(A_re),
            "A_im": _w(A_im),
            "B_re": _w(B_re),
            "B_im": _w(B_im),
            "C_re": _w(C_re),
            "C_im": _w(C_im),
            "log_dt": _w(log_dt),
            "Dskip": _w(Dskip),
        }
    _A_in = _A_setup()

    def _B_setup():
        B, S, D, F = 1, 2048, 512, 1376
        return {
            "x": _w((lambda *s: torch.randn(*s, dtype=torch.bfloat16) * 0.05)(B, S, D)),
            "w_gate": _w((lambda *s: torch.randn(*s, dtype=torch.bfloat16) * 0.05)(D, F)),
            "w_up": _w((lambda *s: torch.randn(*s, dtype=torch.bfloat16) * 0.05)(D, F)),
            "w_down": _w((lambda *s: torch.randn(*s, dtype=torch.bfloat16) * 0.05)(F, D)),
        }
    _B_in = _B_setup()

    return {
        "A_u": _A_in["u"],
        "A_A_re": _A_in["A_re"],
        "A_A_im": _A_in["A_im"],
        "A_B_re": _A_in["B_re"],
        "A_B_im": _A_in["B_im"],
        "A_C_re": _A_in["C_re"],
        "A_C_im": _A_in["C_im"],
        "A_log_dt": _A_in["log_dt"],
        "A_Dskip": _A_in["Dskip"],
        "B_x": _B_in["x"],
        "B_w_gate": _B_in["w_gate"],
        "B_w_up": _B_in["w_up"],
        "B_w_down": _B_in["w_down"],
    }

def reference(A_u, A_A_re, A_A_im, A_B_re, A_B_im, A_C_re, A_C_im, A_log_dt, A_Dskip, B_x, B_w_gate, B_w_up, B_w_down):
    def _A_ref(u, A_re, A_im, B_re, B_im, C_re, C_im, log_dt, Dskip):
        Bsz, L, D = u.shape
        dt = torch.exp(log_dt)[:, None]
        A = A_re + 1j * A_im
        Bc = B_re + 1j * B_im
        Cc = C_re + 1j * C_im
        logdA = dt * A
        dB = dt * Bc
        l = (lambda x, dt: x.to(dt))(torch.arange(L), A_re.dtype)
        P = torch.exp(logdA[:, :, None] * l[None, None, :])
        K = torch.einsum("dn,dnl,dn->dl", Cc, P, dB).real
        L2 = 2 * L
        Kp = _pad(K, ((0, 0), (0, L)))
        up = (lambda x, *d: x.permute(*d))(u, 0, 2, 1)
        up = _pad(up, ((0, 0), (0, 0), (0, L)))
        Kf = (lambda x, axes=(-2,-1): torch.fft.rfft2(x.float(), dim=axes))(Kp[:, None, :], axes=(-2, -1))
        Uf = (lambda x, axes=(-2,-1): torch.fft.rfft2(x.float(), dim=axes))(up[:, :, None, :], axes=(-2, -1))
        Yf = Uf * Kf[None, :, :, :]
        y = (lambda x, s, axes=(-2,-1): torch.fft.irfft2(x, s=s, dim=axes).to(torch.bfloat16))(Yf, (1, L2), axes=(-2, -1))[:, :, 0, :L]
        y = (lambda x, *d: x.permute(*d))(y, 0, 2, 1) + u * Dskip[None, None, :]
        return y

    def _B_ref(x, w_gate, w_up, w_down):
        return (_gelu(x @ w_gate) * (x @ w_up)) @ w_down

    x = A_u
    x = x + _A_ref(_layernorm(x, axis=-1), A_A_re, A_A_im, A_B_re, A_B_im, A_C_re, A_C_im, A_log_dt, A_Dskip)
    x = x + _B_ref(_layernorm(x, axis=-1), B_w_gate, B_w_up, B_w_down)
    x = x + _A_ref(_layernorm(x, axis=-1), A_A_re, A_A_im, A_B_re, A_B_im, A_C_re, A_C_im, A_log_dt, A_Dskip)
    x = x + _B_ref(_layernorm(x, axis=-1), B_w_gate, B_w_up, B_w_down)
    return x
```

```asm
; @launch grid=(256,1,1) block=(256,1,1) lds=147456
.amdgcn_target "amdgcn-amd-amdhsa--gfx950"
.text
.p2align 12
.globl interleave_layers__ssm_conv_s4__geglu_ffn__prompt_kernel
.p2align 8
.type interleave_layers__ssm_conv_s4__geglu_ffn__prompt_kernel,@function
interleave_layers__ssm_conv_s4__geglu_ffn__prompt_kernel:
  s_cmp_ge_u32 s2, 256
  s_cbranch_scc1 B_end
  s_load_dwordx16 s[12:27], s[0:1], 0
  s_load_dwordx16 s[68:83], s[0:1], 64
  s_getpc_b64 s[84:85]
B_pc:
  s_lshr_b32 s4, s2, 3
  v_lshlrev_b32 v32, 6, v0
  s_and_b32 s5, s4, 3
  s_lshl_b32 s5, s5, 14
  v_add_u32 v32, s5, v32
  v_min_u32 v32, B_end-B_pc, v32
  v_mov_b32 v33, s85
  v_add_co_u32 v32, vcc, s84, v32
  v_lshrrev_b32 v34, 6, v0
  v_and_b32 v35, 63, v0
  v_addc_co_u32 v33, vcc, 0, v33, vcc
  v_readfirstlane_b32 s6, v34
  global_load_dword v63, v[32:33], off
  s_and_b32 s3, s2, 7
  s_lshl_b32 s5, s3, 5
  s_add_u32 s5, s5, s4
  s_lshl_b32 s58, s2, 12
  v_lshlrev_b32 v9, 4, v35
  v_lshlrev_b32 v16, 4, v0
  v_mov_b32 v200, -1
  v_mov_b32 v201, -1
  v_mov_b32 v202, -1
  v_mov_b32 v203, -1
  v_lshl_add_u32 v36, v34, 11, v9
  s_lshl_b32 s3, s2, 13
  s_waitcnt lgkmcnt(0)
  s_mov_b32 s8, s82
  s_mov_b32 s9, s83
  s_mov_b32 s10, 0x03000000
  s_mov_b32 s11, 0x00020000
  s_mov_b32 s28, s12
  s_mov_b32 s29, s13
  s_mov_b32 s30, 0x00200000
  s_mov_b32 s31, 0x00020000
  s_mov_b32 s4, 0x01420000
  s_mov_b32 s35, 0x00020000
  buffer_load_dwordx4 v[40:43], v36, s[28:31], s3 offen
  buffer_load_dwordx4 v[44:47], v36, s[28:31], s3 offen offset:1024
  buffer_load_dwordx2 v[60:61], off, s[8:11], s4
  s_lshl_b32 s3, s5, 9
  v_lshlrev_b32 v55, 1, v0
  s_mov_b32 s34, 131072
  v_lshrrev_b32 v56, 7, v0
  v_and_b32 v57, 1, v0
  v_mov_b32 v12, 0
  s_mov_b32 s32, s14
  s_mov_b32 s33, s15
  buffer_load_ushort v48, v55, s[32:35], s3 offen
  s_mov_b32 s32, s16
  s_mov_b32 s33, s17
  buffer_load_ushort v49, v55, s[32:35], s3 offen
  s_mov_b32 s32, s18
  s_mov_b32 s33, s19
  buffer_load_ushort v50, v55, s[32:35], s3 offen
  s_mov_b32 s32, s20
  s_mov_b32 s33, s21
  buffer_load_ushort v51, v55, s[32:35], s3 offen
  s_mov_b32 s32, s22
  s_mov_b32 s33, s23
  buffer_load_ushort v52, v55, s[32:35], s3 offen
  s_mov_b32 s32, s24
  s_mov_b32 s33, s25
  buffer_load_ushort v53, v55, s[32:35], s3 offen
  s_lshl_b32 s3, s5, 2
  v_lshlrev_b32 v58, 1, v56
  v_lshlrev_b32 v59, 1, v57
  s_mov_b32 s34, 1024
  s_mov_b32 s32, s26
  s_mov_b32 s33, s27
  buffer_load_ushort v54, v58, s[32:35], s3 offen
  s_mov_b32 s32, s68
  s_mov_b32 s33, s69
  buffer_load_short_d16_hi v12, v59, s[32:35], s3 offen
  s_mov_b32 s16, s78
  s_mov_b32 s17, s79
  s_mov_b32 s18, 0x00200000
  s_mov_b32 s19, 0x00020000
  s_mov_b32 s20, s82
  s_mov_b32 s21, s83
  s_mov_b32 s22, 0x00000000
  s_mov_b32 s23, 0x00020000
  s_mov_b32 s24, s82
  s_mov_b32 s25, s83
  s_mov_b32 s26, 0x00000000
  s_mov_b32 s27, 0x00020000
  s_mov_b64 s[12:13], s[72:73]
  s_mov_b64 s[14:15], s[74:75]
  s_mov_b64 s[70:71], s[76:77]
  s_lshr_b32 s52, s5, 3
  s_and_b32 s53, s5, 7
  s_lshl_b32 s36, s5, 7
  s_lshl_b32 s60, s6, 13
  s_mov_b32 s22, 0x03000000
  s_cmp_lt_u32 s5, 132
  s_cbranch_scc0 B_m2
  s_mul_i32 s41, s5, 171
  s_lshr_b32 s41, s41, 10
  s_mul_i32 s3, s41, 6
  s_sub_u32 s40, s5, s3
  s_branch B_m3
B_m2:
  s_sub_u32 s4, s5, 132
  s_cmp_ge_u32 s4, 110
  s_cselect_b32 s22, 0, s22
  s_cselect_b32 s3, 14, 0
  s_sub_u32 s4, s4, s3
  s_mul_i32 s41, s4, 205
  s_lshr_b32 s41, s41, 10
  s_mul_i32 s3, s41, 5
  s_sub_u32 s40, s4, s3
  s_add_u32 s40, s40, 6
  s_sub_u32 s4, s5, 242
  s_min_u32 s4, s4, 10
  s_cmp_eq_u32 s22, 0
  s_cselect_b32 s40, s4, s40
B_m3:
  s_lshl_b32 s38, s41, 2
  s_add_u32 s38, s38, s6
  s_cmp_eq_u32 s40, 10
  s_cselect_b32 s26, 0, s22
  s_cselect_b32 s42, 21, 22
  s_add_u32 s42, s42, s40
  s_add_u32 s41, s40, 11
  s_cmp_eq_u32 s22, 0
  s_cselect_b32 s3, s40, s42
  s_cselect_b32 s40, s41, s40
  s_cselect_b32 s41, s42, s41
  s_mov_b32 s42, s3
  s_lshl_b32 s3, s38, 10
  s_mul_i32 s43, s40, 90112
  s_add_u32 s43, s43, s3
  s_lshl_b32 s40, s40, 15
  s_add_u32 s40, s40, s60
  s_mul_i32 s44, s41, 90112
  s_add_u32 s44, s44, s3
  s_lshl_b32 s41, s41, 15
  s_add_u32 s41, s41, s60
  s_mul_i32 s45, s42, 90112
  s_add_u32 s45, s45, s3
  s_lshl_b32 s42, s42, 15
  s_add_u32 s42, s42, s60
  s_mul_i32 s61, s38, 33792
  s_add_u32 s61, s61, 0x01e00000
  s_mul_i32 s46, s52, 90112
  s_mul_i32 s3, s6, 22528
  s_add_u32 s46, s46, s3
  s_lshl_b32 s3, s3, 1
  s_mul_i32 s55, s53, 184320
  s_add_u32 s55, s55, s3
  s_lshl_b32 s3, s52, 15
  s_lshl_b32 s4, s53, 12
  s_add_u32 s47, s3, s4
  s_lshl_b32 s4, s53, 7
  s_add_u32 s51, s3, s4
  s_lshl_b32 s3, s52, 8
  s_lshl_b32 s4, s53, 14
  s_add_u32 s50, s3, s4
  s_cmp_eq_u32 s6, 0
  s_cselect_b32 s50, s50, 0x20000000
  s_mov_b32 s39, 0x8000
  s_mov_b64 s[56:57], -1
  s_mov_b32 s62, 0xaaaaaaaa
  s_mov_b32 s63, 0xaaaaaaaa
  s_mov_b32 s64, 0xcccccccc
  s_mov_b32 s65, 0xcccccccc
  s_lshl_b32 s4, s6, 4
  s_mov_b64 s[82:83], 0x1111
  s_lshl_b64 s[82:83], s[82:83], s4
  s_add_u32 s3, s6, 0
  s_and_b32 s3, s3, 3
  s_lshl_b32 s66, s3, 13
  s_add_u32 s3, s6, 1
  s_and_b32 s3, s3, 3
  s_lshl_b32 s67, s3, 13
  s_add_u32 s3, s6, 2
  s_and_b32 s3, s3, 3
  s_lshl_b32 s68, s3, 13
  s_add_u32 s3, s6, 3
  s_and_b32 s3, s3, 3
  s_lshl_b32 s69, s3, 13
  s_add_u32 s97, s58, 0x00000000
  buffer_store_dwordx4 v[200:203], v16, s[8:11], s97 offen sc1
  v_lshrrev_b32 v64, 3, v0
  v_and_b32 v65, 7, v0
  v_bfe_u32 v66, v0, 1, 2
  v_lshlrev_b32 v3, 15, v64
  v_lshl_add_u32 v3, v57, 6, v3
  v_lshl_add_u32 v3, v66, 4, v3
  v_lshlrev_b32 v4, 8, v64
  v_lshl_add_u32 v4, v65, 4, v4
  s_lshl_b32 s3, s6, 3
  s_add_u32 s3, s3, s53
  s_lshl_b32 s4, s52, 8
  s_cmp_eq_u32 s3, s52
  s_cselect_b32 s4, s4, 0x20000000
  v_and_b32 v67, 63, v0
  v_lshl_add_u32 v5, v67, 2, s4
  v_and_b32 v67, 15, v0
  v_bfe_u32 v68, v0, 4, 2
  v_and_b32 v70, 1, v34
  v_sub_u32 v71, 3, v67
  v_and_b32 v71, 3, v71
  v_lshl_add_u32 v72, v56, 2, v71
  s_movk_i32 s3, 4160
  v_mul_lo_u32 v72, v72, s3
  v_add_u32 v71, v71, v67
  v_lshlrev_b32 v71, 1, v71
  v_sub_u32 v72, v72, v71
  v_lshl_add_u32 v72, v68, 4, v72
  v_lshlrev_b32 v71, 8, v70
  v_sub_u32 v72, v72, v71
  v_add_u32 v1, 98590, v72
  s_movk_i32 s3, 4608
  v_mul_lo_u32 v72, v56, s3
  v_lshl_add_u32 v72, v67, 5, v72
  v_lshl_add_u32 v72, v68, 4, v72
  v_sub_u32 v72, v72, v71
  v_add_u32 v2, 132384, v72
  v_mul_lo_u32 v72, v57, s3
  v_lshl_add_u32 v72, v64, 6, v72
  v_lshl_add_u32 v72, v66, 4, v72
  v_add_u32 v6, 132608, v72
  s_movk_i32 s3, 5120
  v_mul_lo_u32 v72, v34, s3
  v_lshl_add_u32 v72, v68, 4, v72
  s_movk_i32 s4, 80
  v_mad_u32_u24 v72, v67, s4, v72
  v_add_u32 v7, 65536, v72
  v_lshlrev_b32 v72, 1, v57
  v_mul_lo_u32 v72, v72, s3
  v_lshrrev_b32 v73, 2, v0
  v_mad_u32_u24 v72, v73, s4, v72
  v_and_b32 v73, 1, v66
  v_lshl_add_u32 v72, v73, 5, v72
  v_add_u32 v8, 65536, v72
  v_bfe_u32 v76, v0, 2, 2
  v_bfe_u32 v77, v0, 5, 1
  v_lshl_add_u32 v72, v77, 3, v76
  v_lshlrev_b32 v72, 6, v72
  v_and_b32 v78, 1, v68
  v_lshl_add_u32 v72, v78, 5, v72
  v_and_b32 v79, 3, v0
  v_lshl_add_u32 v80, v79, 3, v72
  v_add_u32 v18, 143360, v80
  v_add_u32 v17, 143360, v16
  v_and_b32 v81, 31, v0
  v_lshlrev_b32 v72, 5, v81
  v_add_u32 v11, 141312, v72
  v_lshl_add_u32 v72, v77, 4, v11
  v_lshl_add_u32 v10, v34, 2, v72
  s_movk_i32 s3, 8704
  v_mad_u32_u24 v13, v34, s3, v9
  v_lshl_add_u32 v72, v56, 2, v79
  s_movk_i32 s3, 1088
  v_lshrrev_b32 v73, 2, v35
  v_lshl_add_u32 v73, v70, 4, v73
  v_lshlrev_b32 v73, 4, v73
  v_mad_u32_u24 v14, v72, s3, v73
  v_lshlrev_b32 v72, 10, v81
  v_lshl_add_u32 v72, v34, 5, v72
  v_lshl_add_u32 v15, v77, 4, v72
  v_lshlrev_b32 v19, 2, v35
  v_mov_b32 v22, 0x3f803f80
  v_mov_b32 v23, 0x3f803f80
  v_add_u32 v24, s66, v80
  v_add_u32 v28, 0x10000, v24
  v_add_u32 v25, s67, v80
  v_add_u32 v29, 0x10000, v25
  v_add_u32 v26, s68, v80
  v_add_u32 v30, 0x10000, v26
  v_add_u32 v27, s69, v80
  v_add_u32 v31, 0x10000, v27
  s_lshr_b32 s4, s2, 3
  s_and_b32 s3, s2, 7
  s_mul_i32 s99, s3, 22
  s_mul_i32 s3, s3, 9
  s_add_u32 s3, s3, 154
  s_cmp_lt_u32 s4, 22
  s_cselect_b32 s99, s99, s3
  s_add_u32 s99, s99, s4
  s_cmp_lt_u32 s4, 31
  s_cselect_b32 s99, s99, 255
  v_mov_b32 v116, 0
  v_mov_b32 v117, 0
  v_mov_b32 v120, 0
  v_mov_b32 v121, 0
  v_and_b32 v72, 127, v0
  s_movk_i32 s3, 4608
  v_mul_lo_u32 v73, v56, s3
  v_lshl_add_u32 v73, v72, 2, v73
  v_add_u32 v73, 132096, v73
  ds_write_b32 v73, v116
  v_lshrrev_b32 v73, 4, v72
  s_movk_i32 s3, 4160
  v_lshlrev_b32 v74, 2, v67
  v_mad_u32_u24 v73, v73, s3, v74
  v_add_u32 v73, 102400, v73
  ds_write_b32 v73, v116
  s_lshr_b32 s3, s2, 7
  s_lshl_b32 s3, s3, 13
  s_and_b32 s4, s2, 127
  s_lshl_b32 s4, s4, 5
  s_add_u32 s3, s3, s4
  s_add_u32 s80, s3, 0x01400000
  v_lshlrev_b32 v73, 12, v70
  v_lshl_add_u32 v73, v56, 4, v73
  s_movk_i32 s3, 8320
  v_mad_u32_u24 v62, v34, s3, v9
  v_add_u32 v62, 98304, v62
  v_lshrrev_b32 v74, 1, v79
  v_lshl_add_u32 v74, v68, 1, v74
  v_lshl_add_u32 v74, v34, 3, v74
  v_lshlrev_b32 v74, 3, v74
  s_movk_i32 s3, 4160
  v_mad_u32_u24 v75, v76, s3, v74
  v_bfe_i32 v74, v0, 2, 1
  s_lshl_b32 s74, s2, 14
  s_add_u32 s74, s74, 0x01600000
  s_add_u32 s75, s74, 4096
  s_add_u32 s76, s74, 8192
  s_add_u32 s77, s74, 12288
  v_lshrrev_b32 v82, 2, v0
  v_lshlrev_b32 v82, 15, v82
  v_lshl_add_u32 v82, v57, 4, v82
  v_and_b32 v83, 2, v0
  v_lshl_add_u32 v82, v83, 5, v82
  v_xor_b32 v83, 0x4040, v82
  s_cmp_eq_u32 s6, 0
  s_cbranch_scc1 Ia0
  s_cmp_eq_u32 s6, 1
  s_cbranch_scc1 Ia1
  s_cmp_eq_u32 s6, 2
  s_cbranch_scc1 Ia2
  s_branch Ia3
Iar:
  s_waitcnt vmcnt(9)
  v_add_u32 v63, 98304, v75
  v_add_u32 v118, 1, v60
  v_not_b32 v119, v61
  s_nop 0
  v_readfirstlane_b32 s72, v118
  v_readfirstlane_b32 s73, v119
  ds_write_b128 v62, v[40:43]
  ds_write_b128 v62, v[44:47] offset:4160
  v_dot2_f32_bf16 v116, v40, v22, v116
  v_dot2_f32_bf16 v120, v44, v22, v120
  v_dot2_f32_bf16 v117, v40, v40, v117
  v_dot2_f32_bf16 v121, v44, v44, v121
  v_dot2_f32_bf16 v116, v41, v22, v116
  v_dot2_f32_bf16 v120, v45, v22, v120
  v_dot2_f32_bf16 v117, v41, v41, v117
  v_dot2_f32_bf16 v121, v45, v45, v121
  v_dot2_f32_bf16 v116, v42, v22, v116
  v_dot2_f32_bf16 v120, v46, v22, v120
  v_dot2_f32_bf16 v117, v42, v42, v117
  v_dot2_f32_bf16 v121, v46, v46, v121
  v_dot2_f32_bf16 v116, v43, v22, v116
  v_dot2_f32_bf16 v120, v47, v22, v120
  v_dot2_f32_bf16 v117, v43, v43, v117
  v_dot2_f32_bf16 v121, v47, v47, v121
  s_not_b32 s79, s72
  s_mov_b32 s78, s72
  s_waitcnt lgkmcnt(0)
  v_and_b32 v40, s78, v74
  v_and_b32 v41, s79, v74
  v_mul_f32 v116, 0x3b000000, v116
  v_mul_f32 v120, 0x3b000000, v120
  v_mul_f32 v117, 0x3b000000, v117
  v_mul_f32 v121, 0x3b000000, v121
  v_add_f32_dpp v116, v116, v116 row_shr:1 row_mask:0xf bank_mask:0xf
  v_add_f32_dpp v120, v120, v120 row_shr:1 row_mask:0xf bank_mask:0xf
  v_add_f32_dpp v117, v117, v117 row_shr:1 row_mask:0xf bank_mask:0xf
  v_add_f32_dpp v121, v121, v121 row_shr:1 row_mask:0xf bank_mask:0xf
  v_add_f32_dpp v116, v116, v116 row_shr:2 row_mask:0xf bank_mask:0xf
  v_add_f32_dpp v120, v120, v120 row_shr:2 row_mask:0xf bank_mask:0xf
  v_add_f32_dpp v117, v117, v117 row_shr:2 row_mask:0xf bank_mask:0xf
  v_add_f32_dpp v121, v121, v121 row_shr:2 row_mask:0xf bank_mask:0xf
  v_add_f32_dpp v116, v116, v116 row_shr:4 row_mask:0xf bank_mask:0xf
  v_add_f32_dpp v120, v120, v120 row_shr:4 row_mask:0xf bank_mask:0xf
  v_add_f32_dpp v117, v117, v117 row_shr:4 row_mask:0xf bank_mask:0xf
  v_add_f32_dpp v121, v121, v121 row_shr:4 row_mask:0xf bank_mask:0xf
  v_add_f32_dpp v116, v116, v116 row_shr:8 row_mask:0xf bank_mask:0xf
  v_add_f32_dpp v120, v120, v120 row_shr:8 row_mask:0xf bank_mask:0xf
  v_add_f32_dpp v117, v117, v117 row_shr:8 row_mask:0xf bank_mask:0xf
  v_add_f32_dpp v121, v121, v121 row_shr:8 row_mask:0xf bank_mask:0xf
  v_add_f32_dpp v116, v116, v116 row_bcast:15 row_mask:0xa bank_mask:0xf
  v_add_f32_dpp v120, v120, v120 row_bcast:15 row_mask:0xa bank_mask:0xf
  v_add_f32_dpp v117, v117, v117 row_bcast:15 row_mask:0xa bank_mask:0xf
  v_add_f32_dpp v121, v121, v121 row_bcast:15 row_mask:0xa bank_mask:0xf
  v_add_f32_dpp v116, v116, v116 row_bcast:31 row_mask:0xc bank_mask:0xf
  v_add_f32_dpp v120, v120, v120 row_bcast:31 row_mask:0xc bank_mask:0xf
  v_add_f32_dpp v117, v117, v117 row_bcast:31 row_mask:0xc bank_mask:0xf
  v_add_f32_dpp v121, v121, v121 row_bcast:31 row_mask:0xc bank_mask:0xf
  s_barrier
  ds_read_b64_tr_b16 v[168:169], v63 offset:0
  ds_read_b64_tr_b16 v[170:171], v63 offset:16640
  ds_read_b64_tr_b16 v[172:173], v63 offset:256
  ds_read_b64_tr_b16 v[174:175], v63 offset:16896
  ds_read_b64_tr_b16 v[176:177], v63 offset:512
  ds_read_b64_tr_b16 v[178:179], v63 offset:17152
  ds_read_b64_tr_b16 v[180:181], v63 offset:768
  ds_read_b64_tr_b16 v[182:183], v63 offset:17408
  v_fma_f32 v117, -v116, v116, v117
  v_cvt_pk_bf16_f32 v117, 0, |v117|
  v_add_f32 v117, 0x3727c5ac, v117
  v_cvt_pk_bf16_f32 v117, 0, v117
  v_sqrt_f32 v117, v117
  v_fma_f32 v121, -v120, v120, v121
  v_cvt_pk_bf16_f32 v121, 0, |v121|
  v_add_f32 v121, 0x3727c5ac, v121
  v_cvt_pk_bf16_f32 v121, 0, v121
  v_sqrt_f32 v121, v121
  v_cvt_pk_bf16_f32 v116, v116, v117
  v_cvt_pk_bf16_f32 v117, v120, v121
  s_waitcnt lgkmcnt(0)
  v_xor_b32 v168, v40, v168
  v_xor_b32 v169, v41, v169
  v_xor_b32 v170, v40, v170
  v_xor_b32 v171, v41, v171
  buffer_store_dwordx4 v[168:171], v16, s[8:11], s74 offen sc1
  v_xor_b32 v172, v40, v172
  v_xor_b32 v173, v41, v173
  v_xor_b32 v174, v40, v174
  v_xor_b32 v175, v41, v175
  buffer_store_dwordx4 v[172:175], v16, s[8:11], s75 offen sc1
  v_xor_b32 v176, v40, v176
  v_xor_b32 v177, v41, v177
  v_xor_b32 v178, v40, v178
  v_xor_b32 v179, v41, v179
  buffer_store_dwordx4 v[176:179], v16, s[8:11], s76 offen sc1
  v_xor_b32 v180, v40, v180
  v_xor_b32 v181, v41, v181
  v_xor_b32 v182, v40, v182
  v_xor_b32 v183, v41, v183
  buffer_store_dwordx4 v[180:183], v16, s[8:11], s77 offen sc1
  s_mov_b32 s35, 0x00020000
  s_cmp_ge_u32 s99, 176
  s_cbranch_scc1 P_w2ld
  s_lshr_b32 s59, s99, 3
  s_and_b32 s7, s99, 7
  s_mul_i32 s3, s7, 176128
  s_lshl_b32 s4, s59, 7
  s_add_u32 s3, s3, s4
  s_add_u32 s4, s3, 88064
  s_movk_i32 s34, 2752
  v_lshlrev_b32 v228, 4, v65
  v_mad_u32_u24 v229, v64, s34, v228
  s_mov_b32 s34, 1409024
  s_mov_b32 s32, s12
  s_mov_b32 s33, s13
  buffer_load_dwordx4 v[208:211], v229, s[32:35], s3 offen
  buffer_load_dwordx4 v[216:219], v229, s[32:35], s4 offen
  s_mov_b32 s32, s14
  s_mov_b32 s33, s15
  buffer_load_dwordx4 v[212:215], v229, s[32:35], s3 offen
  buffer_load_dwordx4 v[220:223], v229, s[32:35], s4 offen
  s_branch P_ldd
P_w2ld:
  s_cmp_ge_u32 s99, 248
  s_cbranch_scc1 P_idle
  s_lshr_b32 s59, s2, 3
  s_sub_u32 s59, s59, 22
  s_and_b32 s7, s2, 7
  s_mul_i32 s3, s59, 163840
  s_lshl_b32 s4, s7, 7
  s_add_u32 s3, s3, s4
  v_lshlrev_b32 v228, 4, v65
  v_lshl_add_u32 v229, v64, 10, v228
  s_mov_b32 s34, 1409024
  s_mov_b32 s32, s70
  s_mov_b32 s33, s71
  buffer_load_dwordx4 v[208:211], v229, s[32:35], s3 offen
  s_add_u32 s3, s3, 32768
  buffer_load_dwordx4 v[212:215], v229, s[32:35], s3 offen
  s_add_u32 s3, s3, 32768
  buffer_load_dwordx4 v[216:219], v229, s[32:35], s3 offen
  s_add_u32 s3, s3, 32768
  buffer_load_dwordx4 v[220:223], v229, s[32:35], s3 offen
  s_add_u32 s3, s3, 32768
  buffer_load_dwordx4 v[224:227], v229, s[32:35], s3 offen
  s_add_u32 s3, s3, 32768
P_ldd:
  v_and_b32 v184, 127, v0
  v_lshlrev_b32 v185, 4, v184
  v_sub_u32 v185, 2047, v185
  s_movk_i32 s3, 31008
  v_mul_lo_u32 v186, v56, s3
  v_add_u32 v186, 16, v186
  v_subrev_u32 v148, 0, v185
  v_cvt_f32_i32 v148, v148
  v_cvt_pk_bf16_f32 v148, 0, v148
  v_cvt_i32_f32 v148, v148
  v_ashrrev_i32 v187, 4, v148
  v_add_u32 v148, v148, v187
  v_lshl_add_u32 v148, v148, 2, v186
  v_subrev_u32 v149, 1, v185
  v_cvt_f32_i32 v149, v149
  v_cvt_pk_bf16_f32 v149, 0, v149
  v_cvt_i32_f32 v149, v149
  v_ashrrev_i32 v187, 4, v149
  v_add_u32 v149, v149, v187
  v_lshl_add_u32 v149, v149, 2, v186
  v_subrev_u32 v150, 2, v185
  v_cvt_f32_i32 v150, v150
  v_cvt_pk_bf16_f32 v150, 0, v150
  v_cvt_i32_f32 v150, v150
  v_ashrrev_i32 v187, 4, v150
  v_add_u32 v150, v150, v187
  v_lshl_add_u32 v150, v150, 2, v186
  v_subrev_u32 v151, 3, v185
  v_cvt_f32_i32 v151, v151
  v_cvt_pk_bf16_f32 v151, 0, v151
  v_cvt_i32_f32 v151, v151
  v_ashrrev_i32 v187, 4, v151
  v_add_u32 v151, v151, v187
  v_lshl_add_u32 v151, v151, 2, v186
  v_subrev_u32 v152, 4, v185
  v_cvt_f32_i32 v152, v152
  v_cvt_pk_bf16_f32 v152, 0, v152
  v_cvt_i32_f32 v152, v152
  v_ashrrev_i32 v187, 4, v152
  v_add_u32 v152, v152, v187
  v_lshl_add_u32 v152, v152, 2, v186
  v_subrev_u32 v153, 5, v185
  v_cvt_f32_i32 v153, v153
  v_cvt_pk_bf16_f32 v153, 0, v153
  v_cvt_i32_f32 v153, v153
  v_ashrrev_i32 v187, 4, v153
  v_add_u32 v153, v153, v187
  v_lshl_add_u32 v153, v153, 2, v186
  v_subrev_u32 v154, 6, v185
  v_cvt_f32_i32 v154, v154
  v_cvt_pk_bf16_f32 v154, 0, v154
  v_cvt_i32_f32 v154, v154
  v_ashrrev_i32 v187, 4, v154
  v_add_u32 v154, v154, v187
  v_lshl_add_u32 v154, v154, 2, v186
  v_subrev_u32 v155, 7, v185
  v_cvt_f32_i32 v155, v155
  v_cvt_pk_bf16_f32 v155, 0, v155
  v_cvt_i32_f32 v155, v155
  v_ashrrev_i32 v187, 4, v155
  v_add_u32 v155, v155, v187
  v_lshl_add_u32 v155, v155, 2, v186
  v_subrev_u32 v156, 8, v185
  v_cvt_f32_i32 v156, v156
  v_cvt_pk_bf16_f32 v156, 0, v156
  v_cvt_i32_f32 v156, v156
  v_ashrrev_i32 v187, 4, v156
  v_add_u32 v156, v156, v187
  v_lshl_add_u32 v156, v156, 2, v186
  v_subrev_u32 v157, 9, v185
  v_cvt_f32_i32 v157, v157
  v_cvt_pk_bf16_f32 v157, 0, v157
  v_cvt_i32_f32 v157, v157
  v_ashrrev_i32 v187, 4, v157
  v_add_u32 v157, v157, v187
  v_lshl_add_u32 v157, v157, 2, v186
  v_subrev_u32 v158, 10, v185
  v_cvt_f32_i32 v158, v158
  v_cvt_pk_bf16_f32 v158, 0, v158
  v_cvt_i32_f32 v158, v158
  v_ashrrev_i32 v187, 4, v158
  v_add_u32 v158, v158, v187
  v_lshl_add_u32 v158, v158, 2, v186
  v_subrev_u32 v159, 11, v185
  v_cvt_f32_i32 v159, v159
  v_cvt_pk_bf16_f32 v159, 0, v159
  v_cvt_i32_f32 v159, v159
  v_ashrrev_i32 v187, 4, v159
  v_add_u32 v159, v159, v187
  v_lshl_add_u32 v159, v159, 2, v186
  v_subrev_u32 v160, 12, v185
  v_cvt_f32_i32 v160, v160
  v_cvt_pk_bf16_f32 v160, 0, v160
  v_cvt_i32_f32 v160, v160
  v_ashrrev_i32 v187, 4, v160
  v_add_u32 v160, v160, v187
  v_lshl_add_u32 v160, v160, 2, v186
  v_subrev_u32 v161, 13, v185
  v_cvt_f32_i32 v161, v161
  v_cvt_pk_bf16_f32 v161, 0, v161
s_branch Ia0x
Ia0:
s_branch Ia4
Ia0x:
  v_cvt_i32_f32 v161, v161
  v_ashrrev_i32 v187, 4, v161
  v_add_u32 v161, v161, v187
  v_lshl_add_u32 v161, v161, 2, v186
  v_subrev_u32 v162, 14, v185
  v_cvt_f32_i32 v162, v162
  v_cvt_pk_bf16_f32 v162, 0, v162
  v_cvt_i32_f32 v162, v162
  v_ashrrev_i32 v187, 4, v162
  v_add_u32 v162, v162, v187
  v_lshl_add_u32 v162, v162, 2, v186
  v_subrev_u32 v163, 15, v185
  v_cvt_f32_i32 v163, v163
  v_cvt_pk_bf16_f32 v163, 0, v163
  v_cvt_i32_f32 v163, v163
  v_ashrrev_i32 v187, 4, v163
  v_add_u32 v163, v163, v187
  v_lshl_add_u32 v163, v163, 2, v186
  v_subrev_u32 v164, 16, v185
  v_cvt_f32_i32 v164, v164
  v_cvt_pk_bf16_f32 v164, 0, v164
  v_cvt_i32_f32 v164, v164
  v_ashrrev_i32 v187, 4, v164
  v_add_u32 v164, v164, v187
  v_lshl_add_u32 v164, v164, 2, v186
  v_subrev_u32 v165, 17, v185
  v_cvt_f32_i32 v165, v165
  v_cvt_pk_bf16_f32 v165, 0, v165
  v_cvt_i32_f32 v165, v165
  v_ashrrev_i32 v187, 4, v165
  v_add_u32 v165, v165, v187
  v_lshl_add_u32 v165, v165, 2, v186
  v_subrev_u32 v166, 18, v185
  v_cvt_f32_i32 v166, v166
  v_cvt_pk_bf16_f32 v166, 0, v166
  v_cvt_i32_f32 v166, v166
  v_ashrrev_i32 v187, 4, v166
  v_add_u32 v166, v166, v187
  v_lshl_add_u32 v166, v166, 2, v186
  s_waitcnt vmcnt(9)
  s_waitcnt vmcnt(8)
  s_mov_b32 exec_lo, 0
  s_brev_b32 exec_hi, 1
  buffer_store_dwordx4 v[116:119], v73, s[8:11], s80 offen sc1
  s_mov_b64 exec, -1
  s_movk_i32 s3, 15504
  v_mul_lo_u32 v36, v34, s3
  v_add_u32 v59, v36, v19
  v_lshlrev_b32 v48, 16, v48
  v_lshlrev_b32 v49, 16, v49
  v_lshlrev_b32 v50, 16, v50
  v_lshlrev_b32 v51, 16, v51
  v_lshlrev_b32 v52, 16, v52
  v_lshlrev_b32 v53, 16, v53
  v_lshlrev_b32 v54, 16, v54
  v_mul_f32 v54, 0x3fb8aa3b, v54
  v_exp_f32 v54, v54
  s_nop 0
  v_cvt_pk_bf16_f32 v54, 0, v54
  v_mul_f32 v48, v54, v48
  v_mul_f32 v49, v54, v49
  v_mul_f32 v50, v54, v50
  v_mul_f32 v51, v54, v51
  v_pk_mul_f32 v[126:127], v[52:53], v[50:51] op_sel:[0,0] op_sel_hi:[0,1]
  v_pk_fma_f32 v[124:125], v[52:53], v[50:51], v[126:127] op_sel:[1,1,0] op_sel_hi:[1,0,1] neg_lo:[0,1,0]
  v_mul_f32 v48, 0x3fb8aa3b, v48
  v_mul_f32 v49, 0x3e22f983, v49
  v_mul_f32 v126, 0x3f800000, v48
  v_mul_f32 v127, 0x3f800000, v49
  v_exp_f32 v126, v126
  v_fract_f32 v127, v127
  v_cos_f32 v130, v127
  v_sin_f32 v131, v127
  s_nop 0
  v_mul_f32 v130, v126, v130
  v_mul_f32 v131, v126, v131
  v_mul_f32 v126, 0x41000000, v48
  v_mul_f32 v127, 0x41000000, v49
  v_exp_f32 v126, v126
  v_fract_f32 v127, v127
  v_cos_f32 v132, v127
  v_sin_f32 v133, v127
  s_nop 0
  v_mul_f32 v132, v126, v132
  v_mul_f32 v133, v126, v133
  v_mul_f32 v126, 0x43800000, v48
  v_mul_f32 v127, 0x43800000, v49
  v_exp_f32 v126, v126
  v_fract_f32 v127, v127
  v_cos_f32 v134, v127
  v_sin_f32 v135, v127
  s_nop 0
  v_mul_f32 v134, v126, v134
  v_mul_f32 v135, v126, v135
  v_cvt_pk_bf16_f32 v128, v124, -v125
  ds_write_b32 v59, v128 offset:0
  v_mov_b32 v129, 0x3f80
  ds_write_b32 v59, v129 offset:6800
  v_mov_b32 v144, v132
  v_mov_b32 v145, v133
  v_cvt_pk_bf16_f32 v129, v144, v145
  ds_write_b32 v59, v129 offset:7072
  v_pk_mul_f32 v[126:127], v[124:125], v[130:131] op_sel:[0,0] op_sel_hi:[0,1]
  v_pk_fma_f32 v[136:137], v[124:125], v[130:131], v[126:127] op_sel:[1,1,0] op_sel_hi:[1,0,1] neg_lo:[0,1,0]
  v_cvt_pk_bf16_f32 v128, v136, -v137
  ds_write_b32 v59, v128 offset:272
  v_pk_mul_f32 v[146:147], v[144:145], v[132:133] op_sel:[0,0] op_sel_hi:[0,1]
  v_pk_fma_f32 v[144:145], v[144:145], v[132:133], v[146:147] op_sel:[1,1,0] op_sel_hi:[1,0,1] neg_lo:[0,1,0]
  v_cvt_pk_bf16_f32 v129, v144, v145
  ds_write_b32 v59, v129 offset:7344
  v_pk_mul_f32 v[126:127], v[136:137], v[130:131] op_sel:[0,0] op_sel_hi:[0,1]
  v_pk_fma_f32 v[138:139], v[136:137], v[130:131], v[126:127] op_sel:[1,1,0] op_sel_hi:[1,0,1] neg_lo:[0,1,0]
  v_cvt_pk_bf16_f32 v128, v138, -v139
  ds_write_b32 v59, v128 offset:544
  v_pk_mul_f32 v[146:147], v[144:145], v[132:133] op_sel:[0,0] op_sel_hi:[0,1]
  v_pk_fma_f32 v[144:145], v[144:145], v[132:133], v[146:147] op_sel:[1,1,0] op_sel_hi:[1,0,1] neg_lo:[0,1,0]
  v_cvt_pk_bf16_f32 v129, v144, v145
  ds_write_b32 v59, v129 offset:7616
  v_pk_mul_f32 v[126:127], v[138:139], v[130:131] op_sel:[0,0] op_sel_hi:[0,1]
  v_pk_fma_f32 v[136:137], v[138:139], v[130:131], v[126:127] op_sel:[1,1,0] op_sel_hi:[1,0,1] neg_lo:[0,1,0]
  v_cvt_pk_bf16_f32 v128, v136, -v137
  ds_write_b32 v59, v128 offset:816
  v_pk_mul_f32 v[146:147], v[144:145], v[132:133] op_sel:[0,0] op_sel_hi:[0,1]
  v_pk_fma_f32 v[144:145], v[144:145], v[132:133], v[146:147] op_sel:[1,1,0] op_sel_hi:[1,0,1] neg_lo:[0,1,0]
  v_cvt_pk_bf16_f32 v129, v144, v145
  ds_write_b32 v59, v129 offset:7888
  v_pk_mul_f32 v[126:127], v[136:137], v[130:131] op_sel:[0,0] op_sel_hi:[0,1]
  v_pk_fma_f32 v[140:141], v[136:137], v[130:131], v[126:127] op_sel:[1,1,0] op_sel_hi:[1,0,1] neg_lo:[0,1,0]
  v_cvt_pk_bf16_f32 v128, v140, -v141
  ds_write_b32 v59, v128 offset:1088
  v_pk_mul_f32 v[146:147], v[144:145], v[132:133] op_sel:[0,0] op_sel_hi:[0,1]
  v_pk_fma_f32 v[144:145], v[144:145], v[132:133], v[146:147] op_sel:[1,1,0] op_sel_hi:[1,0,1] neg_lo:[0,1,0]
  v_cvt_pk_bf16_f32 v129, v144, v145
  ds_write_b32 v59, v129 offset:8160
  v_pk_mul_f32 v[126:127], v[140:141], v[130:131] op_sel:[0,0] op_sel_hi:[0,1]
  v_pk_fma_f32 v[136:137], v[140:141], v[130:131], v[126:127] op_sel:[1,1,0] op_sel_hi:[1,0,1] neg_lo:[0,1,0]
  v_cvt_pk_bf16_f32 v128, v136, -v137
  ds_write_b32 v59, v128 offset:1360
  v_pk_mul_f32 v[146:147], v[144:145], v[132:133] op_sel:[0,0] op_sel_hi:[0,1]
  v_pk_fma_f32 v[144:145], v[144:145], v[132:133], v[146:147] op_sel:[1,1,0] op_sel_hi:[1,0,1] neg_lo:[0,1,0]
  v_cvt_pk_bf16_f32 v129, v144, v145
  ds_write_b32 v59, v129 offset:8432
  v_pk_mul_f32 v[126:127], v[136:137], v[130:131] op_sel:[0,0] op_sel_hi:[0,1]
  v_pk_fma_f32 v[142:143], v[136:137], v[130:131], v[126:127] op_sel:[1,1,0] op_sel_hi:[1,0,1] neg_lo:[0,1,0]
  v_cvt_pk_bf16_f32 v128, v142, -v143
  ds_write_b32 v59, v128 offset:1632
  v_pk_mul_f32 v[146:147], v[144:145], v[132:133] op_sel:[0,0] op_sel_hi:[0,1]
  v_pk_fma_f32 v[144:145], v[144:145], v[132:133], v[146:147] op_sel:[1,1,0] op_sel_hi:[1,0,1] neg_lo:[0,1,0]
  v_cvt_pk_bf16_f32 v129, v144, v145
  ds_write_b32 v59, v129 offset:8704
  v_pk_mul_f32 v[126:127], v[142:143], v[130:131] op_sel:[0,0] op_sel_hi:[0,1]
  v_pk_fma_f32 v[136:137], v[142:143], v[130:131], v[126:127] op_sel:[1,1,0] op_sel_hi:[1,0,1] neg_lo:[0,1,0]
  v_cvt_pk_bf16_f32 v128, v136, -v137
  ds_write_b32 v59, v128 offset:1904
  v_pk_mul_f32 v[146:147], v[144:145], v[132:133] op_sel:[0,0] op_sel_hi:[0,1]
  v_pk_fma_f32 v[144:145], v[144:145], v[132:133], v[146:147] op_sel:[1,1,0] op_sel_hi:[1,0,1] neg_lo:[0,1,0]
  v_cvt_pk_bf16_f32 v129, v144, v145
  ds_write_b32 v59, v129 offset:8976
  v_pk_mul_f32 v[126:127], v[124:125], v[134:135] op_sel:[0,0] op_sel_hi:[0,1]
  v_pk_fma_f32 v[124:125], v[124:125], v[134:135], v[126:127] op_sel:[1,1,0] op_sel_hi:[1,0,1] neg_lo:[0,1,0]
  v_cvt_pk_bf16_f32 v128, v124, -v125
  ds_write_b32 v59, v128 offset:2176
  v_pk_mul_f32 v[146:147], v[144:145], v[132:133] op_sel:[0,0] op_sel_hi:[0,1]
  v_pk_fma_f32 v[144:145], v[144:145], v[132:133], v[146:147] op_sel:[1,1,0] op_sel_hi:[1,0,1] neg_lo:[0,1,0]
  v_cvt_pk_bf16_f32 v129, v144, v145
  ds_write_b32 v59, v129 offset:9248
  v_pk_mul_f32 v[126:127], v[138:139], v[134:135] op_sel:[0,0] op_sel_hi:[0,1]
  v_pk_fma_f32 v[138:139], v[138:139], v[134:135], v[126:127] op_sel:[1,1,0] op_sel_hi:[1,0,1] neg_lo:[0,1,0]
  v_cvt_pk_bf16_f32 v128, v138, -v139
  ds_write_b32 v59, v128 offset:2448
  v_pk_mul_f32 v[146:147], v[144:145], v[132:133] op_sel:[0,0] op_sel_hi:[0,1]
  v_pk_fma_f32 v[144:145], v[144:145], v[132:133], v[146:147] op_sel:[1,1,0] op_sel_hi:[1,0,1] neg_lo:[0,1,0]
  v_cvt_pk_bf16_f32 v129, v144, v145
  ds_write_b32 v59, v129 offset:9520
  v_pk_mul_f32 v[126:127], v[140:141], v[134:135] op_sel:[0,0] op_sel_hi:[0,1]
  v_pk_fma_f32 v[140:141], v[140:141], v[134:135], v[126:127] op_sel:[1,1,0] op_sel_hi:[1,0,1] neg_lo:[0,1,0]
  v_cvt_pk_bf16_f32 v128, v140, -v141
  ds_write_b32 v59, v128 offset:3264
  v_pk_mul_f32 v[146:147], v[144:145], v[132:133] op_sel:[0,0] op_sel_hi:[0,1]
  v_pk_fma_f32 v[144:145], v[144:145], v[132:133], v[146:147] op_sel:[1,1,0] op_sel_hi:[1,0,1] neg_lo:[0,1,0]
  v_cvt_pk_bf16_f32 v129, v144, v145
  ds_write_b32 v59, v129 offset:9792
  v_pk_mul_f32 v[126:127], v[142:143], v[134:135] op_sel:[0,0] op_sel_hi:[0,1]
  v_pk_fma_f32 v[142:143], v[142:143], v[134:135], v[126:127] op_sel:[1,1,0] op_sel_hi:[1,0,1] neg_lo:[0,1,0]
  v_cvt_pk_bf16_f32 v128, v142, -v143
  ds_write_b32 v59, v128 offset:3536
  v_pk_mul_f32 v[146:147], v[144:145], v[132:133] op_sel:[0,0] op_sel_hi:[0,1]
  v_pk_fma_f32 v[144:145], v[144:145], v[132:133], v[146:147] op_sel:[1,1,0] op_sel_hi:[1,0,1] neg_lo:[0,1,0]
  v_cvt_pk_bf16_f32 v129, v144, v145
  ds_write_b32 v59, v129 offset:10064
  v_pk_mul_f32 v[126:127], v[124:125], v[134:135] op_sel:[0,0] op_sel_hi:[0,1]
  v_pk_fma_f32 v[124:125], v[124:125], v[134:135], v[126:127] op_sel:[1,1,0] op_sel_hi:[1,0,1] neg_lo:[0,1,0]
  v_cvt_pk_bf16_f32 v128, v124, -v125
  ds_write_b32 v59, v128 offset:2720
  v_pk_mul_f32 v[146:147], v[144:145], v[132:133] op_sel:[0,0] op_sel_hi:[0,1]
  v_pk_fma_f32 v[144:145], v[144:145], v[132:133], v[146:147] op_sel:[1,1,0] op_sel_hi:[1,0,1] neg_lo:[0,1,0]
  v_cvt_pk_bf16_f32 v129, v144, v145
  ds_write_b32 v59, v129 offset:10336
  v_pk_mul_f32 v[126:127], v[140:141], v[134:135] op_sel:[0,0] op_sel_hi:[0,1]
  v_pk_fma_f32 v[140:141], v[140:141], v[134:135], v[126:127] op_sel:[1,1,0] op_sel_hi:[1,0,1] neg_lo:[0,1,0]
  v_cvt_pk_bf16_f32 v128, v140, -v141
  ds_write_b32 v59, v128 offset:3808
  v_pk_mul_f32 v[146:147], v[144:145], v[132:133] op_sel:[0,0] op_sel_hi:[0,1]
  v_pk_fma_f32 v[144:145], v[144:145], v[132:133], v[146:147] op_sel:[1,1,0] op_sel_hi:[1,0,1] neg_lo:[0,1,0]
  v_cvt_pk_bf16_f32 v129, v144, v145
  ds_write_b32 v59, v129 offset:10608
  v_pk_mul_f32 v[126:127], v[124:125], v[134:135] op_sel:[0,0] op_sel_hi:[0,1]
  v_pk_fma_f32 v[124:125], v[124:125], v[134:135], v[126:127] op_sel:[1,1,0] op_sel_hi:[1,0,1] neg_lo:[0,1,0]
  v_cvt_pk_bf16_f32 v128, v124, -v125
  ds_write_b32 v59, v128 offset:2992
  v_pk_mul_f32 v[146:147], v[144:145], v[132:133] op_sel:[0,0] op_sel_hi:[0,1]
  v_pk_fma_f32 v[144:145], v[144:145], v[132:133], v[146:147] op_sel:[1,1,0] op_sel_hi:[1,0,1] neg_lo:[0,1,0]
  v_cvt_pk_bf16_f32 v129, v144, v145
  ds_write_b32 v59, v129 offset:10880
  v_pk_mul_f32 v[126:127], v[140:141], v[134:135] op_sel:[0,0] op_sel_hi:[0,1]
  v_pk_fma_f32 v[140:141], v[140:141], v[134:135], v[126:127] op_sel:[1,1,0] op_sel_hi:[1,0,1] neg_lo:[0,1,0]
  v_cvt_pk_bf16_f32 v128, v140, -v141
  ds_write_b32 v59, v128 offset:4080
  v_pk_mul_f32 v[146:147], v[144:145], v[132:133] op_sel:[0,0] op_sel_hi:[0,1]
  v_pk_fma_f32 v[144:145], v[144:145], v[132:133], v[146:147] op_sel:[1,1,0] op_sel_hi:[1,0,1] neg_lo:[0,1,0]
  v_cvt_pk_bf16_f32 v129, v144, v145
  ds_write_b32 v59, v129 offset:11152
  v_pk_mul_f32 v[126:127], v[124:125], v[134:135] op_sel:[0,0] op_sel_hi:[0,1]
  v_pk_fma_f32 v[124:125], v[124:125], v[134:135], v[126:127] op_sel:[1,1,0] op_sel_hi:[1,0,1] neg_lo:[0,1,0]
  s_add_u32 s97, s36, 0x00100000
  buffer_store_dwordx4 v[200:203], v3, s[8:11], s97 offen sc1
  v_cvt_pk_bf16_f32 v128, v124, -v125
  ds_write_b32 v59, v128 offset:4352
  v_pk_mul_f32 v[146:147], v[144:145], v[132:133] op_sel:[0,0] op_sel_hi:[0,1]
  v_pk_fma_f32 v[144:145], v[144:145], v[132:133], v[146:147] op_sel:[1,1,0] op_sel_hi:[1,0,1] neg_lo:[0,1,0]
  v_cvt_pk_bf16_f32 v129, v144, v145
  ds_write_b32 v59, v129 offset:11424
  v_pk_mul_f32 v[126:127], v[124:125], v[134:135] op_sel:[0,0] op_sel_hi:[0,1]
  v_pk_fma_f32 v[124:125], v[124:125], v[134:135], v[126:127] op_sel:[1,1,0] op_sel_hi:[1,0,1] neg_lo:[0,1,0]
  v_cvt_pk_bf16_f32 v128, v124, -v125
  ds_write_b32 v59, v128 offset:4624
  v_pk_mul_f32 v[146:147], v[144:145], v[132:133] op_sel:[0,0] op_sel_hi:[0,1]
  v_pk_fma_f32 v[144:145], v[144:145], v[132:133], v[146:147] op_sel:[1,1,0] op_sel_hi:[1,0,1] neg_lo:[0,1,0]
  v_cvt_pk_bf16_f32 v129, v144, v145
  ds_write_b32 v59, v129 offset:11696
  v_pk_mul_f32 v[126:127], v[124:125], v[134:135] op_sel:[0,0] op_sel_hi:[0,1]
  v_pk_fma_f32 v[124:125], v[124:125], v[134:135], v[126:127] op_sel:[1,1,0] op_sel_hi:[1,0,1] neg_lo:[0,1,0]
  v_cvt_pk_bf16_f32 v128, v124, -v125
  ds_write_b32 v59, v128 offset:4896
  v_pk_mul_f32 v[146:147], v[144:145], v[132:133] op_sel:[0,0] op_sel_hi:[0,1]
  v_pk_fma_f32 v[144:145], v[144:145], v[132:133], v[146:147] op_sel:[1,1,0] op_sel_hi:[1,0,1] neg_lo:[0,1,0]
  v_cvt_pk_bf16_f32 v129, v144, v145
  ds_write_b32 v59, v129 offset:11968
  v_pk_mul_f32 v[126:127], v[124:125], v[134:135] op_sel:[0,0] op_sel_hi:[0,1]
  v_pk_fma_f32 v[124:125], v[124:125], v[134:135], v[126:127] op_sel:[1,1,0] op_sel_hi:[1,0,1] neg_lo:[0,1,0]
  v_cvt_pk_bf16_f32 v128, v124, -v125
  ds_write_b32 v59, v128 offset:5168
  v_pk_mul_f32 v[146:147], v[144:145], v[132:133] op_sel:[0,0] op_sel_hi:[0,1]
  v_pk_fma_f32 v[144:145], v[144:145], v[132:133], v[146:147] op_sel:[1,1,0] op_sel_hi:[1,0,1] neg_lo:[0,1,0]
  v_cvt_pk_bf16_f32 v129, v144, v145
  ds_write_b32 v59, v129 offset:12240
  v_pk_mul_f32 v[126:127], v[124:125], v[134:135] op_sel:[0,0] op_sel_hi:[0,1]
  v_pk_fma_f32 v[124:125], v[124:125], v[134:135], v[126:127] op_sel:[1,1,0] op_sel_hi:[1,0,1] neg_lo:[0,1,0]
  v_cvt_pk_bf16_f32 v128, v124, -v125
  ds_write_b32 v59, v128 offset:6528
  v_pk_mul_f32 v[146:147], v[144:145], v[132:133] op_sel:[0,0] op_sel_hi:[0,1]
  v_pk_fma_f32 v[144:145], v[144:145], v[132:133], v[146:147] op_sel:[1,1,0] op_sel_hi:[1,0,1] neg_lo:[0,1,0]
  v_cvt_pk_bf16_f32 v129, v144, v145
  ds_write_b32 v59, v129 offset:12512
  v_pk_mul_f32 v[146:147], v[144:145], v[132:133] op_sel:[0,0] op_sel_hi:[0,1]
  v_pk_fma_f32 v[144:145], v[144:145], v[132:133], v[146:147] op_sel:[1,1,0] op_sel_hi:[1,0,1] neg_lo:[0,1,0]
  v_cvt_pk_bf16_f32 v129, v144, v145
  ds_write_b32 v59, v129 offset:12784
  v_pk_mul_f32 v[146:147], v[144:145], v[132:133] op_sel:[0,0] op_sel_hi:[0,1]
  v_pk_fma_f32 v[144:145], v[144:145], v[132:133], v[146:147] op_sel:[1,1,0] op_sel_hi:[1,0,1] neg_lo:[0,1,0]
  v_cvt_pk_bf16_f32 v129, v144, v145
  ds_write_b32 v59, v129 offset:13056
  v_pk_mul_f32 v[146:147], v[144:145], v[132:133] op_sel:[0,0] op_sel_hi:[0,1]
  v_pk_fma_f32 v[144:145], v[144:145], v[132:133], v[146:147] op_sel:[1,1,0] op_sel_hi:[1,0,1] neg_lo:[0,1,0]
  v_cvt_pk_bf16_f32 v129, v144, v145
  ds_write_b32 v59, v129 offset:13328
  v_pk_mul_f32 v[146:147], v[144:145], v[132:133] op_sel:[0,0] op_sel_hi:[0,1]
  v_pk_fma_f32 v[144:145], v[144:145], v[132:133], v[146:147] op_sel:[1,1,0] op_sel_hi:[1,0,1] neg_lo:[0,1,0]
  s_add_u32 s97, s58, 0x00400000
  s_cmp_lt_u32 s2, 52
  s_cselect_b32 s97, s97, 0x03000000
  buffer_store_dwordx4 v[200:203], v16, s[8:11], s97 offen sc1
  v_cvt_pk_bf16_f32 v129, v144, v145
  ds_write_b32 v59, v129 offset:13600
  v_pk_mul_f32 v[146:147], v[144:145], v[132:133] op_sel:[0,0] op_sel_hi:[0,1]
  v_pk_fma_f32 v[144:145], v[144:145], v[132:133], v[146:147] op_sel:[1,1,0] op_sel_hi:[1,0,1] neg_lo:[0,1,0]
  v_cvt_pk_bf16_f32 v129, v144, v145
  ds_write_b32 v59, v129 offset:13872
  v_pk_mul_f32 v[146:147], v[144:145], v[132:133] op_sel:[0,0] op_sel_hi:[0,1]
  v_pk_fma_f32 v[144:145], v[144:145], v[132:133], v[146:147] op_sel:[1,1,0] op_sel_hi:[1,0,1] neg_lo:[0,1,0]
  v_cvt_pk_bf16_f32 v129, v144, v145
  ds_write_b32 v59, v129 offset:14144
  v_pk_mul_f32 v[146:147], v[144:145], v[132:133] op_sel:[0,0] op_sel_hi:[0,1]
  v_pk_fma_f32 v[144:145], v[144:145], v[132:133], v[146:147] op_sel:[1,1,0] op_sel_hi:[1,0,1] neg_lo:[0,1,0]
  v_cvt_pk_bf16_f32 v129, v144, v145
  ds_write_b32 v59, v129 offset:14416
  v_pk_mul_f32 v[146:147], v[144:145], v[132:133] op_sel:[0,0] op_sel_hi:[0,1]
  v_pk_fma_f32 v[144:145], v[144:145], v[132:133], v[146:147] op_sel:[1,1,0] op_sel_hi:[1,0,1] neg_lo:[0,1,0]
  v_cvt_pk_bf16_f32 v129, v144, v145
  ds_write_b32 v59, v129 offset:14688
  v_pk_mul_f32 v[146:147], v[144:145], v[132:133] op_sel:[0,0] op_sel_hi:[0,1]
  v_pk_fma_f32 v[144:145], v[144:145], v[132:133], v[146:147] op_sel:[1,1,0] op_sel_hi:[1,0,1] neg_lo:[0,1,0]
  v_cvt_pk_bf16_f32 v129, v144, v145
  ds_write_b32 v59, v129 offset:14960
  v_pk_mul_f32 v[146:147], v[144:145], v[132:133] op_sel:[0,0] op_sel_hi:[0,1]
  v_pk_fma_f32 v[144:145], v[144:145], v[132:133], v[146:147] op_sel:[1,1,0] op_sel_hi:[1,0,1] neg_lo:[0,1,0]
  v_cvt_pk_bf16_f32 v129, v144, v145
  ds_write_b32 v59, v129 offset:15232
  s_movk_i32 s3, 272
  v_mad_u32_u24 v38, v81, s3, v36
  v_lshl_add_u32 v38, v77, 4, v38
  s_waitcnt lgkmcnt(0)
  ds_read_b128 v[84:87], v38 offset:0
  ds_read_b128 v[88:91], v38 offset:6800
  ds_read_b128 v[92:95], v38 offset:32
  ds_read_b128 v[96:99], v38 offset:6832
  ds_read_b128 v[100:103], v38 offset:64
  ds_read_b128 v[104:107], v38 offset:6864
  ds_read_b128 v[108:111], v38 offset:96
  ds_read_b128 v[112:115], v38 offset:6896
  ds_read_b128 v[116:119], v38 offset:128
  ds_read_b128 v[120:123], v38 offset:6928
  ds_read_b128 v[124:127], v38 offset:160
  ds_read_b128 v[128:131], v38 offset:6960
  ds_read_b128 v[132:135], v38 offset:192
  ds_read_b128 v[136:139], v38 offset:6992
  ds_read_b128 v[140:143], v38 offset:224
  ds_read_b128 v[144:147], v38 offset:7024
  s_lshr_b32 s74, s5, 1
  s_lshl_b32 s74, s74, 7
  s_and_b32 s4, s5, 1
  s_lshl_b32 s4, s4, 5
  s_add_u32 s74, s74, s4
  v_and_b32 v60, 127, v0
  s_waitcnt lgkmcnt(14)
  v_mfma_f32_32x32x16_bf16 v[40:55], v[84:87], v[88:91], 0
  v_lshrrev_b32 v39, 1, v81
  s_waitcnt lgkmcnt(12)
  v_mfma_f32_32x32x16_bf16 v[40:55], v[92:95], v[96:99], v[40:55]
  v_lshl_add_u32 v39, v81, 3, v39
  s_waitcnt lgkmcnt(10)
  v_mfma_f32_32x32x16_bf16 v[40:55], v[100:103], v[104:107], v[40:55]
  v_lshl_add_u32 v39, v77, 2, v39
  s_waitcnt lgkmcnt(8)
  v_mfma_f32_32x32x16_bf16 v[40:55], v[108:111], v[112:115], v[40:55]
  v_lshl_add_u32 v39, v39, 2, v36
  s_waitcnt lgkmcnt(6)
  v_mfma_f32_32x32x16_bf16 v[40:55], v[116:119], v[120:123], v[40:55]
  v_mov_b32 v168, 0
  s_waitcnt lgkmcnt(4)
  v_mfma_f32_32x32x16_bf16 v[40:55], v[124:127], v[128:131], v[40:55]
  v_mov_b32 v169, 0
  s_waitcnt lgkmcnt(2)
  v_mfma_f32_32x32x16_bf16 v[40:55], v[132:135], v[136:139], v[40:55]
  v_mov_b32 v170, 0
  s_waitcnt lgkmcnt(0)
  v_mfma_f32_32x32x16_bf16 v[40:55], v[140:143], v[144:147], v[40:55]
  v_mov_b32 v171, 0
  ds_write_b128 v36, v[168:171]
  s_nop 7
  s_nop 5
  ds_write_b32 v39, v40 offset:16
  ds_write_b32 v39, v41 offset:20
  ds_write_b32 v39, v42 offset:24
  ds_write_b32 v39, v43 offset:28
  ds_write_b32 v39, v44 offset:1104
  ds_write_b32 v39, v45 offset:1112
  ds_write_b32 v39, v46 offset:2192
  ds_write_b32 v39, v47 offset:3280
  ds_write_b32 v39, v48 offset:4368
  ds_write_b32 v39, v49 offset:5456
  ds_write_b32 v39, v50 offset:6544
  ds_write_b32 v39, v51 offset:7632
  ds_write_b32 v39, v52 offset:8720
  s_waitcnt lgkmcnt(0)
  s_barrier
  ds_read_b32 v116, v148 offset:15504
  ds_read_b32 v84, v148
  ds_read_b32 v117, v149 offset:15504
  ds_read_b32 v85, v149
  ds_read_b32 v118, v150 offset:15504
  ds_read_b32 v86, v150
  ds_read_b32 v119, v151 offset:15504
  ds_read_b32 v87, v151
  ds_read_b32 v120, v152 offset:15504
  ds_read_b32 v88, v152
  ds_read_b32 v121, v153 offset:15504
  ds_read_b32 v89, v153
  ds_read_b32 v122, v154 offset:15504
  ds_read_b32 v90, v154
  ds_read_b32 v123, v155 offset:15504
  ds_read_b32 v91, v155
  ds_read_b32 v124, v156 offset:15504
  ds_read_b32 v92, v156
  ds_read_b32 v125, v157 offset:15504
  ds_read_b32 v93, v157
  ds_read_b32 v126, v158 offset:15504
  ds_read_b32 v94, v158
  ds_read_b32 v127, v159 offset:15504
  ds_read_b32 v95, v159
  ds_read_b32 v128, v160 offset:15504
  ds_read_b32 v96, v160
  ds_read_b32 v129, v161 offset:15504
  ds_read_b32 v97, v161
  ds_read_b32 v130, v162 offset:15504
  ds_read_b32 v98, v162
  ds_read_b32 v131, v163 offset:15504
  ds_read_b32 v99, v163
  ds_read_b32 v132, v164 offset:15504
  ds_read_b32 v100, v164
  ds_read_b32 v133, v165 offset:15504
  ds_read_b32 v101, v165
  ds_read_b32 v134, v166 offset:15504
  ds_read_b32 v102, v166
  s_add_u32 s3, s74, 0x01600000
  buffer_load_dwordx4 v[168:171], v82, s[8:11], s3 offen sc1
  s_add_u32 s3, s74, 0x01800000
  buffer_load_dwordx4 v[172:175], v82, s[8:11], s3 offen sc1
  s_add_u32 s3, s74, 0x01600000
  buffer_load_dwordx4 v[180:183], v83, s[8:11], s3 offen sc1
  s_add_u32 s3, s74, 0x01800000
  buffer_load_dwordx4 v[184:187], v83, s[8:11], s3 offen sc1
  s_mov_b32 s3, 0x01400000
  buffer_load_dwordx4 v[176:179], v16, s[8:11], s3 offen sc1
  s_mov_b32 s3, 0x01401000
  buffer_load_dwordx4 v[188:191], v16, s[8:11], s3 offen sc1
  s_mov_b32 s3, 0x01402000
  buffer_load_dwordx4 v[192:195], v16, s[8:11], s3 offen sc1
  s_mov_b32 s3, 0x01403000
  buffer_load_dwordx4 v[196:199], v16, s[8:11], s3 offen sc1
  s_movk_i32 s4, 16640
  v_lshlrev_b32 v39, 5, v60
  v_mad_u32_u24 v39, v56, s4, v39
  v_add_u32 v39, 98304, v39
  s_waitcnt lgkmcnt(0)
  v_pk_add_f32 v[84:85], v[84:85], v[116:117]
  v_pk_add_f32 v[86:87], v[86:87], v[118:119]
  v_pk_add_f32 v[88:89], v[88:89], v[120:121]
  v_pk_add_f32 v[90:91], v[90:91], v[122:123]
  v_pk_add_f32 v[92:93], v[92:93], v[124:125]
  v_pk_add_f32 v[94:95], v[94:95], v[126:127]
  v_pk_add_f32 v[96:97], v[96:97], v[128:129]
  v_pk_add_f32 v[98:99], v[98:99], v[130:131]
  v_pk_add_f32 v[100:101], v[100:101], v[132:133]
  v_pk_add_f32 v[102:103], v[102:103], v[134:135]
  v_cvt_pk_bf16_f32 v104, v84, v85
  v_cvt_pk_bf16_f32 v105, v86, v87
  v_cvt_pk_bf16_f32 v106, v88, v89
  v_cvt_pk_bf16_f32 v107, v90, v91
  v_cvt_pk_bf16_f32 v108, v92, v93
  v_cvt_pk_bf16_f32 v109, v94, v95
  v_cvt_pk_bf16_f32 v110, v96, v97
  v_cvt_pk_bf16_f32 v111, v98, v99
  ds_write_b128 v39, v[104:107] offset:0
  ds_write_b128 v39, v[108:111] offset:16
  v_cvt_pk_bf16_f32 v112, v85, v86
  v_cvt_pk_bf16_f32 v113, v87, v88
  v_cvt_pk_bf16_f32 v114, v89, v90
  v_cvt_pk_bf16_f32 v115, v91, v92
  v_cvt_pk_bf16_f32 v116, v93, v94
  v_cvt_pk_bf16_f32 v117, v95, v96
  v_cvt_pk_bf16_f32 v118, v97, v98
  v_cvt_pk_bf16_f32 v119, v99, v100
  ds_write_b128 v39, v[112:115] offset:4160
  ds_write_b128 v39, v[116:119] offset:4176
  v_cvt_pk_bf16_f32 v120, v86, v87
  v_cvt_pk_bf16_f32 v121, v88, v89
  v_cvt_pk_bf16_f32 v122, v90, v91
  v_cvt_pk_bf16_f32 v123, v92, v93
  v_cvt_pk_bf16_f32 v124, v94, v95
  v_cvt_pk_bf16_f32 v125, v96, v97
  v_cvt_pk_bf16_f32 v126, v98, v99
  v_cvt_pk_bf16_f32 v127, v100, v101
  ds_write_b128 v39, v[120:123] offset:8320
  ds_write_b128 v39, v[124:127] offset:8336
  v_cvt_pk_bf16_f32 v128, v87, v88
  v_cvt_pk_bf16_f32 v129, v89, v90
  v_cvt_pk_bf16_f32 v130, v91, v92
  v_cvt_pk_bf16_f32 v131, v93, v94
  v_cvt_pk_bf16_f32 v132, v95, v96
  v_cvt_pk_bf16_f32 v133, v97, v98
  v_cvt_pk_bf16_f32 v134, v99, v100
  v_cvt_pk_bf16_f32 v135, v101, v102
  ds_write_b128 v39, v[128:131] offset:12480
  ds_write_b128 v39, v[132:135] offset:12496
  s_waitcnt vmcnt(11)
  s_cmp_ge_u32 s99, 176
  s_cbranch_scc1 P_w2
  s_movk_i32 s4, 288
  v_mad_u32_u24 v229, v64, s4, v228
  v_add_u32 v229, 62016, v229
  ds_write_b128 v229, v[208:211]
  ds_write_b128 v229, v[212:215] offset:128
  ds_write_b128 v229, v[216:219] offset:9216
  ds_write_b128 v229, v[220:223] offset:9344
  v_lshl_add_u32 v229, v77, 3, v76
  v_lshlrev_b32 v228, 7, v78
  v_lshl_add_u32 v228, v34, 5, v228
  v_lshl_add_u32 v228, v79, 3, v228
  v_mad_u32_u24 v229, v229, s4, v228
  v_add_u32 v229, 62016, v229
  s_lshl_b32 s3, s59, 2
  s_add_u32 s3, s3, s6
  s_mul_i32 s3, s3, 33792
  s_add_u32 s3, s3, 0x01e00000
  s_lshl_b32 s4, s7, 12
  s_add_u32 s4, s4, s3
  v_mov_b32 v230, 0
  s_waitcnt lgkmcnt(0)
  s_barrier
  ds_read_b64_tr_b16 v[208:209], v229 offset:0
  ds_read_b64_tr_b16 v[210:211], v229 offset:1152
  ds_read_b64_tr_b16 v[212:213], v229 offset:4608
  ds_read_b64_tr_b16 v[214:215], v229 offset:5760
  ds_read_b64_tr_b16 v[216:217], v229 offset:9216
  ds_read_b64_tr_b16 v[218:219], v229 offset:10368
  ds_read_b64_tr_b16 v[220:221], v229 offset:13824
  ds_read_b64_tr_b16 v[222:223], v229 offset:14976
  s_lshl_b32 s7, s7, 7
  s_add_u32 s3, s3, s7
  s_add_u32 s3, s3, 32768
  s_waitcnt lgkmcnt(0)
  buffer_store_dwordx4 v[208:211], v9, s[8:11], s4 offen offset:0 sc1
  buffer_store_dwordx4 v[212:215], v9, s[8:11], s4 offen offset:1024 sc1
  buffer_store_dwordx4 v[216:219], v9, s[8:11], s4 offen offset:2048 sc1
  buffer_store_dwordx4 v[220:223], v9, s[8:11], s4 offen offset:3072 sc1
  v_dot2_f32_bf16 v230, v208, v22, v230
  v_dot2_f32_bf16 v230, v209, v22, v230
  v_dot2_f32_bf16 v230, v210, v22, v230
  v_dot2_f32_bf16 v230, v211, v22, v230
  v_dot2_f32_bf16 v230, v212, v22, v230
  v_dot2_f32_bf16 v230, v213, v22, v230
  v_dot2_f32_bf16 v230, v214, v22, v230
  v_dot2_f32_bf16 v230, v215, v22, v230
  v_dot2_f32_bf16 v230, v216, v22, v230
  v_dot2_f32_bf16 v230, v217, v22, v230
  v_dot2_f32_bf16 v230, v218, v22, v230
  v_dot2_f32_bf16 v230, v219, v22, v230
  v_dot2_f32_bf16 v230, v220, v22, v230
  v_dot2_f32_bf16 v230, v221, v22, v230
  v_dot2_f32_bf16 v230, v222, v22, v230
  v_dot2_f32_bf16 v230, v223, v22, v230
  s_nop 2
  v_mov_b32 v231, v230
  s_nop 1
  v_permlane32_swap_b32 v230, v231
  s_nop 1
  v_add_f32 v230, v230, v231
  v_cvt_pk_bf16_f32 v231, 0, v230
  v_sub_f32 v230, v230, v231
  v_cvt_pk_bf16_f32 v230, v231, v230
  s_mov_b32 exec_hi, 0
  buffer_store_dword v230, v19, s[8:11], s3 offen sc1
  s_mov_b64 exec, -1
  s_branch P_done
P_w2:
  s_cmp_ge_u32 s99, 248
  s_cbranch_scc1 P_idle2
  s_movk_i32 s4, 192
  v_mad_u32_u24 v229, v64, s4, v228
  v_add_u32 v229, 62016, v229
  ds_write_b128 v229, v[208:211] offset:0
  ds_write_b128 v229, v[212:215] offset:6144
  ds_write_b128 v229, v[216:219] offset:12288
  ds_write_b128 v229, v[220:223] offset:18432
  ds_write_b128 v229, v[224:227] offset:24576
  v_lshl_add_u32 v229, v77, 2, v76
  s_movk_i32 s3, 80
  v_mad_u32_u24 v229, v56, s3, v229
  v_lshlrev_b32 v228, 6, v70
  v_lshl_add_u32 v228, v78, 5, v228
  v_lshl_add_u32 v228, v79, 3, v228
  v_mad_u32_u24 v229, v229, s4, v228
  v_add_u32 v229, 62016, v229
  s_movk_i32 s4, 10240
  v_lshl_add_u32 v228, v70, 10, v9
  v_mad_u32_u24 v228, v56, s4, v228
s_branch Ia1x
Ia1:
s_branch Ia5
Ia1x:
  s_mul_i32 s3, s7, 9
  s_add_u32 s3, s3, s59
  s_mul_i32 s3, s3, 20480
  s_add_u32 s3, s3, 0x02200000
  s_waitcnt lgkmcnt(0)
  s_barrier
  ds_read_b64_tr_b16 v[208:209], v229 offset:0
  ds_read_b64_tr_b16 v[210:211], v229 offset:1536
  ds_read_b64_tr_b16 v[212:213], v229 offset:3072
  ds_read_b64_tr_b16 v[214:215], v229 offset:4608
  ds_read_b64_tr_b16 v[216:217], v229 offset:6144
  ds_read_b64_tr_b16 v[218:219], v229 offset:7680
  ds_read_b64_tr_b16 v[220:221], v229 offset:9216
  ds_read_b64_tr_b16 v[222:223], v229 offset:10752
  ds_read_b64_tr_b16 v[224:225], v229 offset:12288
  ds_read_b64_tr_b16 v[226:227], v229 offset:13824
  s_waitcnt lgkmcnt(8)
  buffer_store_dwordx4 v[208:211], v228, s[8:11], s3 offen offset:0 sc1
  s_waitcnt lgkmcnt(6)
  buffer_store_dwordx4 v[212:215], v228, s[8:11], s3 offen offset:2048 sc1
  s_add_u32 s3, s3, 4096
  s_waitcnt lgkmcnt(4)
  buffer_store_dwordx4 v[216:219], v228, s[8:11], s3 offen offset:0 sc1
  s_waitcnt lgkmcnt(2)
  buffer_store_dwordx4 v[220:223], v228, s[8:11], s3 offen offset:2048 sc1
  s_add_u32 s3, s3, 4096
  s_waitcnt lgkmcnt(0)
  buffer_store_dwordx4 v[224:227], v228, s[8:11], s3 offen offset:0 sc1
P_done:
  s_mul_i32 s3, s53, 9
  s_lshl_b32 s4, s6, 1
  s_add_u32 s3, s3, s4
  s_lshl_b32 s3, s3, 2
  s_add_u32 s3, s3, 696
  s_lshr_b32 s4, s38, 2
  s_lshl_b32 s4, s4, 5
  s_add_u32 s4, s4, s6
  v_min_u32 v40, 19, v35
  v_add_u32 v41, s3, v40
  v_lshl_add_u32 v40, v40, 2, s4
  v_cmp_gt_u32 vcc, 8, v35
  s_lshl_b32 s99, s99, 2
  s_add_u32 s99, s99, s6
  s_lshl_b32 s99, s99, 7
  s_add_u32 s99, s99, 0x01440000
  v_cndmask_b32 v40, v41, v40, vcc
  v_lshlrev_b32 v20, 7, v40
  s_lshr_b32 s12, s40, 15
  s_lshl_b32 s12, s12, 9
  s_lshr_b32 s13, s41, 15
  s_lshl_b32 s13, s13, 9
  s_lshr_b32 s14, s42, 15
  s_lshl_b32 s14, s14, 9
  v_bfe_u32 v0, v0, 3, 2
  v_lshl_add_u32 v0, v0, 2, v9
  v_add_u32 v0, s60, v0
  s_cmp_eq_u32 s6, 0
  s_cselect_b32 s70, -1, 0
  s_mov_b32 s71, 0
  s_mov_b32 s28, 0x00400000
  s_mov_b32 s29, 0x00404000
  s_mov_b32 s30, 0x00408000
  s_mov_b32 s31, 0x0040c000
  s_mov_b32 s32, 0x00410000
  s_mov_b32 s33, 0x00414000
  s_mov_b32 s34, 0x00418000
  s_mov_b32 s35, 0x0041c000
P_s0chk:
  s_waitcnt vmcnt(5)
  v_cmp_ne_u64 vcc, s[72:73], v[178:179]
  v_cmp_ne_u64 s[84:85], s[72:73], v[190:191]
  s_or_b64 vcc, vcc, s[84:85]
  v_cmp_ne_u64 s[84:85], s[72:73], v[194:195]
  s_or_b64 vcc, vcc, s[84:85]
  v_cmp_ne_u64 s[84:85], s[72:73], v[198:199]
  s_or_b64 vcc, vcc, s[84:85]
  v_xor_b32_dpp v32, v168, v168 quad_perm:[2,3,0,1] row_mask:0xf bank_mask:0xf
  v_xor_b32_dpp v33, v169, v169 quad_perm:[2,3,0,1] row_mask:0xf bank_mask:0xf
  v_xor_b32_dpp v34, v170, v170 quad_perm:[2,3,0,1] row_mask:0xf bank_mask:0xf
  v_xor_b32_dpp v35, v171, v171 quad_perm:[2,3,0,1] row_mask:0xf bank_mask:0xf
  v_cmp_ne_u64 s[84:85], s[78:79], v[32:33]
  s_or_b64 vcc, vcc, s[84:85]
  v_cmp_ne_u64 s[84:85], s[78:79], v[34:35]
  s_or_b64 vcc, vcc, s[84:85]
  v_xor_b32_dpp v32, v172, v172 quad_perm:[2,3,0,1] row_mask:0xf bank_mask:0xf
  v_xor_b32_dpp v33, v173, v173 quad_perm:[2,3,0,1] row_mask:0xf bank_mask:0xf
  v_xor_b32_dpp v34, v174, v174 quad_perm:[2,3,0,1] row_mask:0xf bank_mask:0xf
  v_xor_b32_dpp v35, v175, v175 quad_perm:[2,3,0,1] row_mask:0xf bank_mask:0xf
  v_cmp_ne_u64 s[84:85], s[78:79], v[32:33]
  s_or_b64 vcc, vcc, s[84:85]
  v_cmp_ne_u64 s[84:85], s[78:79], v[34:35]
  s_or_b64 vcc, vcc, s[84:85]
  v_xor_b32_dpp v32, v180, v180 quad_perm:[2,3,0,1] row_mask:0xf bank_mask:0xf
  v_xor_b32_dpp v33, v181, v181 quad_perm:[2,3,0,1] row_mask:0xf bank_mask:0xf
  v_xor_b32_dpp v34, v182, v182 quad_perm:[2,3,0,1] row_mask:0xf bank_mask:0xf
  v_xor_b32_dpp v35, v183, v183 quad_perm:[2,3,0,1] row_mask:0xf bank_mask:0xf
  v_cmp_ne_u64 s[84:85], s[78:79], v[32:33]
  s_or_b64 vcc, vcc, s[84:85]
  v_cmp_ne_u64 s[84:85], s[78:79], v[34:35]
  s_or_b64 vcc, vcc, s[84:85]
  v_xor_b32_dpp v32, v184, v184 quad_perm:[2,3,0,1] row_mask:0xf bank_mask:0xf
  v_xor_b32_dpp v33, v185, v185 quad_perm:[2,3,0,1] row_mask:0xf bank_mask:0xf
  v_xor_b32_dpp v34, v186, v186 quad_perm:[2,3,0,1] row_mask:0xf bank_mask:0xf
  v_xor_b32_dpp v35, v187, v187 quad_perm:[2,3,0,1] row_mask:0xf bank_mask:0xf
  v_cmp_ne_u64 s[84:85], s[78:79], v[32:33]
  s_or_b64 vcc, vcc, s[84:85]
  v_cmp_ne_u64 s[84:85], s[78:79], v[34:35]
  s_or_b64 vcc, vcc, s[84:85]
  s_and_b64 vcc, vcc, s[56:57]
  s_cbranch_scc1 P_s0retry
  v_cndmask_b32 v168, v168, v180, s[64:65]
  v_cndmask_b32 v169, v169, v181, s[64:65]
  v_cndmask_b32 v170, v170, v182, s[64:65]
  v_cndmask_b32 v171, v171, v183, s[64:65]
  v_cndmask_b32 v172, v172, v184, s[64:65]
  v_cndmask_b32 v173, v173, v185, s[64:65]
  v_cndmask_b32 v174, v174, v186, s[64:65]
  v_cndmask_b32 v175, v175, v187, s[64:65]
  v_and_b32 v41, 0xffff0000, v176
  v_lshlrev_b32 v40, 16, v176
  v_and_b32 v43, 0xffff0000, v177
  v_lshlrev_b32 v42, 16, v177
  v_and_b32 v45, 0xffff0000, v188
  v_lshlrev_b32 v44, 16, v188
  v_and_b32 v47, 0xffff0000, v189
  v_lshlrev_b32 v46, 16, v189
  v_rcp_f32 v41, v41
  v_rcp_f32 v43, v43
  v_rcp_f32 v45, v45
  v_rcp_f32 v47, v47
  v_and_b32 v65, 0xffff0000, v168
  v_lshlrev_b32 v64, 16, v168
  v_and_b32 v67, 0xffff0000, v169
  v_lshlrev_b32 v66, 16, v169
  v_and_b32 v69, 0xffff0000, v170
  v_lshlrev_b32 v68, 16, v170
  v_and_b32 v71, 0xffff0000, v171
  v_lshlrev_b32 v70, 16, v171
  v_subrev_f32_dpp v32, v40, v64 quad_perm:[0,0,2,2] row_mask:0xf bank_mask:0xf
  v_subrev_f32_dpp v33, v42, v65 quad_perm:[0,0,2,2] row_mask:0xf bank_mask:0xf
  v_subrev_f32_dpp v34, v44, v66 quad_perm:[0,0,2,2] row_mask:0xf bank_mask:0xf
  v_subrev_f32_dpp v35, v46, v67 quad_perm:[0,0,2,2] row_mask:0xf bank_mask:0xf
  v_subrev_f32_dpp v36, v40, v68 quad_perm:[1,1,3,3] row_mask:0xf bank_mask:0xf
  v_subrev_f32_dpp v37, v42, v69 quad_perm:[1,1,3,3] row_mask:0xf bank_mask:0xf
  v_subrev_f32_dpp v38, v44, v70 quad_perm:[1,1,3,3] row_mask:0xf bank_mask:0xf
  v_subrev_f32_dpp v39, v46, v71 quad_perm:[1,1,3,3] row_mask:0xf bank_mask:0xf
  v_cvt_pk_bf16_f32 v32, 0, v32
  v_cvt_pk_bf16_f32 v33, 0, v33
  v_cvt_pk_bf16_f32 v34, 0, v34
  v_cvt_pk_bf16_f32 v35, 0, v35
  v_cvt_pk_bf16_f32 v36, 0, v36
  v_cvt_pk_bf16_f32 v37, 0, v37
  v_cvt_pk_bf16_f32 v38, 0, v38
  v_cvt_pk_bf16_f32 v39, 0, v39
  v_mul_f32_dpp v32, v41, v32 quad_perm:[0,0,2,2] row_mask:0xf bank_mask:0xf
  v_mul_f32_dpp v33, v43, v33 quad_perm:[0,0,2,2] row_mask:0xf bank_mask:0xf
  v_mul_f32_dpp v34, v45, v34 quad_perm:[0,0,2,2] row_mask:0xf bank_mask:0xf
  v_mul_f32_dpp v35, v47, v35 quad_perm:[0,0,2,2] row_mask:0xf bank_mask:0xf
  v_mul_f32_dpp v36, v41, v36 quad_perm:[1,1,3,3] row_mask:0xf bank_mask:0xf
  v_mul_f32_dpp v37, v43, v37 quad_perm:[1,1,3,3] row_mask:0xf bank_mask:0xf
  v_mul_f32_dpp v38, v45, v38 quad_perm:[1,1,3,3] row_mask:0xf bank_mask:0xf
  v_mul_f32_dpp v39, v47, v39 quad_perm:[1,1,3,3] row_mask:0xf bank_mask:0xf
  v_cvt_pk_bf16_f32 v80, v32, v33
  v_cvt_pk_bf16_f32 v81, v34, v35
  v_cvt_pk_bf16_f32 v82, v36, v37
  v_cvt_pk_bf16_f32 v83, v38, v39
  ds_write_b128 v6, v[80:83] offset:0
  s_waitcnt lgkmcnt(0)
  s_barrier
  ds_read_b64 v[100:101], v1 offset:3776
  ds_read_b64 v[102:103], v1 offset:3784
  ds_read_b128 v[104:107], v2 offset:1728
  ds_read_b128 v[108:111], v2 offset:1216
  ds_read_b64 v[112:113], v1 offset:3264
  ds_read_b64 v[114:115], v1 offset:3272
  ds_read_b128 v[116:119], v2 offset:704
  ds_read_b64 v[120:121], v1 offset:2752
  ds_read_b64 v[122:123], v1 offset:2760
  s_waitcnt lgkmcnt(6)
  v_mfma_f32_16x16x32_bf16 v[44:47], v[100:103], v[104:107], 0
  ds_read_b128 v[124:127], v2 offset:192
  ds_read_b64 v[128:129], v1 offset:2240
  v_and_b32 v73, 0xffff0000, v80
  s_waitcnt lgkmcnt(7)
  v_mfma_f32_16x16x32_bf16 v[40:43], v[100:103], v[108:111], 0
  ds_read_b64 v[130:131], v1 offset:2248
  ds_read_b64 v[132:133], v1 offset:3712
  s_waitcnt lgkmcnt(7)
  v_mfma_f32_16x16x32_bf16 v[44:47], v[112:115], v[108:111], v[44:47]
  ds_read_b64 v[134:135], v1 offset:3720
  ds_read_b128 v[136:139], v2 offset:1664
  v_lshlrev_b32 v72, 16, v80
  s_waitcnt lgkmcnt(5)
  v_mfma_f32_16x16x32_bf16 v[36:39], v[100:103], v[116:119], 0
  ds_read_b128 v[156:159], v2 offset:1152
  ds_read_b64 v[160:161], v1 offset:3200
  v_mfma_f32_16x16x32_bf16 v[40:43], v[112:115], v[116:119], v[40:43]
  ds_read_b64 v[162:163], v1 offset:3208
  ds_read_b128 v[164:167], v2 offset:640
  v_and_b32 v75, 0xffff0000, v81
  v_mfma_f32_16x16x32_bf16 v[44:47], v[120:123], v[116:119], v[44:47]
  ds_read_b64 v[104:105], v1 offset:2688
  ds_read_b64 v[106:107], v1 offset:2696
  v_lshlrev_b32 v74, 16, v81
  v_mfma_f32_16x16x32_bf16 v[32:35], v[100:103], v[124:127], 0
  ds_read_b128 v[108:111], v2 offset:128
  ds_read_b64 v[116:117], v1 offset:2176
  v_mfma_f32_16x16x32_bf16 v[36:39], v[112:115], v[124:127], v[36:39]
  v_and_b32 v77, 0xffff0000, v82
  s_waitcnt lgkmcnt(7)
  v_mfma_f32_16x16x32_bf16 v[44:47], v[128:131], v[124:127], v[44:47]
  ds_read_b64 v[118:119], v1 offset:2184
  ds_read_b64 v[100:101], v1 offset:3648
  v_mfma_f32_16x16x32_bf16 v[40:43], v[120:123], v[124:127], v[40:43]
  ds_read_b64 v[102:103], v1 offset:3656
  ds_read_b128 v[112:115], v2 offset:1600
  v_lshlrev_b32 v76, 16, v82
  v_mfma_f32_16x16x32_bf16 v[44:47], v[132:135], v[136:139], v[44:47]
  ds_read_b128 v[128:131], v2 offset:1088
  ds_read_b64 v[120:121], v1 offset:3136
  v_and_b32 v79, 0xffff0000, v83
  v_mfma_f32_16x16x32_bf16 v[40:43], v[132:135], v[156:159], v[40:43]
  s_waitcnt lgkmcnt(8)
  v_mfma_f32_16x16x32_bf16 v[44:47], v[160:163], v[156:159], v[44:47]
  ds_read_b64 v[122:123], v1 offset:3144
  ds_read_b128 v[124:127], v2 offset:576
  v_lshlrev_b32 v78, 16, v83
  v_mfma_f32_16x16x32_bf16 v[36:39], v[132:135], v[164:167], v[36:39]
  ds_read_b64 v[136:137], v1 offset:2624
  ds_read_b64 v[138:139], v1 offset:2632
  v_mfma_f32_16x16x32_bf16 v[40:43], v[160:163], v[164:167], v[40:43]
  v_mul_f32 v72, v12, v72
  v_mfma_f32_16x16x32_bf16 v[44:47], v[104:107], v[164:167], v[44:47]
  v_mul_f32 v73, v12, v73
  s_waitcnt lgkmcnt(9)
  v_mfma_f32_16x16x32_bf16 v[32:35], v[132:135], v[108:111], v[32:35]
  ds_read_b128 v[156:159], v2 offset:64
  ds_read_b64 v[164:165], v1 offset:2112
  v_mfma_f32_16x16x32_bf16 v[36:39], v[160:163], v[108:111], v[36:39]
  ds_read_b64 v[166:167], v1 offset:2120
  ds_read_b64 v[132:133], v1 offset:3584
  v_mul_f32 v74, v12, v74
  v_mfma_f32_16x16x32_bf16 v[44:47], v[116:119], v[108:111], v[44:47]
  v_mfma_f32_16x16x32_bf16 v[40:43], v[104:107], v[108:111], v[40:43]
  v_mul_f32 v75, v12, v75
  s_add_u32 s97, s43, 0x00434000
  buffer_store_dwordx4 v[200:203], v9, s[20:23], s97 offen sc1
  s_waitcnt lgkmcnt(6)
  v_mfma_f32_16x16x32_bf16 v[44:47], v[100:103], v[112:115], v[44:47]
  ds_read_b64 v[134:135], v1 offset:3592
  ds_read_b128 v[160:163], v2 offset:1536
  v_mul_f32 v76, v12, v76
  v_mov_b32 v142, s72
  v_mov_b32 v143, s73
  s_waitcnt vmcnt(1)
  s_mov_b64 exec, 1
  buffer_store_dwordx2 v[142:143], off, s[8:11], s99 sc1
  s_mov_b64 exec, -1
  v_mfma_f32_16x16x32_bf16 v[40:43], v[100:103], v[128:131], v[40:43]
  ds_read_b128 v[116:119], v2 offset:1024
  ds_read_b64 v[104:105], v1 offset:3072
  v_mfma_f32_16x16x32_bf16 v[44:47], v[120:123], v[128:131], v[44:47]
  ds_read_b64 v[106:107], v1 offset:3080
  ds_read_b128 v[108:111], v2 offset:512
  v_mul_f32 v77, v12, v77
  v_mfma_f32_16x16x32_bf16 v[36:39], v[100:103], v[124:127], v[36:39]
  v_mfma_f32_16x16x32_bf16 v[40:43], v[120:123], v[124:127], v[40:43]
  v_mul_f32 v78, v12, v78
  s_waitcnt lgkmcnt(7)
  v_mfma_f32_16x16x32_bf16 v[44:47], v[136:139], v[124:127], v[44:47]
  ds_read_b64 v[112:113], v1 offset:2560
  ds_read_b64 v[114:115], v1 offset:2568
  v_mul_f32 v79, v12, v79
  v_mfma_f32_16x16x32_bf16 v[32:35], v[100:103], v[156:159], v[32:35]
  ds_read_b128 v[128:131], v2 offset:0
  ds_read_b64 v[124:125], v1 offset:2048
  v_mfma_f32_16x16x32_bf16 v[36:39], v[120:123], v[156:159], v[36:39]
  ds_read_b64 v[126:127], v1 offset:2056
  ds_read_b64 v[100:101], v1 offset:3264
  v_cvt_pk_bf16_f32 v72, 0, v72
  v_mfma_f32_16x16x32_bf16 v[44:47], v[164:167], v[156:159], v[44:47]
  v_mfma_f32_16x16x32_bf16 v[40:43], v[136:139], v[156:159], v[40:43]
  v_cvt_pk_bf16_f32 v73, 0, v73
  s_add_u32 s97, s44, 0x00434000
  buffer_store_dwordx4 v[200:203], v9, s[20:23], s97 offen sc1
  s_waitcnt lgkmcnt(6)
  v_mfma_f32_16x16x32_bf16 v[44:47], v[132:135], v[160:163], v[44:47]
  ds_read_b64 v[102:103], v1 offset:3272
  ds_read_b128 v[120:123], v2 offset:1728
  v_cvt_pk_bf16_f32 v74, 0, v74
  v_mfma_f32_16x16x32_bf16 v[40:43], v[132:135], v[116:119], v[40:43]
  ds_read_b64 v[164:165], v1 offset:2752
  ds_read_b64 v[166:167], v1 offset:2760
  v_mfma_f32_16x16x32_bf16 v[44:47], v[104:107], v[116:119], v[44:47]
  ds_read_b128 v[136:139], v2 offset:1216
  ds_read_b64 v[156:157], v1 offset:2240
  v_cvt_pk_bf16_f32 v75, 0, v75
  v_mfma_f32_16x16x32_bf16 v[36:39], v[132:135], v[108:111], v[36:39]
  v_mfma_f32_16x16x32_bf16 v[40:43], v[104:107], v[108:111], v[40:43]
  v_cvt_pk_bf16_f32 v76, 0, v76
  s_waitcnt lgkmcnt(7)
  v_mfma_f32_16x16x32_bf16 v[44:47], v[112:115], v[108:111], v[44:47]
  ds_read_b64 v[158:159], v1 offset:2248
  ds_read_b128 v[160:163], v2 offset:704
  v_cvt_pk_bf16_f32 v77, 0, v77
  v_mfma_f32_16x16x32_bf16 v[32:35], v[132:135], v[128:131], v[32:35]
  ds_read_b64 v[116:117], v1 offset:1728
  ds_read_b64 v[118:119], v1 offset:1736
  v_mfma_f32_16x16x32_bf16 v[36:39], v[104:107], v[128:131], v[36:39]
  ds_read_b128 v[108:111], v2 offset:192
  ds_read_b64 v[132:133], v1 offset:1216
  v_cvt_pk_bf16_f32 v78, 0, v78
  v_mfma_f32_16x16x32_bf16 v[44:47], v[124:127], v[128:131], v[44:47]
  v_mfma_f32_16x16x32_bf16 v[40:43], v[112:115], v[128:131], v[40:43]
  v_cvt_pk_bf16_f32 v79, 0, v79
  s_waitcnt lgkmcnt(5)
  v_mfma_f32_16x16x32_bf16 v[48:51], v[100:103], v[120:123], 0
  ds_read_b64 v[134:135], v1 offset:1224
  ds_read_b64 v[104:105], v1 offset:704
  s_add_u32 s97, s45, 0x00434000
  buffer_store_dwordx4 v[200:203], v9, s[24:27], s97 offen sc1
  v_mfma_f32_16x16x32_bf16 v[52:55], v[164:167], v[120:123], 0
  ds_read_b64 v[106:107], v1 offset:712
  ds_read_b64 v[124:125], v1 offset:192
  v_mfma_f32_16x16x32_bf16 v[48:51], v[164:167], v[136:139], v[48:51]
  ds_read_b64 v[126:127], v1 offset:200
  ds_read_b64 v[112:113], v1 offset:3200
  ds_write_b128 v7, v[32:35] offset:0
  v_mfma_f32_16x16x32_bf16 v[56:59], v[156:159], v[120:123], 0
  ds_write_b128 v7, v[36:39] offset:1280
  v_mfma_f32_16x16x32_bf16 v[52:55], v[156:159], v[136:139], v[52:55]
  ds_write_b128 v7, v[44:47] offset:3840
  s_waitcnt lgkmcnt(11)
  v_mfma_f32_16x16x32_bf16 v[48:51], v[156:159], v[160:163], v[48:51]
  ds_read_b64 v[114:115], v1 offset:3208
  ds_read_b128 v[128:131], v2 offset:1664
  ds_write_b128 v7, v[40:43] offset:2560
  v_mfma_f32_16x16x32_bf16 v[60:63], v[116:119], v[120:123], 0
  v_mfma_f32_16x16x32_bf16 v[56:59], v[116:119], v[136:139], v[56:59]
  s_waitcnt lgkmcnt(0)
  s_barrier
  ds_read_b128 v[32:35], v8 offset:0
  ds_read_b128 v[36:39], v8 offset:16
  ds_read_b128 v[40:43], v8 offset:5120
  ds_read_b128 v[44:47], v8 offset:5136
  v_mfma_f32_16x16x32_bf16 v[52:55], v[116:119], v[160:163], v[52:55]
  ds_read_b64 v[100:101], v1 offset:2688
  ds_read_b64 v[102:103], v1 offset:2696
  v_mfma_f32_16x16x32_bf16 v[48:51], v[116:119], v[108:111], v[48:51]
  ds_read_b128 v[164:167], v2 offset:1152
  ds_read_b64 v[156:157], v1 offset:2176
  v_mfma_f32_16x16x32_bf16 v[60:63], v[132:135], v[136:139], v[60:63]
  ds_read_b64 v[158:159], v1 offset:2184
  ds_read_b128 v[120:123], v2 offset:640
  s_add_u32 s97, s58, 0x00200000
  buffer_store_dwordx4 v[200:203], v16, s[8:11], s97 offen sc1
  v_mfma_f32_16x16x32_bf16 v[56:59], v[132:135], v[160:163], v[56:59]
  ds_read_b64 v[116:117], v1 offset:1664
  ds_read_b64 v[118:119], v1 offset:1672
  s_waitcnt lgkmcnt(8)
  v_add_f32 v32, v32, v40
  v_add_f32 v33, v33, v41
  v_mfma_f32_16x16x32_bf16 v[52:55], v[132:135], v[108:111], v[52:55]
  ds_read_b128 v[136:139], v2 offset:128
  ds_read_b64 v[132:133], v1 offset:1152
  v_add_f32 v34, v34, v42
  v_add_f32 v35, v35, v43
  v_add_f32 v36, v36, v44
  v_mfma_f32_16x16x32_bf16 v[60:63], v[104:107], v[160:163], v[60:63]
  ds_read_b64 v[134:135], v1 offset:1160
  ds_read_b64 v[160:161], v1 offset:640
  v_add_f32 v37, v37, v45
  v_add_f32 v38, v38, v46
  v_add_f32 v39, v39, v47
  v_mfma_f32_16x16x32_bf16 v[56:59], v[104:107], v[108:111], v[56:59]
  v_cvt_pk_bf16_f32 v32, 0, v32
  v_cvt_pk_bf16_f32 v33, 0, v33
  v_cvt_pk_bf16_f32 v34, 0, v34
  v_mfma_f32_16x16x32_bf16 v[60:63], v[124:127], v[108:111], v[60:63]
  v_cvt_pk_bf16_f32 v35, 0, v35
  v_cvt_pk_bf16_f32 v36, 0, v36
  v_cvt_pk_bf16_f32 v37, 0, v37
  v_mfma_f32_16x16x32_bf16 v[48:51], v[112:115], v[128:131], v[48:51]
  v_cvt_pk_bf16_f32 v38, 0, v38
  v_cvt_pk_bf16_f32 v39, 0, v39
  v_add_f32 v32, v32, v72
  s_waitcnt lgkmcnt(7)
  v_mfma_f32_16x16x32_bf16 v[52:55], v[100:103], v[128:131], v[52:55]
  ds_read_b64 v[162:163], v1 offset:648
  ds_read_b64 v[104:105], v1 offset:128
  v_add_f32 v33, v33, v73
  v_add_f32 v34, v34, v74
  v_add_f32 v35, v35, v75
  v_mfma_f32_16x16x32_bf16 v[48:51], v[100:103], v[164:167], v[48:51]
  ds_read_b64 v[106:107], v1 offset:136
  ds_read_b64 v[124:125], v1 offset:3136
  v_add_f32 v36, v36, v76
  v_add_f32 v37, v37, v77
  v_add_f32 v38, v38, v78
  v_mfma_f32_16x16x32_bf16 v[56:59], v[156:159], v[128:131], v[56:59]
  ds_read_b64 v[126:127], v1 offset:3144
  ds_read_b128 v[108:111], v2 offset:1600
  v_add_f32 v39, v39, v79
  v_cvt_pk_bf16_f32 v32, 0, v32
  v_mfma_f32_16x16x32_bf16 v[52:55], v[156:159], v[164:167], v[52:55]
  v_cvt_pk_bf16_f32 v33, 0, v33
  v_cvt_pk_bf16_f32 v34, 0, v34
  v_cvt_pk_bf16_f32 v35, 0, v35
  s_waitcnt lgkmcnt(10)
  v_mfma_f32_16x16x32_bf16 v[48:51], v[156:159], v[120:123], v[48:51]
  ds_read_b64 v[112:113], v1 offset:2624
  ds_read_b64 v[114:115], v1 offset:2632
  v_cvt_pk_bf16_f32 v36, 0, v36
  v_cvt_pk_bf16_f32 v37, 0, v37
  v_cvt_pk_bf16_f32 v38, 0, v38
  v_mfma_f32_16x16x32_bf16 v[60:63], v[116:119], v[128:131], v[60:63]
  v_cvt_pk_bf16_f32 v39, 0, v39
  v_add_f32 v32, v32, v64
  v_add_f32 v33, v33, v65
  v_mfma_f32_16x16x32_bf16 v[56:59], v[116:119], v[164:167], v[56:59]
  v_add_f32 v34, v34, v66
  v_add_f32 v35, v35, v67
  v_add_f32 v36, v36, v68
  v_mfma_f32_16x16x32_bf16 v[52:55], v[116:119], v[120:123], v[52:55]
  v_add_f32 v37, v37, v69
  v_add_f32 v38, v38, v70
  v_add_f32 v39, v39, v71
  s_waitcnt lgkmcnt(9)
  v_mfma_f32_16x16x32_bf16 v[48:51], v[116:119], v[136:139], v[48:51]
  ds_read_b128 v[100:103], v2 offset:1088
  ds_read_b64 v[156:157], v1 offset:2112
  v_cvt_pk_bf16_f32 v80, v32, v33
  v_cvt_pk_bf16_f32 v81, v34, v35
  v_cvt_pk_bf16_f32 v82, v36, v37
  v_mfma_f32_16x16x32_bf16 v[60:63], v[132:135], v[164:167], v[60:63]
  ds_read_b64 v[158:159], v1 offset:2120
  ds_read_b128 v[128:131], v2 offset:576
  v_cvt_pk_bf16_f32 v83, v38, v39
  s_add_u32 s98, s36, 0x00000000
  buffer_store_dwordx4 v[80:83], v3, s[8:11], s98 offen sc1
  v_mfma_f32_16x16x32_bf16 v[56:59], v[132:135], v[120:123], v[56:59]
  v_mfma_f32_16x16x32_bf16 v[52:55], v[132:135], v[136:139], v[52:55]
  s_waitcnt lgkmcnt(6)
  v_mfma_f32_16x16x32_bf16 v[60:63], v[160:163], v[120:123], v[60:63]
  ds_read_b64 v[116:117], v1 offset:1600
  ds_read_b64 v[118:119], v1 offset:1608
  v_mfma_f32_16x16x32_bf16 v[56:59], v[160:163], v[136:139], v[56:59]
  ds_read_b128 v[164:167], v2 offset:64
  ds_read_b64 v[132:133], v1 offset:1088
  s_mov_b32 s3, 0x01440000
  buffer_load_dwordx2 v[140:141], v20, s[8:11], s3 offen sc1
  v_mfma_f32_16x16x32_bf16 v[60:63], v[104:107], v[136:139], v[60:63]
  ds_read_b64 v[134:135], v1 offset:1096
  ds_read_b64 v[120:121], v1 offset:576
  v_mfma_f32_16x16x32_bf16 v[48:51], v[124:127], v[108:111], v[48:51]
  s_waitcnt lgkmcnt(7)
  v_mfma_f32_16x16x32_bf16 v[52:55], v[112:115], v[108:111], v[52:55]
  ds_read_b64 v[122:123], v1 offset:584
  ds_read_b64 v[160:161], v1 offset:64
  v_mfma_f32_16x16x32_bf16 v[48:51], v[112:115], v[100:103], v[48:51]
  ds_read_b64 v[162:163], v1 offset:72
  ds_read_b64 v[104:105], v1 offset:3072
  v_mfma_f32_16x16x32_bf16 v[56:59], v[156:159], v[108:111], v[56:59]
  ds_read_b64 v[106:107], v1 offset:3080
  ds_read_b128 v[136:139], v2 offset:1536
  v_mfma_f32_16x16x32_bf16 v[52:55], v[156:159], v[100:103], v[52:55]
  s_waitcnt lgkmcnt(10)
  v_mfma_f32_16x16x32_bf16 v[48:51], v[156:159], v[128:131], v[48:51]
  ds_read_b64 v[124:125], v1 offset:2560
  ds_read_b64 v[126:127], v1 offset:2568
  v_mfma_f32_16x16x32_bf16 v[60:63], v[116:119], v[108:111], v[60:63]
  v_mfma_f32_16x16x32_bf16 v[56:59], v[116:119], v[100:103], v[56:59]
  v_mfma_f32_16x16x32_bf16 v[52:55], v[116:119], v[128:131], v[52:55]
  s_waitcnt lgkmcnt(9)
  v_mfma_f32_16x16x32_bf16 v[48:51], v[116:119], v[164:167], v[48:51]
  ds_read_b128 v[112:115], v2 offset:1024
  ds_read_b64 v[156:157], v1 offset:2048
  v_mfma_f32_16x16x32_bf16 v[60:63], v[132:135], v[100:103], v[60:63]
  ds_read_b64 v[158:159], v1 offset:2056
  ds_read_b128 v[108:111], v2 offset:512
  v_mfma_f32_16x16x32_bf16 v[56:59], v[132:135], v[128:131], v[56:59]
  v_mfma_f32_16x16x32_bf16 v[52:55], v[132:135], v[164:167], v[52:55]
  s_waitcnt lgkmcnt(6)
  v_mfma_f32_16x16x32_bf16 v[60:63], v[120:123], v[128:131], v[60:63]
  ds_read_b64 v[116:117], v1 offset:1536
  ds_read_b64 v[118:119], v1 offset:1544
  v_mfma_f32_16x16x32_bf16 v[56:59], v[120:123], v[164:167], v[56:59]
  ds_read_b128 v[100:103], v2 offset:0
  ds_read_b64 v[132:133], v1 offset:1024
  v_mfma_f32_16x16x32_bf16 v[60:63], v[160:163], v[164:167], v[60:63]
  ds_read_b64 v[134:135], v1 offset:1032
  ds_read_b64 v[128:129], v1 offset:512
  v_mfma_f32_16x16x32_bf16 v[48:51], v[104:107], v[136:139], v[48:51]
  s_waitcnt lgkmcnt(7)
  v_mfma_f32_16x16x32_bf16 v[52:55], v[124:127], v[136:139], v[52:55]
  ds_read_b64 v[130:131], v1 offset:520
  ds_read_b64 v[120:121], v1 offset:0
  v_mfma_f32_16x16x32_bf16 v[48:51], v[124:127], v[112:115], v[48:51]
  ds_read_b64 v[122:123], v1 offset:8
  v_mfma_f32_16x16x32_bf16 v[56:59], v[156:159], v[136:139], v[56:59]
  v_mfma_f32_16x16x32_bf16 v[52:55], v[156:159], v[112:115], v[52:55]
  s_waitcnt lgkmcnt(7)
  v_mfma_f32_16x16x32_bf16 v[48:51], v[156:159], v[108:111], v[48:51]
  v_mfma_f32_16x16x32_bf16 v[60:63], v[116:119], v[136:139], v[60:63]
  v_mfma_f32_16x16x32_bf16 v[56:59], v[116:119], v[112:115], v[56:59]
  s_waitcnt vmcnt(0)
F_chk0:
  v_cmp_ne_u64 vcc, s[72:73], v[140:141]
  s_and_b32 vcc_lo, vcc_lo, 0xff
  s_and_b32 vcc_lo, vcc_lo, s56
  s_cbranch_scc1 F_retry0
  v_mfma_f32_16x16x32_bf16 v[52:55], v[116:119], v[108:111], v[52:55]
  s_waitcnt lgkmcnt(4)
  v_mfma_f32_16x16x32_bf16 v[48:51], v[116:119], v[100:103], v[48:51]
  s_add_u32 s95, s61, s66
  buffer_load_dwordx4 a[176:179], v9, s[8:11], s95 offen offset:0 sc1
  v_mfma_f32_16x16x32_bf16 v[60:63], v[132:135], v[112:115], v[60:63]
  buffer_load_dwordx4 a[180:183], v9, s[8:11], s95 offen offset:1024 sc1
  v_mfma_f32_16x16x32_bf16 v[56:59], v[132:135], v[108:111], v[56:59]
  v_mfma_f32_16x16x32_bf16 v[52:55], v[132:135], v[100:103], v[52:55]
  s_waitcnt lgkmcnt(0)
  v_mfma_f32_16x16x32_bf16 v[60:63], v[128:131], v[108:111], v[60:63]
  buffer_load_dwordx4 a[184:187], v9, s[8:11], s95 offen offset:2048 sc1
  v_mfma_f32_16x16x32_bf16 v[56:59], v[128:131], v[100:103], v[56:59]
  buffer_load_dwordx4 a[188:191], v9, s[8:11], s95 offen offset:3072 sc1
  v_mfma_f32_16x16x32_bf16 v[60:63], v[120:123], v[100:103], v[60:63]
  v_and_b32 v41, 0xffff0000, v192
  v_lshlrev_b32 v40, 16, v192
  v_and_b32 v43, 0xffff0000, v193
  v_lshlrev_b32 v42, 16, v193
  v_and_b32 v45, 0xffff0000, v196
  v_lshlrev_b32 v44, 16, v196
  v_and_b32 v47, 0xffff0000, v197
  v_lshlrev_b32 v46, 16, v197
  v_rcp_f32 v41, v41
  v_rcp_f32 v43, v43
  v_rcp_f32 v45, v45
  s_add_u32 s95, s95, 4096
  buffer_load_dwordx4 a[192:195], v9, s[8:11], s95 offen offset:0 sc1
  v_rcp_f32 v47, v47
  v_and_b32 v65, 0xffff0000, v172
  v_lshlrev_b32 v64, 16, v172
  v_and_b32 v67, 0xffff0000, v173
  v_lshlrev_b32 v66, 16, v173
  v_and_b32 v69, 0xffff0000, v174
  v_lshlrev_b32 v68, 16, v174
  buffer_load_dwordx4 a[196:199], v9, s[8:11], s95 offen offset:1024 sc1
  v_and_b32 v71, 0xffff0000, v175
  v_lshlrev_b32 v70, 16, v175
  v_subrev_f32_dpp v32, v40, v64 quad_perm:[0,0,2,2] row_mask:0xf bank_mask:0xf
  v_subrev_f32_dpp v33, v42, v65 quad_perm:[0,0,2,2] row_mask:0xf bank_mask:0xf
  v_subrev_f32_dpp v34, v44, v66 quad_perm:[0,0,2,2] row_mask:0xf bank_mask:0xf
  v_subrev_f32_dpp v35, v46, v67 quad_perm:[0,0,2,2] row_mask:0xf bank_mask:0xf
  v_subrev_f32_dpp v36, v40, v68 quad_perm:[1,1,3,3] row_mask:0xf bank_mask:0xf
  buffer_load_dwordx4 a[200:203], v9, s[8:11], s95 offen offset:2048 sc1
  v_subrev_f32_dpp v37, v42, v69 quad_perm:[1,1,3,3] row_mask:0xf bank_mask:0xf
  v_subrev_f32_dpp v38, v44, v70 quad_perm:[1,1,3,3] row_mask:0xf bank_mask:0xf
  v_subrev_f32_dpp v39, v46, v71 quad_perm:[1,1,3,3] row_mask:0xf bank_mask:0xf
  v_cvt_pk_bf16_f32 v32, 0, v32
  v_cvt_pk_bf16_f32 v33, 0, v33
  v_cvt_pk_bf16_f32 v34, 0, v34
  buffer_load_dwordx4 a[204:207], v9, s[8:11], s95 offen offset:3072 sc1
  v_cvt_pk_bf16_f32 v35, 0, v35
  v_cvt_pk_bf16_f32 v36, 0, v36
  v_cvt_pk_bf16_f32 v37, 0, v37
  v_cvt_pk_bf16_f32 v38, 0, v38
  v_cvt_pk_bf16_f32 v39, 0, v39
  v_mul_f32_dpp v32, v41, v32 quad_perm:[0,0,2,2] row_mask:0xf bank_mask:0xf
  v_mul_f32_dpp v33, v43, v33 quad_perm:[0,0,2,2] row_mask:0xf bank_mask:0xf
  s_add_u32 s95, s61, s67
  buffer_load_dwordx4 a[208:211], v9, s[8:11], s95 offen offset:0 sc1
  v_mul_f32_dpp v34, v45, v34 quad_perm:[0,0,2,2] row_mask:0xf bank_mask:0xf
  v_mul_f32_dpp v35, v47, v35 quad_perm:[0,0,2,2] row_mask:0xf bank_mask:0xf
  v_mul_f32_dpp v36, v41, v36 quad_perm:[1,1,3,3] row_mask:0xf bank_mask:0xf
  v_mul_f32_dpp v37, v43, v37 quad_perm:[1,1,3,3] row_mask:0xf bank_mask:0xf
  v_mul_f32_dpp v38, v45, v38 quad_perm:[1,1,3,3] row_mask:0xf bank_mask:0xf
  v_mul_f32_dpp v39, v47, v39 quad_perm:[1,1,3,3] row_mask:0xf bank_mask:0xf
  v_cvt_pk_bf16_f32 v80, v32, v33
  buffer_load_dwordx4 a[212:215], v9, s[8:11], s95 offen offset:1024 sc1
  v_cvt_pk_bf16_f32 v81, v34, v35
  v_cvt_pk_bf16_f32 v82, v36, v37
  v_cvt_pk_bf16_f32 v83, v38, v39
  ds_write_b128 v6, v[80:83] offset:2048
  s_waitcnt lgkmcnt(0)
  s_barrier
  ds_read_b64 v[100:101], v1 offset:3776
  ds_read_b64 v[102:103], v1 offset:3784
  ds_read_b128 v[104:107], v2 offset:3776
  ds_read_b128 v[108:111], v2 offset:3264
  ds_read_b64 v[112:113], v1 offset:3264
  ds_read_b64 v[114:115], v1 offset:3272
s_branch Ia2x
Ia2:
s_branch Iar
Ia2x:
  ds_read_b128 v[116:119], v2 offset:2752
  ds_read_b64 v[120:121], v1 offset:2752
  ds_read_b64 v[122:123], v1 offset:2760
  s_waitcnt lgkmcnt(6)
  v_mfma_f32_16x16x32_bf16 v[60:63], v[100:103], v[104:107], v[60:63]
  ds_read_b128 v[124:127], v2 offset:2240
  ds_read_b64 v[128:129], v1 offset:2240
  v_and_b32 v73, 0xffff0000, v80
  buffer_load_dwordx4 a[216:219], v9, s[8:11], s95 offen offset:2048 sc1
  s_waitcnt lgkmcnt(7)
  v_mfma_f32_16x16x32_bf16 v[56:59], v[100:103], v[108:111], v[56:59]
  ds_read_b64 v[130:131], v1 offset:2248
  ds_read_b64 v[132:133], v1 offset:3712
  s_waitcnt lgkmcnt(7)
  v_mfma_f32_16x16x32_bf16 v[60:63], v[112:115], v[108:111], v[60:63]
  ds_read_b64 v[134:135], v1 offset:3720
  ds_read_b128 v[136:139], v2 offset:3712
  v_lshlrev_b32 v72, 16, v80
  buffer_load_dwordx4 a[220:223], v9, s[8:11], s95 offen offset:3072 sc1
  s_waitcnt lgkmcnt(5)
  v_mfma_f32_16x16x32_bf16 v[52:55], v[100:103], v[116:119], v[52:55]
  ds_read_b128 v[156:159], v2 offset:3200
  ds_read_b64 v[160:161], v1 offset:3200
  v_mfma_f32_16x16x32_bf16 v[56:59], v[112:115], v[116:119], v[56:59]
  ds_read_b64 v[162:163], v1 offset:3208
  ds_read_b128 v[164:167], v2 offset:2688
  v_and_b32 v75, 0xffff0000, v81
  s_add_u32 s95, s95, 4096
  buffer_load_dwordx4 a[224:227], v9, s[8:11], s95 offen offset:0 sc1
  v_mfma_f32_16x16x32_bf16 v[60:63], v[120:123], v[116:119], v[60:63]
  ds_read_b64 v[104:105], v1 offset:2688
  ds_read_b64 v[106:107], v1 offset:2696
  v_lshlrev_b32 v74, 16, v81
  buffer_load_dwordx4 a[228:231], v9, s[8:11], s95 offen offset:1024 sc1
  v_mfma_f32_16x16x32_bf16 v[48:51], v[100:103], v[124:127], v[48:51]
  ds_read_b128 v[108:111], v2 offset:2176
  ds_read_b64 v[116:117], v1 offset:2176
  v_mfma_f32_16x16x32_bf16 v[52:55], v[112:115], v[124:127], v[52:55]
  v_and_b32 v77, 0xffff0000, v82
  buffer_load_dwordx4 a[232:235], v9, s[8:11], s95 offen offset:2048 sc1
  s_waitcnt lgkmcnt(7)
  v_mfma_f32_16x16x32_bf16 v[60:63], v[128:131], v[124:127], v[60:63]
  ds_read_b64 v[118:119], v1 offset:2184
  ds_read_b64 v[100:101], v1 offset:3648
  v_mfma_f32_16x16x32_bf16 v[56:59], v[120:123], v[124:127], v[56:59]
  ds_read_b64 v[102:103], v1 offset:3656
  ds_read_b128 v[112:115], v2 offset:3648
  v_lshlrev_b32 v76, 16, v82
  buffer_load_dwordx4 a[236:239], v9, s[8:11], s95 offen offset:3072 sc1
  v_mfma_f32_16x16x32_bf16 v[60:63], v[132:135], v[136:139], v[60:63]
  ds_read_b128 v[128:131], v2 offset:3136
  ds_read_b64 v[120:121], v1 offset:3136
  v_and_b32 v79, 0xffff0000, v83
  s_add_u32 s95, s61, s68
  buffer_load_dwordx4 a[240:243], v9, s[8:11], s95 offen offset:0 sc1
  v_mfma_f32_16x16x32_bf16 v[56:59], v[132:135], v[156:159], v[56:59]
  s_waitcnt lgkmcnt(8)
  v_mfma_f32_16x16x32_bf16 v[60:63], v[160:163], v[156:159], v[60:63]
  ds_read_b64 v[122:123], v1 offset:3144
  ds_read_b128 v[124:127], v2 offset:2624
  v_lshlrev_b32 v78, 16, v83
  buffer_load_dwordx4 a[244:247], v9, s[8:11], s95 offen offset:1024 sc1
  v_mfma_f32_16x16x32_bf16 v[52:55], v[132:135], v[164:167], v[52:55]
  ds_read_b64 v[136:137], v1 offset:2624
  ds_read_b64 v[138:139], v1 offset:2632
  v_mfma_f32_16x16x32_bf16 v[56:59], v[160:163], v[164:167], v[56:59]
  v_mul_f32 v72, v12, v72
  buffer_load_dwordx4 a[248:251], v9, s[8:11], s95 offen offset:2048 sc1
  v_mfma_f32_16x16x32_bf16 v[60:63], v[104:107], v[164:167], v[60:63]
  v_mul_f32 v73, v12, v73
  buffer_load_dwordx4 a[252:255], v9, s[8:11], s95 offen offset:3072 sc1
  s_waitcnt lgkmcnt(9)
  v_mfma_f32_16x16x32_bf16 v[48:51], v[132:135], v[108:111], v[48:51]
  ds_read_b128 v[156:159], v2 offset:2112
  ds_read_b64 v[164:165], v1 offset:2112
  v_mfma_f32_16x16x32_bf16 v[52:55], v[160:163], v[108:111], v[52:55]
  ds_read_b64 v[166:167], v1 offset:2120
  ds_read_b64 v[132:133], v1 offset:3584
  v_mul_f32 v74, v12, v74
  s_add_u32 s95, s95, 4096
  buffer_load_dwordx4 v[208:211], v9, s[8:11], s95 offen offset:0 sc1
  v_mfma_f32_16x16x32_bf16 v[60:63], v[116:119], v[108:111], v[60:63]
  v_mfma_f32_16x16x32_bf16 v[56:59], v[104:107], v[108:111], v[56:59]
  v_mul_f32 v75, v12, v75
  buffer_load_dwordx4 v[212:215], v9, s[8:11], s95 offen offset:1024 sc1
  s_waitcnt lgkmcnt(6)
  v_mfma_f32_16x16x32_bf16 v[60:63], v[100:103], v[112:115], v[60:63]
  ds_read_b64 v[134:135], v1 offset:3592
  ds_read_b128 v[160:163], v2 offset:3584
  v_mul_f32 v76, v12, v76
  buffer_load_dwordx4 v[216:219], v9, s[8:11], s95 offen offset:2048 sc1
  v_mfma_f32_16x16x32_bf16 v[56:59], v[100:103], v[128:131], v[56:59]
  ds_read_b128 v[116:119], v2 offset:3072
  ds_read_b64 v[104:105], v1 offset:3072
  v_mfma_f32_16x16x32_bf16 v[60:63], v[120:123], v[128:131], v[60:63]
  ds_read_b64 v[106:107], v1 offset:3080
  ds_read_b128 v[108:111], v2 offset:2560
  v_mul_f32 v77, v12, v77
  buffer_load_dwordx4 v[220:223], v9, s[8:11], s95 offen offset:3072 sc1
  v_mfma_f32_16x16x32_bf16 v[52:55], v[100:103], v[124:127], v[52:55]
  v_mfma_f32_16x16x32_bf16 v[56:59], v[120:123], v[124:127], v[56:59]
  v_mul_f32 v78, v12, v78
  s_mov_b32 s3, 0x01440000
  buffer_load_dwordx2 v[140:141], v20, s[8:11], s3 offen sc1
  s_waitcnt lgkmcnt(7)
  v_mfma_f32_16x16x32_bf16 v[60:63], v[136:139], v[124:127], v[60:63]
  ds_read_b64 v[112:113], v1 offset:2560
  ds_read_b64 v[114:115], v1 offset:2568
  v_mul_f32 v79, v12, v79
  s_add_u32 m0, s60, 0x00000000
  s_add_u32 s89, s40, 0x00000000
  buffer_load_dwordx4 v9, s[8:11], s89 offen offset:0 sc1 lds
  v_mfma_f32_16x16x32_bf16 v[48:51], v[100:103], v[156:159], v[48:51]
  ds_read_b128 v[128:131], v2 offset:2048
  ds_read_b64 v[124:125], v1 offset:2048
  v_mfma_f32_16x16x32_bf16 v[52:55], v[120:123], v[156:159], v[52:55]
  ds_read_b64 v[126:127], v1 offset:2056
  v_cvt_pk_bf16_f32 v72, 0, v72
  buffer_load_dwordx4 v9, s[8:11], s89 offen offset:1024 sc1 lds
  v_mfma_f32_16x16x32_bf16 v[60:63], v[164:167], v[156:159], v[60:63]
  v_mfma_f32_16x16x32_bf16 v[56:59], v[136:139], v[156:159], v[56:59]
  v_cvt_pk_bf16_f32 v73, 0, v73
  buffer_load_dwordx4 v9, s[8:11], s89 offen offset:2048 sc1 lds
  s_waitcnt lgkmcnt(5)
  v_mfma_f32_16x16x32_bf16 v[60:63], v[132:135], v[160:163], v[60:63]
  v_cvt_pk_bf16_f32 v74, 0, v74
  buffer_load_dwordx4 v9, s[8:11], s89 offen offset:3072 sc1 lds
  v_mfma_f32_16x16x32_bf16 v[56:59], v[132:135], v[116:119], v[56:59]
  v_mfma_f32_16x16x32_bf16 v[60:63], v[104:107], v[116:119], v[60:63]
  v_cvt_pk_bf16_f32 v75, 0, v75
  s_add_u32 m0, s60, 0x00001000
  s_add_u32 s89, s40, 0x00001000
  buffer_load_dwordx4 v9, s[8:11], s89 offen offset:0 sc1 lds
  v_mfma_f32_16x16x32_bf16 v[52:55], v[132:135], v[108:111], v[52:55]
  v_mfma_f32_16x16x32_bf16 v[56:59], v[104:107], v[108:111], v[56:59]
  v_cvt_pk_bf16_f32 v76, 0, v76
  buffer_load_dwordx4 v9, s[8:11], s89 offen offset:1024 sc1 lds
  s_waitcnt lgkmcnt(0)
  v_mfma_f32_16x16x32_bf16 v[60:63], v[112:115], v[108:111], v[60:63]
  v_cvt_pk_bf16_f32 v77, 0, v77
  buffer_load_dwordx4 v9, s[8:11], s89 offen offset:2048 sc1 lds
  v_mfma_f32_16x16x32_bf16 v[48:51], v[132:135], v[128:131], v[48:51]
  v_mfma_f32_16x16x32_bf16 v[52:55], v[104:107], v[128:131], v[52:55]
  v_cvt_pk_bf16_f32 v78, 0, v78
  buffer_load_dwordx4 v9, s[8:11], s89 offen offset:3072 sc1 lds
  v_mfma_f32_16x16x32_bf16 v[60:63], v[124:127], v[128:131], v[60:63]
  v_mfma_f32_16x16x32_bf16 v[56:59], v[112:115], v[128:131], v[56:59]
  v_cvt_pk_bf16_f32 v79, 0, v79
  s_add_u32 m0, s60, 0x00008000
  s_add_u32 s89, s41, 0x00000000
  buffer_load_dwordx4 v9, s[8:11], s89 offen offset:0 sc1 lds
  s_nop 4
  ds_write_b128 v7, v[48:51] offset:0
  ds_write_b128 v7, v[52:55] offset:1280
  ds_write_b128 v7, v[60:63] offset:3840
  ds_write_b128 v7, v[56:59] offset:2560
  s_waitcnt lgkmcnt(0)
  s_barrier
  ds_read_b128 v[32:35], v8 offset:0
  ds_read_b128 v[36:39], v8 offset:16
  ds_read_b128 v[40:43], v8 offset:5120
  ds_read_b128 v[44:47], v8 offset:5136
  s_waitcnt lgkmcnt(0)
  v_pk_add_f32 v[32:33], v[32:33], v[40:41]
  buffer_load_dwordx4 v9, s[8:11], s89 offen offset:1024 sc1 lds
  v_pk_add_f32 v[34:35], v[34:35], v[42:43]
  v_pk_add_f32 v[36:37], v[36:37], v[44:45]
  v_pk_add_f32 v[38:39], v[38:39], v[46:47]
  v_cvt_pk_bf16_f32 v32, 0, v32
  v_cvt_pk_bf16_f32 v33, 0, v33
  buffer_load_dwordx4 v9, s[8:11], s89 offen offset:2048 sc1 lds
  v_cvt_pk_bf16_f32 v34, 0, v34
  v_cvt_pk_bf16_f32 v35, 0, v35
  v_cvt_pk_bf16_f32 v36, 0, v36
  v_cvt_pk_bf16_f32 v37, 0, v37
  buffer_load_dwordx4 v9, s[8:11], s89 offen offset:3072 sc1 lds
  v_cvt_pk_bf16_f32 v38, 0, v38
  v_cvt_pk_bf16_f32 v39, 0, v39
  v_pk_add_f32 v[32:33], v[32:33], v[72:73]
  v_pk_add_f32 v[34:35], v[34:35], v[74:75]
  v_pk_add_f32 v[36:37], v[36:37], v[76:77]
  s_add_u32 m0, s60, 0x00009000
  s_add_u32 s89, s41, 0x00001000
  buffer_load_dwordx4 v9, s[8:11], s89 offen offset:0 sc1 lds
  v_pk_add_f32 v[38:39], v[38:39], v[78:79]
  v_cvt_pk_bf16_f32 v32, 0, v32
  v_cvt_pk_bf16_f32 v33, 0, v33
  v_cvt_pk_bf16_f32 v34, 0, v34
  v_cvt_pk_bf16_f32 v35, 0, v35
  buffer_load_dwordx4 v9, s[8:11], s89 offen offset:1024 sc1 lds
  v_cvt_pk_bf16_f32 v36, 0, v36
  v_cvt_pk_bf16_f32 v37, 0, v37
  s_waitcnt vmcnt(6)
  v_cvt_pk_bf16_f32 v38, 0, v38
  ds_read_b64_tr_b16 v[84:85], v24 offset:0
  v_cvt_pk_bf16_f32 v39, 0, v39
  ds_read_b64_tr_b16 v[86:87], v24 offset:256
  buffer_load_dwordx4 v9, s[8:11], s89 offen offset:2048 sc1 lds
  ds_read_b64_tr_b16 v[88:89], v24 offset:1024
  v_pk_add_f32 v[32:33], v[32:33], v[64:65]
  ds_read_b64_tr_b16 v[90:91], v24 offset:1280
  ds_read_b64_tr_b16 v[92:93], v24 offset:2048
  v_pk_add_f32 v[34:35], v[34:35], v[66:67]
  ds_read_b64_tr_b16 v[94:95], v24 offset:2304
  v_pk_add_f32 v[36:37], v[36:37], v[68:69]
  ds_read_b64_tr_b16 v[96:97], v24 offset:3072
  v_pk_add_f32 v[38:39], v[38:39], v[70:71]
  ds_read_b64_tr_b16 v[98:99], v24 offset:3328
  v_cvt_pk_bf16_f32 v80, v32, v33
  ds_read_b64_tr_b16 v[100:101], v24 offset:4096
  buffer_load_dwordx4 v9, s[8:11], s89 offen offset:3072 sc1 lds
  ds_read_b64_tr_b16 v[102:103], v24 offset:4352
  v_cvt_pk_bf16_f32 v81, v34, v35
  ds_read_b64_tr_b16 v[104:105], v24 offset:5120
  ds_read_b64_tr_b16 v[106:107], v24 offset:5376
  v_cvt_pk_bf16_f32 v82, v36, v37
  ds_read_b64_tr_b16 v[108:109], v24 offset:6144
  v_cvt_pk_bf16_f32 v83, v38, v39
  ds_read_b64_tr_b16 v[110:111], v24 offset:6400
  s_add_u32 s98, s36, 0x00100000
  ds_read_b64_tr_b16 v[112:113], v24 offset:7168
  buffer_store_dwordx4 v[80:83], v3, s[8:11], s98 offen sc1
  ds_read_b64_tr_b16 v[114:115], v24 offset:7424
F_chk1:
  v_cmp_ne_u64 vcc, s[72:73], v[140:141]
  s_and_b64 vcc, vcc, s[56:57]
  s_cbranch_scc1 F_retry1
  s_waitcnt lgkmcnt(0)
  v_mfma_f32_4x4x4_16b_bf16 v[140:143], v[84:85], v[84:85], 0
  v_mfma_f32_4x4x4_16b_bf16 v[144:147], v[22:23], v[84:85], 0
  v_mfma_f32_4x4x4_16b_bf16 v[148:151], v[86:87], v[86:87], 0
  v_mfma_f32_4x4x4_16b_bf16 v[152:155], v[22:23], v[86:87], 0
  v_mfma_f32_4x4x4_16b_bf16 v[140:143], v[88:89], v[88:89], v[140:143]
  v_mfma_f32_4x4x4_16b_bf16 v[144:147], v[22:23], v[88:89], v[144:147]
  v_mfma_f32_4x4x4_16b_bf16 v[148:151], v[90:91], v[90:91], v[148:151]
  v_mfma_f32_4x4x4_16b_bf16 v[152:155], v[22:23], v[90:91], v[152:155]
  v_mfma_f32_4x4x4_16b_bf16 v[140:143], v[92:93], v[92:93], v[140:143]
  v_mfma_f32_4x4x4_16b_bf16 v[144:147], v[22:23], v[92:93], v[144:147]
  v_mfma_f32_4x4x4_16b_bf16 v[148:151], v[94:95], v[94:95], v[148:151]
  v_mfma_f32_4x4x4_16b_bf16 v[152:155], v[22:23], v[94:95], v[152:155]
  v_mfma_f32_4x4x4_16b_bf16 v[140:143], v[96:97], v[96:97], v[140:143]
  v_mfma_f32_4x4x4_16b_bf16 v[144:147], v[22:23], v[96:97], v[144:147]
  v_mfma_f32_4x4x4_16b_bf16 v[148:151], v[98:99], v[98:99], v[148:151]
  v_mfma_f32_4x4x4_16b_bf16 v[152:155], v[22:23], v[98:99], v[152:155]
  v_mfma_f32_4x4x4_16b_bf16 v[140:143], v[100:101], v[100:101], v[140:143]
  v_mfma_f32_4x4x4_16b_bf16 v[144:147], v[22:23], v[100:101], v[144:147]
  v_mfma_f32_4x4x4_16b_bf16 v[148:151], v[102:103], v[102:103], v[148:151]
  v_mfma_f32_4x4x4_16b_bf16 v[152:155], v[22:23], v[102:103], v[152:155]
  v_mfma_f32_4x4x4_16b_bf16 v[140:143], v[104:105], v[104:105], v[140:143]
  v_mfma_f32_4x4x4_16b_bf16 v[144:147], v[22:23], v[104:105], v[144:147]
  v_mfma_f32_4x4x4_16b_bf16 v[148:151], v[106:107], v[106:107], v[148:151]
  v_mfma_f32_4x4x4_16b_bf16 v[152:155], v[22:23], v[106:107], v[152:155]
  v_mfma_f32_4x4x4_16b_bf16 v[140:143], v[108:109], v[108:109], v[140:143]
  v_mfma_f32_4x4x4_16b_bf16 v[144:147], v[22:23], v[108:109], v[144:147]
  v_mfma_f32_4x4x4_16b_bf16 v[148:151], v[110:111], v[110:111], v[148:151]
  v_mfma_f32_4x4x4_16b_bf16 v[152:155], v[22:23], v[110:111], v[152:155]
  v_mfma_f32_4x4x4_16b_bf16 v[140:143], v[112:113], v[112:113], v[140:143]
  v_mfma_f32_4x4x4_16b_bf16 v[144:147], v[22:23], v[112:113], v[144:147]
  v_mfma_f32_4x4x4_16b_bf16 v[148:151], v[114:115], v[114:115], v[148:151]
  v_mfma_f32_4x4x4_16b_bf16 v[152:155], v[22:23], v[114:115], v[152:155]
  s_nop 4
  v_add_f32 v140, v140, v148
  v_add_f32 v141, v141, v149
  v_add_f32 v142, v142, v150
  v_add_f32 v143, v143, v151
  v_add_f32 v144, v144, v152
  v_cndmask_b32 v140, v140, v141, s[62:63]
  v_cndmask_b32 v142, v142, v143, s[62:63]
  v_cndmask_b32 v140, v140, v142, s[64:65]
  s_nop 1
  v_permlane32_swap_b32 v144, v140
  s_nop 0
  v_add_f32 v144, v144, v140
  v_cmp_u_f32 vcc, v144, v144
  s_and_b64 vcc, vcc, s[56:57]
  s_cbranch_scc1 G_r00
G_b00:
  ds_write_b32 v10, v144 offset:0
  v_and_b32 v20, 0x1ff, v9
  s_cmp_eq_u32 s22, 0
  s_cbranch_scc1 S_0
  s_waitcnt lgkmcnt(0)
  s_barrier
  v_mfma_f32_32x32x16_bf16 v[32:47], a[176:179], v[84:87], 0
  ds_read_b128 v[160:163], v11 offset:0
  ds_read_b128 v[164:167], v11 offset:16
  s_add_u32 s95, s61, s69
  buffer_load_dwordx4 v[224:227], v9, s[8:11], s95 offen offset:0 sc1
  v_mfma_f32_32x32x16_bf16 v[32:47], a[180:183], v[88:91], v[32:47]
  buffer_load_dwordx4 v[228:231], v9, s[8:11], s95 offen offset:1024 sc1
  v_mfma_f32_32x32x16_bf16 v[32:47], a[184:187], v[92:95], v[32:47]
  buffer_load_dwordx4 v[232:235], v9, s[8:11], s95 offen offset:2048 sc1
  v_mfma_f32_32x32x16_bf16 v[32:47], a[188:191], v[96:99], v[32:47]
  ds_read_b64_tr_b16 v[124:125], v25 offset:0
  ds_read_b64_tr_b16 v[126:127], v25 offset:256
  buffer_load_dwordx4 v[236:239], v9, s[8:11], s95 offen offset:3072 sc1
  s_waitcnt lgkmcnt(2)
  v_mfma_f32_32x32x16_bf16 v[32:47], a[192:195], v[100:103], v[32:47]
  ds_read_b64_tr_b16 v[128:129], v25 offset:1024
  ds_read_b64_tr_b16 v[130:131], v25 offset:1280
  s_add_u32 s95, s95, 4096
  buffer_load_dwordx4 v[240:243], v9, s[8:11], s95 offen offset:0 sc1
  v_add_f32 v160, v160, v161
  v_mfma_f32_32x32x16_bf16 v[32:47], a[196:199], v[104:107], v[32:47]
  ds_read_b64_tr_b16 v[132:133], v25 offset:2048
  ds_read_b64_tr_b16 v[134:135], v25 offset:2304
  buffer_load_dwordx4 v[244:247], v9, s[8:11], s95 offen offset:1024 sc1
  v_add_f32 v162, v162, v163
  v_mfma_f32_32x32x16_bf16 v[32:47], a[200:203], v[108:111], v[32:47]
  ds_read_b64_tr_b16 v[136:137], v25 offset:3072
  ds_read_b64_tr_b16 v[138:139], v25 offset:3328
  buffer_load_dwordx4 v[248:251], v9, s[8:11], s95 offen offset:2048 sc1
  v_add_f32 v164, v164, v165
  v_mfma_f32_32x32x16_bf16 v[32:47], a[204:207], v[112:115], v[32:47]
  ds_read_b64_tr_b16 v[116:117], v25 offset:4096
  ds_read_b64_tr_b16 v[118:119], v25 offset:4352
  buffer_load_dwordx4 v[252:255], v9, s[8:11], s95 offen offset:3072 sc1
  v_add_f32 v166, v166, v167
  s_waitcnt lgkmcnt(6)
  v_mfma_f32_32x32x16_bf16 v[32:47], a[208:211], v[124:127], v[32:47]
  ds_read_b64_tr_b16 v[120:121], v25 offset:5120
  ds_read_b64_tr_b16 v[122:123], v25 offset:5376
  s_add_u32 s95, s61, 32768
  buffer_load_dword v204, v19, s[8:11], s95 offen offset:0 sc1
  buffer_load_dword v205, v19, s[8:11], s95 offen offset:256 sc1
  buffer_load_dword v206, v19, s[8:11], s95 offen offset:512 sc1
  buffer_load_dword v207, v19, s[8:11], s95 offen offset:768 sc1
  v_add_f32 v160, v160, v162
  v_mfma_f32_32x32x16_bf16 v[32:47], a[212:215], v[128:131], v[32:47]
  ds_read_b64_tr_b16 v[124:125], v25 offset:6144
  ds_read_b64_tr_b16 v[126:127], v25 offset:6400
  s_add_u32 s97, s43, 0x006f4000
  buffer_store_dwordx4 v[200:203], v9, s[20:23], s97 offen sc1
  v_add_f32 v164, v164, v166
  s_waitcnt lgkmcnt(6)
  v_mfma_f32_32x32x16_bf16 v[32:47], a[216:219], v[132:135], v[32:47]
  ds_read_b64_tr_b16 v[128:129], v25 offset:7168
  ds_read_b64_tr_b16 v[130:131], v25 offset:7424
  v_mul_f32 v160, 0xbb000000, v160
  v_mfma_f32_32x32x16_bf16 v[32:47], a[220:223], v[136:139], v[32:47]
  ds_read_b64_tr_b16 v[132:133], v26 offset:0
  ds_read_b64_tr_b16 v[134:135], v26 offset:256
  v_mul_f32 v164, 0x3b000000, v164
  v_cvt_pk_bf16_f32 v156, v160, v160
  s_waitcnt lgkmcnt(6)
  v_mfma_f32_32x32x16_bf16 v[32:47], a[224:227], v[116:119], v[32:47]
  ds_read_b64_tr_b16 v[136:137], v26 offset:1024
  ds_read_b64_tr_b16 v[138:139], v26 offset:1280
  v_fma_f32 v164, -v160, v160, v164
  v_mfma_f32_32x32x16_bf16 v[32:47], a[228:231], v[120:123], v[32:47]
  ds_read_b64_tr_b16 v[116:117], v26 offset:2048
  ds_read_b64_tr_b16 v[118:119], v26 offset:2304
  v_cvt_pk_bf16_f32 v164, 0, |v164|
  s_waitcnt lgkmcnt(6)
  v_mfma_f32_32x32x16_bf16 v[32:47], a[232:235], v[124:127], v[32:47]
  ds_read_b64_tr_b16 v[120:121], v26 offset:3072
  ds_read_b64_tr_b16 v[122:123], v26 offset:3328
  v_add_f32 v164, 0x3727c5ac, v164
  v_mfma_f32_32x32x16_bf16 v[32:47], a[236:239], v[128:131], v[32:47]
  ds_read_b64_tr_b16 v[124:125], v26 offset:4096
  ds_read_b64_tr_b16 v[126:127], v26 offset:4352
  v_cvt_pk_bf16_f32 v164, 0, v164
  v_sqrt_f32 v164, v164
  s_waitcnt lgkmcnt(6)
  v_mfma_f32_32x32x16_bf16 v[32:47], a[240:243], v[132:135], v[32:47]
  ds_read_b64_tr_b16 v[128:129], v26 offset:5120
  ds_read_b64_tr_b16 v[130:131], v26 offset:5376
  s_add_u32 m0, s60, 0x00010000
  s_add_u32 s89, s42, 0x00000000
  buffer_load_dwordx4 v9, s[8:11], s89 offen offset:0 sc1 lds
  v_mov_b32 v157, v156
  v_mfma_f32_32x32x16_bf16 v[32:47], a[244:247], v[136:139], v[32:47]
  ds_read_b64_tr_b16 v[132:133], v26 offset:6144
  ds_read_b64_tr_b16 v[134:135], v26 offset:6400
  buffer_load_dwordx4 v9, s[8:11], s89 offen offset:1024 sc1 lds
  v_cvt_pk_bf16_f32 v164, 0, v164
  s_waitcnt lgkmcnt(6)
  v_mfma_f32_32x32x16_bf16 v[32:47], a[248:251], v[116:119], v[32:47]
  ds_read_b64_tr_b16 v[136:137], v26 offset:7168
  ds_read_b64_tr_b16 v[138:139], v26 offset:7424
  v_rcp_f32 v160, v164
  v_mfma_f32_32x32x16_bf16 v[32:47], a[252:255], v[120:123], v[32:47]
  ds_read_b64_tr_b16 v[116:117], v27 offset:0
  ds_read_b64_tr_b16 v[118:119], v27 offset:256
  v_mul_f32 v66, v164, v164
  s_waitcnt lgkmcnt(6)
  v_mfma_f32_32x32x16_bf16 v[32:47], v[208:211], v[124:127], v[32:47]
  ds_read_b64_tr_b16 v[120:121], v27 offset:1024
  ds_read_b64_tr_b16 v[122:123], v27 offset:1280
  s_waitcnt vmcnt(16)
  ds_read2st64_b32 v[140:141], v0 offset0:128 offset1:132
  buffer_load_dwordx4 v9, s[8:11], s89 offen offset:2048 sc1 lds
  v_mul_f32 v161, v160, v160
  v_mfma_f32_32x32x16_bf16 v[32:47], v[212:215], v[128:131], v[32:47]
  ds_read_b64_tr_b16 v[124:125], v27 offset:2048
  ds_read_b64_tr_b16 v[126:127], v27 offset:2304
  ds_read2st64_b32 v[142:143], v0 offset0:136 offset1:140
  buffer_load_dwordx4 v9, s[8:11], s89 offen offset:3072 sc1 lds
  s_waitcnt lgkmcnt(8)
  v_mfma_f32_32x32x16_bf16 v[32:47], v[216:219], v[132:135], v[32:47]
  ds_read_b64_tr_b16 v[128:129], v27 offset:3072
  ds_read_b64_tr_b16 v[130:131], v27 offset:3328
  ds_read2st64_b32 v[144:145], v0 offset0:144 offset1:148
  v_mul_f32 v64, 0xc0135761, v160
  v_mfma_f32_32x32x16_bf16 v[32:47], v[220:223], v[136:139], v[32:47]
  ds_read_b64_tr_b16 v[132:133], v27 offset:4096
  ds_read_b64_tr_b16 v[134:135], v27 offset:4352
  ds_read2st64_b32 v[146:147], v0 offset0:152 offset1:156
  v_mul_f32 v161, 0x3d372713, v161
  s_waitcnt lgkmcnt(10)
  s_waitcnt vmcnt(13)
  v_mfma_f32_32x32x16_bf16 v[32:47], v[224:227], v[116:119], v[32:47]
  ds_read_b64_tr_b16 v[136:137], v27 offset:5120
  ds_read_b64_tr_b16 v[138:139], v27 offset:5376
  ds_read_b64_tr_b16 v[84:85], v24 offset:32768
  s_add_u32 m0, s60, 0x00011000
  s_add_u32 s89, s42, 0x00001000
  buffer_load_dwordx4 v9, s[8:11], s89 offen offset:0 sc1 lds
  v_mul_f32 v65, v161, v64
  v_mfma_f32_32x32x16_bf16 v[32:47], v[228:231], v[120:123], v[32:47]
  ds_read_b64_tr_b16 v[116:117], v27 offset:6144
  ds_read_b64_tr_b16 v[118:119], v27 offset:6400
  ds_read_b64_tr_b16 v[86:87], v24 offset:33024
  s_waitcnt lgkmcnt(6)
  v_max3_u32 v140, v140, v141, v142
  buffer_load_dwordx4 v9, s[8:11], s89 offen offset:1024 sc1 lds
  v_mfma_f32_32x32x16_bf16 v[32:47], v[232:235], v[124:127], v[32:47]
  ds_read_b64_tr_b16 v[120:121], v27 offset:7168
  ds_read_b64_tr_b16 v[122:123], v27 offset:7424
  ds_read_b64_tr_b16 v[88:89], v24 offset:33792
  v_max3_u32 v143, v143, v144, v145
  v_mov_b64 v[158:159], v[156:157]
  v_mfma_f32_32x32x16_bf16 v[32:47], v[236:239], v[128:131], v[32:47]
  ds_read_b64_tr_b16 v[90:91], v24 offset:34048
  ds_read_b64_tr_b16 v[92:93], v24 offset:34816
  ds_read_b64_tr_b16 v[94:95], v24 offset:35072
  ds_read_b64_tr_b16 v[96:97], v24 offset:35840
  v_max3_u32 v140, v140, v146, v147
  v_max_u32 v140, v140, v143
  s_waitcnt lgkmcnt(11)
  s_waitcnt vmcnt(11)
  v_mfma_f32_32x32x16_bf16 v[32:47], v[240:243], v[132:135], v[32:47]
  ds_read_b64_tr_b16 v[98:99], v24 offset:36096
  ds_read_b64_tr_b16 v[100:101], v24 offset:36864
  ds_read_b64_tr_b16 v[102:103], v24 offset:37120
  ds_read_b64_tr_b16 v[104:105], v24 offset:37888
  ds_read_b64_tr_b16 v[106:107], v24 offset:38144
  buffer_load_dwordx4 v9, s[8:11], s89 offen offset:2048 sc1 lds
  v_mfma_f32_32x32x16_bf16 v[32:47], v[244:247], v[136:139], v[32:47]
  ds_read_b64_tr_b16 v[108:109], v24 offset:38912
  ds_read_b64_tr_b16 v[110:111], v24 offset:39168
  ds_read_b64_tr_b16 v[112:113], v24 offset:39936
  ds_read_b64_tr_b16 v[114:115], v24 offset:40192
  buffer_load_dwordx4 v9, s[8:11], s89 offen offset:3072 sc1 lds
  s_waitcnt lgkmcnt(14)
  v_mfma_f32_32x32x16_bf16 v[32:47], v[248:251], v[116:119], v[32:47]
  v_mfma_f32_32x32x16_bf16 v[32:47], v[252:255], v[120:123], v[32:47]
  s_waitcnt vmcnt(9)
  v_mfma_f32_32x32x16_bf16 v[32:47], v[204:207], v[156:159], v[32:47]
  v_cmp_eq_u32 vcc, -1, v140
  s_and_b64 vcc, vcc, s[56:57]
  s_cbranch_scc1 G_r01
G_b01:
  s_waitcnt lgkmcnt(0)
  s_barrier
  v_mfma_f32_32x32x16_bf16 v[48:63], a[176:179], v[84:87], 0
  s_add_u32 s97, s44, 0x006f4000
  buffer_store_dwordx4 v[200:203], v9, s[20:23], s97 offen sc1
  v_mfma_f32_32x32x16_bf16 v[48:63], a[180:183], v[88:91], v[48:63]
  v_mul_f32 v72, v32, v32
  v_mul_f32 v73, v33, v33
  v_fma_f32 v72, v72, v65, v64
  v_mul_f32 v74, v34, v34
  v_fma_f32 v73, v73, v65, v64
  v_mfma_f32_32x32x16_bf16 v[48:63], a[184:187], v[92:95], v[48:63]
  s_add_u32 s95, s55, 0x02200000
  buffer_load_dwordx4 a[0:3], v9, s[8:11], s95 offen offset:0 sc1
  v_mul_f32 v72, v72, v32
  v_mul_f32 v75, v35, v35
  v_fma_f32 v74, v74, v65, v64
  v_mul_f32 v73, v73, v33
  v_mfma_f32_32x32x16_bf16 v[48:63], a[188:191], v[96:99], v[48:63]
  ds_read_b64_tr_b16 v[124:125], v25 offset:32768
  ds_read_b64_tr_b16 v[126:127], v25 offset:33024
  buffer_load_dwordx4 a[4:7], v9, s[8:11], s95 offen offset:1024 sc1
  v_mul_f32 v40, v40, v32
  v_mul_f32 v76, v36, v36
  v_exp_f32 v72, v72
  v_mfma_f32_32x32x16_bf16 v[48:63], a[192:195], v[100:103], v[48:63]
  ds_read_b64_tr_b16 v[128:129], v25 offset:33792
  ds_read_b64_tr_b16 v[130:131], v25 offset:34048
  v_fma_f32 v75, v75, v65, v64
  v_mul_f32 v74, v74, v34
  v_mul_f32 v41, v41, v33
  v_mul_f32 v77, v37, v37
  v_mfma_f32_32x32x16_bf16 v[48:63], a[196:199], v[104:107], v[48:63]
  ds_read_b64_tr_b16 v[132:133], v25 offset:34816
  ds_read_b64_tr_b16 v[134:135], v25 offset:35072
  buffer_load_dwordx4 a[8:11], v9, s[8:11], s95 offen offset:2048 sc1
  v_exp_f32 v73, v73
  v_fma_f32 v76, v76, v65, v64
  v_mfma_f32_32x32x16_bf16 v[48:63], a[200:203], v[108:111], v[48:63]
  ds_read_b64_tr_b16 v[136:137], v25 offset:35840
  ds_read_b64_tr_b16 v[138:139], v25 offset:36096
  buffer_load_dwordx4 a[12:15], v9, s[8:11], s95 offen offset:3072 sc1
  v_mul_f32 v75, v75, v35
  v_mul_f32 v42, v42, v34
  v_fma_f32 v72, v72, v66, v66
  v_mfma_f32_32x32x16_bf16 v[48:63], a[204:207], v[112:115], v[48:63]
  ds_read_b64_tr_b16 v[116:117], v25 offset:36864
  ds_read_b64_tr_b16 v[118:119], v25 offset:37120
  s_add_u32 s95, s55, 0x02201000
  buffer_load_dwordx4 a[16:19], v9, s[8:11], s95 offen offset:0 sc1
  v_mul_f32 v78, v38, v38
  v_exp_f32 v74, v74
  s_waitcnt lgkmcnt(6)
  v_mfma_f32_32x32x16_bf16 v[48:63], a[208:211], v[124:127], v[48:63]
  ds_read_b64_tr_b16 v[120:121], v25 offset:37888
  ds_read_b64_tr_b16 v[122:123], v25 offset:38144
  v_fma_f32 v77, v77, v65, v64
  v_mul_f32 v76, v76, v36
  v_mul_f32 v43, v43, v35
  v_fma_f32 v73, v73, v66, v66
  v_mfma_f32_32x32x16_bf16 v[48:63], a[212:215], v[128:131], v[48:63]
  ds_read_b64_tr_b16 v[124:125], v25 offset:38912
  ds_read_b64_tr_b16 v[126:127], v25 offset:39168
  buffer_load_dwordx4 a[20:23], v9, s[8:11], s95 offen offset:1024 sc1
  v_mul_f32 v79, v39, v39
  v_exp_f32 v75, v75
  s_waitcnt lgkmcnt(6)
  v_mfma_f32_32x32x16_bf16 v[48:63], a[216:219], v[132:135], v[48:63]
  ds_read_b64_tr_b16 v[128:129], v25 offset:39936
  ds_read_b64_tr_b16 v[130:131], v25 offset:40192
  buffer_load_dwordx4 a[24:27], v9, s[8:11], s95 offen offset:2048 sc1
  v_fma_f32 v78, v78, v65, v64
  v_rcp_f32 v72, v72
  v_mul_f32 v77, v77, v37
  v_mfma_f32_32x32x16_bf16 v[48:63], a[220:223], v[136:139], v[48:63]
  ds_read_b64_tr_b16 v[132:133], v26 offset:32768
  ds_read_b64_tr_b16 v[134:135], v26 offset:33024
  v_mul_f32 v44, v44, v36
  v_fma_f32 v74, v74, v66, v66
  v_exp_f32 v76, v76
  s_waitcnt lgkmcnt(6)
  v_mfma_f32_32x32x16_bf16 v[48:63], a[224:227], v[116:119], v[48:63]
  ds_read_b64_tr_b16 v[136:137], v26 offset:33792
  ds_read_b64_tr_b16 v[138:139], v26 offset:34048
  buffer_load_dwordx4 a[28:31], v9, s[8:11], s95 offen offset:3072 sc1
  v_fma_f32 v79, v79, v65, v64
  v_rcp_f32 v73, v73
  v_mul_f32 v78, v78, v38
  v_mfma_f32_32x32x16_bf16 v[48:63], a[228:231], v[120:123], v[48:63]
  ds_read_b64_tr_b16 v[116:117], v26 offset:34816
  ds_read_b64_tr_b16 v[118:119], v26 offset:35072
  s_add_u32 s95, s55, 0x02202000
  buffer_load_dwordx4 a[32:35], v9, s[8:11], s95 offen offset:0 sc1
  v_mul_f32 v45, v45, v37
  v_fma_f32 v75, v75, v66, v66
  v_exp_f32 v77, v77
  s_waitcnt lgkmcnt(6)
  v_mfma_f32_32x32x16_bf16 v[48:63], a[232:235], v[124:127], v[48:63]
  ds_read_b64_tr_b16 v[120:121], v26 offset:35840
  ds_read_b64_tr_b16 v[122:123], v26 offset:36096
  s_add_u32 s3, s13, 0x00420000
  buffer_load_dwordx4 v[68:71], v20, s[8:11], s3 offen sc1
  v_mul_f32 v40, v40, v72
  v_rcp_f32 v74, v74
  v_mfma_f32_32x32x16_bf16 v[48:63], a[236:239], v[128:131], v[48:63]
  ds_read_b64_tr_b16 v[124:125], v26 offset:36864
  ds_read_b64_tr_b16 v[126:127], v26 offset:37120
  buffer_load_dwordx4 a[36:39], v9, s[8:11], s95 offen offset:1024 sc1
  v_mul_f32 v79, v79, v39
  v_mul_f32 v46, v46, v38
  v_fma_f32 v76, v76, v66, v66
  s_waitcnt lgkmcnt(6)
  v_mfma_f32_32x32x16_bf16 v[48:63], a[240:243], v[132:135], v[48:63]
  ds_read_b64_tr_b16 v[128:129], v26 offset:37888
  ds_read_b64_tr_b16 v[130:131], v26 offset:38144
s_branch Ia3x
Ia3:
s_branch Iar
Ia3x:
  s_add_u32 m0, s60, 0x00000000
  s_add_u32 s89, s40, 0x00100000
  buffer_load_dwordx4 v9, s[8:11], s89 offen offset:0 sc1 lds
  v_exp_f32 v78, v78
  v_mul_f32 v41, v41, v73
  v_mfma_f32_32x32x16_bf16 v[48:63], a[244:247], v[136:139], v[48:63]
  ds_read_b64_tr_b16 v[132:133], v26 offset:38912
  ds_read_b64_tr_b16 v[134:135], v26 offset:39168
  buffer_load_dwordx4 v9, s[8:11], s89 offen offset:1024 sc1 lds
  v_rcp_f32 v75, v75
  v_mul_f32 v47, v47, v39
  v_fma_f32 v77, v77, v66, v66
  s_waitcnt lgkmcnt(6)
  v_mfma_f32_32x32x16_bf16 v[48:63], a[248:251], v[116:119], v[48:63]
  ds_read_b64_tr_b16 v[136:137], v26 offset:39936
  ds_read_b64_tr_b16 v[138:139], v26 offset:40192
  v_exp_f32 v79, v79
  v_mul_f32 v42, v42, v74
  v_cvt_pk_bf16_f32 v80, v40, v41
  v_mfma_f32_32x32x16_bf16 v[48:63], a[252:255], v[120:123], v[48:63]
  ds_read_b64_tr_b16 v[116:117], v27 offset:32768
  ds_read_b64_tr_b16 v[118:119], v27 offset:33024
  v_add_u32 v148, 0x10000, v0
  v_rcp_f32 v76, v76
  v_fma_f32 v78, v78, v66, v66
  v_mul_f32 v43, v43, v75
  s_waitcnt lgkmcnt(6)
  v_mfma_f32_32x32x16_bf16 v[48:63], v[208:211], v[124:127], v[48:63]
  ds_read_b64_tr_b16 v[120:121], v27 offset:33792
  ds_read_b64_tr_b16 v[122:123], v27 offset:34048
  s_waitcnt vmcnt(14)
  ds_read2st64_b32 v[140:141], v148 offset0:0 offset1:4
  buffer_load_dwordx4 v9, s[8:11], s89 offen offset:2048 sc1 lds
  v_rcp_f32 v77, v77
  v_mfma_f32_32x32x16_bf16 v[48:63], v[212:215], v[128:131], v[48:63]
  ds_read_b64_tr_b16 v[124:125], v27 offset:34816
  ds_read_b64_tr_b16 v[126:127], v27 offset:35072
  ds_read2st64_b32 v[142:143], v148 offset0:8 offset1:12
  buffer_load_dwordx4 v9, s[8:11], s89 offen offset:3072 sc1 lds
  v_fma_f32 v79, v79, v66, v66
  v_mul_f32 v44, v44, v76
  s_waitcnt lgkmcnt(8)
  v_mfma_f32_32x32x16_bf16 v[48:63], v[216:219], v[132:135], v[48:63]
  ds_read_b64_tr_b16 v[128:129], v27 offset:35840
  ds_read_b64_tr_b16 v[130:131], v27 offset:36096
  ds_read2st64_b32 v[144:145], v148 offset0:16 offset1:20
  v_cvt_pk_bf16_f32 v81, v42, v43
  v_rcp_f32 v78, v78
  v_mfma_f32_32x32x16_bf16 v[48:63], v[220:223], v[136:139], v[48:63]
  ds_read_b64_tr_b16 v[132:133], v27 offset:36864
  ds_read_b64_tr_b16 v[134:135], v27 offset:37120
  ds_read2st64_b32 v[146:147], v148 offset0:24 offset1:28
  v_mul_f32 v45, v45, v77
  v_rcp_f32 v79, v79
  v_mul_f32 v46, v46, v78
  s_waitcnt lgkmcnt(10)
  v_mfma_f32_32x32x16_bf16 v[48:63], v[224:227], v[116:119], v[48:63]
  ds_read_b64_tr_b16 v[136:137], v27 offset:37888
  ds_read_b64_tr_b16 v[138:139], v27 offset:38144
  ds_read_b64_tr_b16 v[84:85], v28 offset:0
  s_add_u32 m0, s60, 0x00001000
  s_add_u32 s89, s40, 0x00101000
  buffer_load_dwordx4 v9, s[8:11], s89 offen offset:0 sc1 lds
  v_cvt_pk_bf16_f32 v82, v44, v45
  v_mfma_f32_32x32x16_bf16 v[48:63], v[228:231], v[120:123], v[48:63]
  ds_read_b64_tr_b16 v[116:117], v27 offset:38912
  ds_read_b64_tr_b16 v[118:119], v27 offset:39168
  ds_read_b64_tr_b16 v[86:87], v28 offset:256
  s_waitcnt lgkmcnt(6)
  v_max3_u32 v140, v140, v141, v142
  buffer_load_dwordx4 v9, s[8:11], s89 offen offset:1024 sc1 lds
  v_mul_f32 v47, v47, v79
  v_mfma_f32_32x32x16_bf16 v[48:63], v[232:235], v[124:127], v[48:63]
  ds_read_b64_tr_b16 v[120:121], v27 offset:39936
  ds_read_b64_tr_b16 v[122:123], v27 offset:40192
  ds_read_b64_tr_b16 v[88:89], v28 offset:1024
  v_max3_u32 v143, v143, v144, v145
  v_cvt_pk_bf16_f32 v83, v46, v47
  s_add_u32 s98, s43, 0x00434000
  buffer_store_dwordx4 v[80:83], v9, s[20:23], s98 offen sc1
  v_mfma_f32_32x32x16_bf16 v[48:63], v[236:239], v[128:131], v[48:63]
  ds_read_b64_tr_b16 v[90:91], v28 offset:1280
  ds_read_b64_tr_b16 v[92:93], v28 offset:2048
  ds_read_b64_tr_b16 v[94:95], v28 offset:2304
  ds_read_b64_tr_b16 v[96:97], v28 offset:3072
  v_max3_u32 v140, v140, v146, v147
  v_max_u32 v140, v140, v143
  s_waitcnt lgkmcnt(11)
  v_mfma_f32_32x32x16_bf16 v[48:63], v[240:243], v[132:135], v[48:63]
  ds_read_b64_tr_b16 v[98:99], v28 offset:3328
  ds_read_b64_tr_b16 v[100:101], v28 offset:4096
  ds_read_b64_tr_b16 v[102:103], v28 offset:4352
  ds_read_b64_tr_b16 v[104:105], v28 offset:5120
  ds_read_b64_tr_b16 v[106:107], v28 offset:5376
  buffer_load_dwordx4 v9, s[8:11], s89 offen offset:2048 sc1 lds
  v_mfma_f32_32x32x16_bf16 v[48:63], v[244:247], v[136:139], v[48:63]
  ds_read_b64_tr_b16 v[108:109], v28 offset:6144
  ds_read_b64_tr_b16 v[110:111], v28 offset:6400
  ds_read_b64_tr_b16 v[112:113], v28 offset:7168
  ds_read_b64_tr_b16 v[114:115], v28 offset:7424
  buffer_load_dwordx4 v9, s[8:11], s89 offen offset:3072 sc1 lds
  s_waitcnt lgkmcnt(14)
  v_mfma_f32_32x32x16_bf16 v[48:63], v[248:251], v[116:119], v[48:63]
  s_waitcnt vmcnt(10)
T_b01:
  v_cmp_eq_u32 vcc, -1, v68
  s_and_b64 vcc, vcc, s[56:57]
  s_cbranch_scc1 T_r01
  v_mfma_f32_32x32x16_bf16 v[48:63], v[252:255], v[120:123], v[48:63]
  v_mov_b32 v156, v71
  v_mov_b32 v157, v71
  v_mov_b64 v[158:159], v[156:157]
  s_nop 1
  v_mfma_f32_32x32x16_bf16 v[48:63], v[204:207], v[156:159], v[48:63]
  v_cmp_eq_u32 vcc, -1, v140
  s_and_b64 vcc, vcc, s[56:57]
  s_cbranch_scc1 G_r02
G_b02:
  s_waitcnt lgkmcnt(0)
  s_barrier
  v_mfma_f32_32x32x16_bf16 v[32:47], a[176:179], v[84:87], 0
  v_mfma_f32_32x32x16_bf16 v[32:47], a[180:183], v[88:91], v[32:47]
  s_add_u32 m0, s60, 0x00008000
  s_add_u32 s89, s41, 0x00100000
  buffer_load_dwordx4 v9, s[8:11], s89 offen offset:0 sc1 lds
  v_mul_f32 v72, v48, v48
  v_mul_f32 v73, v49, v49
  v_fma_f32 v72, v72, v69, v68
  v_mul_f32 v74, v50, v50
  v_mfma_f32_32x32x16_bf16 v[32:47], a[184:187], v[92:95], v[32:47]
  buffer_load_dwordx4 v9, s[8:11], s89 offen offset:1024 sc1 lds
  v_fma_f32 v73, v73, v69, v68
  v_mul_f32 v72, v72, v48
  v_mul_f32 v75, v51, v51
  v_fma_f32 v74, v74, v69, v68
  v_mul_f32 v73, v73, v49
  v_mfma_f32_32x32x16_bf16 v[32:47], a[188:191], v[96:99], v[32:47]
  ds_read_b64_tr_b16 v[124:125], v29 offset:0
  ds_read_b64_tr_b16 v[126:127], v29 offset:256
  v_mul_f32 v56, v56, v48
  v_mul_f32 v76, v52, v52
  v_exp_f32 v72, v72
  v_mfma_f32_32x32x16_bf16 v[32:47], a[192:195], v[100:103], v[32:47]
  ds_read_b64_tr_b16 v[128:129], v29 offset:1024
  ds_read_b64_tr_b16 v[130:131], v29 offset:1280
  v_fma_f32 v75, v75, v69, v68
  v_mul_f32 v74, v74, v50
  v_mul_f32 v57, v57, v49
  v_mfma_f32_32x32x16_bf16 v[32:47], a[196:199], v[104:107], v[32:47]
  ds_read_b64_tr_b16 v[132:133], v29 offset:2048
  ds_read_b64_tr_b16 v[134:135], v29 offset:2304
  buffer_load_dwordx4 v9, s[8:11], s89 offen offset:2048 sc1 lds
  v_mul_f32 v77, v53, v53
  v_exp_f32 v73, v73
  v_fma_f32 v76, v76, v69, v68
  v_mfma_f32_32x32x16_bf16 v[32:47], a[200:203], v[108:111], v[32:47]
  ds_read_b64_tr_b16 v[136:137], v29 offset:3072
  ds_read_b64_tr_b16 v[138:139], v29 offset:3328
  buffer_load_dwordx4 v9, s[8:11], s89 offen offset:3072 sc1 lds
  v_mul_f32 v75, v75, v51
  v_mul_f32 v58, v58, v50
  v_mfma_f32_32x32x16_bf16 v[32:47], a[204:207], v[112:115], v[32:47]
  ds_read_b64_tr_b16 v[116:117], v29 offset:4096
  ds_read_b64_tr_b16 v[118:119], v29 offset:4352
  v_fma_f32 v72, v72, v70, v70
  v_mul_f32 v78, v54, v54
  v_exp_f32 v74, v74
  v_fma_f32 v77, v77, v69, v68
  s_waitcnt lgkmcnt(6)
  v_mfma_f32_32x32x16_bf16 v[32:47], a[208:211], v[124:127], v[32:47]
  ds_read_b64_tr_b16 v[120:121], v29 offset:5120
  ds_read_b64_tr_b16 v[122:123], v29 offset:5376
  v_mul_f32 v76, v76, v52
  v_mul_f32 v59, v59, v51
  v_fma_f32 v73, v73, v70, v70
  v_mfma_f32_32x32x16_bf16 v[32:47], a[212:215], v[128:131], v[32:47]
  ds_read_b64_tr_b16 v[124:125], v29 offset:6144
  ds_read_b64_tr_b16 v[126:127], v29 offset:6400
  s_add_u32 m0, s60, 0x00009000
  s_add_u32 s89, s41, 0x00101000
  buffer_load_dwordx4 v9, s[8:11], s89 offen offset:0 sc1 lds
  v_mul_f32 v79, v55, v55
  v_exp_f32 v75, v75
  v_fma_f32 v78, v78, v69, v68
  s_waitcnt lgkmcnt(6)
  v_mfma_f32_32x32x16_bf16 v[32:47], a[216:219], v[132:135], v[32:47]
  ds_read_b64_tr_b16 v[128:129], v29 offset:7168
  ds_read_b64_tr_b16 v[130:131], v29 offset:7424
  buffer_load_dwordx4 v9, s[8:11], s89 offen offset:1024 sc1 lds
  v_rcp_f32 v72, v72
  v_mul_f32 v77, v77, v53
  v_mfma_f32_32x32x16_bf16 v[32:47], a[220:223], v[136:139], v[32:47]
  ds_read_b64_tr_b16 v[132:133], v30 offset:0
  ds_read_b64_tr_b16 v[134:135], v30 offset:256
  v_mul_f32 v60, v60, v52
  v_fma_f32 v74, v74, v70, v70
  v_exp_f32 v76, v76
  v_fma_f32 v79, v79, v69, v68
  s_waitcnt lgkmcnt(6)
  v_mfma_f32_32x32x16_bf16 v[32:47], a[224:227], v[116:119], v[32:47]
  ds_read_b64_tr_b16 v[136:137], v30 offset:1024
  ds_read_b64_tr_b16 v[138:139], v30 offset:1280
  v_rcp_f32 v73, v73
  v_mul_f32 v78, v78, v54
  v_mul_f32 v61, v61, v53
  v_mfma_f32_32x32x16_bf16 v[32:47], a[228:231], v[120:123], v[32:47]
  ds_read_b64_tr_b16 v[116:117], v30 offset:2048
  ds_read_b64_tr_b16 v[118:119], v30 offset:2304
  buffer_load_dwordx4 v9, s[8:11], s89 offen offset:2048 sc1 lds
  v_fma_f32 v75, v75, v70, v70
  v_exp_f32 v77, v77
  v_mul_f32 v56, v56, v72
  s_waitcnt lgkmcnt(6)
  v_mfma_f32_32x32x16_bf16 v[32:47], a[232:235], v[124:127], v[32:47]
  ds_read_b64_tr_b16 v[120:121], v30 offset:3072
  ds_read_b64_tr_b16 v[122:123], v30 offset:3328
  s_add_u32 s3, s14, 0x00420000
  buffer_load_dwordx4 v[64:67], v20, s[8:11], s3 offen sc1
  buffer_load_dwordx4 v9, s[8:11], s89 offen offset:3072 sc1 lds
  v_rcp_f32 v74, v74
  v_mfma_f32_32x32x16_bf16 v[32:47], a[236:239], v[128:131], v[32:47]
  ds_read_b64_tr_b16 v[124:125], v30 offset:4096
  ds_read_b64_tr_b16 v[126:127], v30 offset:4352
  v_mul_f32 v79, v79, v55
  v_mul_f32 v62, v62, v54
  v_fma_f32 v76, v76, v70, v70
  v_exp_f32 v78, v78
  s_waitcnt lgkmcnt(6)
  v_mfma_f32_32x32x16_bf16 v[32:47], a[240:243], v[132:135], v[32:47]
  ds_read_b64_tr_b16 v[128:129], v30 offset:5120
  ds_read_b64_tr_b16 v[130:131], v30 offset:5376
  s_add_u32 s97, s45, 0x006f4000
  buffer_store_dwordx4 v[200:203], v9, s[24:27], s97 offen sc1
  v_mul_f32 v57, v57, v73
  v_rcp_f32 v75, v75
  v_mfma_f32_32x32x16_bf16 v[32:47], a[244:247], v[136:139], v[32:47]
  ds_read_b64_tr_b16 v[132:133], v30 offset:6144
  ds_read_b64_tr_b16 v[134:135], v30 offset:6400
  v_mul_f32 v63, v63, v55
  v_fma_f32 v77, v77, v70, v70
  v_exp_f32 v79, v79
  v_mul_f32 v58, v58, v74
  s_waitcnt lgkmcnt(6)
  v_mfma_f32_32x32x16_bf16 v[32:47], a[248:251], v[116:119], v[32:47]
  ds_read_b64_tr_b16 v[136:137], v30 offset:7168
  ds_read_b64_tr_b16 v[138:139], v30 offset:7424
  buffer_load_dwordx4 a[40:43], v9, s[8:11], s95 offen offset:2048 sc1
  v_cvt_pk_bf16_f32 v80, v56, v57
  v_rcp_f32 v76, v76
  v_mfma_f32_32x32x16_bf16 v[32:47], a[252:255], v[120:123], v[32:47]
  ds_read_b64_tr_b16 v[116:117], v31 offset:0
  ds_read_b64_tr_b16 v[118:119], v31 offset:256
  buffer_load_dwordx4 a[44:47], v9, s[8:11], s95 offen offset:3072 sc1
  v_fma_f32 v78, v78, v70, v70
  v_mul_f32 v59, v59, v75
  v_rcp_f32 v77, v77
  s_waitcnt lgkmcnt(6)
  v_mfma_f32_32x32x16_bf16 v[32:47], v[208:211], v[124:127], v[32:47]
  ds_read_b64_tr_b16 v[120:121], v31 offset:1024
  ds_read_b64_tr_b16 v[122:123], v31 offset:1280
  s_waitcnt vmcnt(12)
  ds_read2st64_b32 v[140:141], v0 offset0:0 offset1:4
  v_fma_f32 v79, v79, v70, v70
  v_mul_f32 v60, v60, v76
  v_mfma_f32_32x32x16_bf16 v[32:47], v[212:215], v[128:131], v[32:47]
  ds_read_b64_tr_b16 v[124:125], v31 offset:2048
  ds_read_b64_tr_b16 v[126:127], v31 offset:2304
  ds_read2st64_b32 v[142:143], v0 offset0:8 offset1:12
  s_add_u32 s95, s55, 0x02203000
  buffer_load_dwordx4 a[48:51], v9, s[8:11], s95 offen offset:0 sc1
  v_cvt_pk_bf16_f32 v81, v58, v59
  s_waitcnt lgkmcnt(8)
  v_mfma_f32_32x32x16_bf16 v[32:47], v[216:219], v[132:135], v[32:47]
  ds_read_b64_tr_b16 v[128:129], v31 offset:3072
  ds_read_b64_tr_b16 v[130:131], v31 offset:3328
  ds_read2st64_b32 v[144:145], v0 offset0:16 offset1:20
  buffer_load_dwordx4 a[52:55], v9, s[8:11], s95 offen offset:1024 sc1
  v_rcp_f32 v78, v78
  v_mul_f32 v61, v61, v77
  v_mfma_f32_32x32x16_bf16 v[32:47], v[220:223], v[136:139], v[32:47]
  ds_read_b64_tr_b16 v[132:133], v31 offset:4096
  ds_read_b64_tr_b16 v[134:135], v31 offset:4352
  ds_read2st64_b32 v[146:147], v0 offset0:24 offset1:28
  buffer_load_dwordx4 a[56:59], v9, s[8:11], s95 offen offset:2048 sc1
  v_rcp_f32 v79, v79
  v_mul_f32 v62, v62, v78
  s_waitcnt lgkmcnt(10)
  v_mfma_f32_32x32x16_bf16 v[32:47], v[224:227], v[116:119], v[32:47]
  ds_read_b64_tr_b16 v[136:137], v31 offset:5120
  ds_read_b64_tr_b16 v[138:139], v31 offset:5376
  ds_read_b64_tr_b16 v[84:85], v24 offset:0
  v_cvt_pk_bf16_f32 v82, v60, v61
  v_mul_f32 v63, v63, v79
  v_mfma_f32_32x32x16_bf16 v[32:47], v[228:231], v[120:123], v[32:47]
  ds_read_b64_tr_b16 v[116:117], v31 offset:6144
  ds_read_b64_tr_b16 v[118:119], v31 offset:6400
  ds_read_b64_tr_b16 v[86:87], v24 offset:256
  s_waitcnt lgkmcnt(6)
  v_max3_u32 v140, v140, v141, v142
  buffer_load_dwordx4 a[60:63], v9, s[8:11], s95 offen offset:3072 sc1
  v_cvt_pk_bf16_f32 v83, v62, v63
  v_mfma_f32_32x32x16_bf16 v[32:47], v[232:235], v[124:127], v[32:47]
  ds_read_b64_tr_b16 v[120:121], v31 offset:7168
  ds_read_b64_tr_b16 v[122:123], v31 offset:7424
  ds_read_b64_tr_b16 v[88:89], v24 offset:1024
  v_max3_u32 v143, v143, v144, v145
  s_add_u32 s95, s55, 0x02204000
  buffer_load_dwordx4 a[64:67], v9, s[8:11], s95 offen offset:0 sc1
  s_add_u32 s98, s44, 0x00434000
  buffer_store_dwordx4 v[80:83], v9, s[20:23], s98 offen sc1
  v_mfma_f32_32x32x16_bf16 v[32:47], v[236:239], v[128:131], v[32:47]
  ds_read_b64_tr_b16 v[90:91], v24 offset:1280
  ds_read_b64_tr_b16 v[92:93], v24 offset:2048
  ds_read_b64_tr_b16 v[94:95], v24 offset:2304
  ds_read_b64_tr_b16 v[96:97], v24 offset:3072
  v_max3_u32 v140, v140, v146, v147
  v_max_u32 v140, v140, v143
  s_waitcnt lgkmcnt(11)
  v_mfma_f32_32x32x16_bf16 v[32:47], v[240:243], v[132:135], v[32:47]
  ds_read_b64_tr_b16 v[98:99], v24 offset:3328
  ds_read_b64_tr_b16 v[100:101], v24 offset:4096
  ds_read_b64_tr_b16 v[102:103], v24 offset:4352
  ds_read_b64_tr_b16 v[104:105], v24 offset:5120
  ds_read_b64_tr_b16 v[106:107], v24 offset:5376
  buffer_load_dwordx4 a[68:71], v9, s[8:11], s95 offen offset:1024 sc1
  v_mfma_f32_32x32x16_bf16 v[32:47], v[244:247], v[136:139], v[32:47]
  ds_read_b64_tr_b16 v[108:109], v24 offset:6144
  ds_read_b64_tr_b16 v[110:111], v24 offset:6400
  ds_read_b64_tr_b16 v[112:113], v24 offset:7168
  ds_read_b64_tr_b16 v[114:115], v24 offset:7424
  buffer_load_dwordx4 a[72:75], v9, s[8:11], s95 offen offset:2048 sc1
  s_waitcnt lgkmcnt(14)
  v_mfma_f32_32x32x16_bf16 v[32:47], v[248:251], v[116:119], v[32:47]
  s_waitcnt vmcnt(12)
T_b02:
  v_cmp_eq_u32 vcc, -1, v64
  s_and_b64 vcc, vcc, s[56:57]
  s_cbranch_scc1 T_r02
  v_mfma_f32_32x32x16_bf16 v[32:47], v[252:255], v[120:123], v[32:47]
  v_mov_b32 v156, v67
  v_mov_b32 v157, v67
  v_mov_b64 v[158:159], v[156:157]
  s_nop 1
  buffer_load_dwordx4 a[76:79], v9, s[8:11], s95 offen offset:3072 sc1
  v_mfma_f32_32x32x16_bf16 v[32:47], v[204:207], v[156:159], v[32:47]
  v_cmp_eq_u32 vcc, -1, v140
  s_and_b64 vcc, vcc, s[56:57]
  s_cbranch_scc1 G_r03
G_b03:
  s_waitcnt lgkmcnt(0)
  s_barrier
  v_mfma_f32_32x32x16_bf16 v[48:63], a[176:179], v[84:87], 0
  v_mfma_f32_32x32x16_bf16 v[48:63], a[180:183], v[88:91], v[48:63]
  s_add_u32 m0, s60, 0x00010000
  s_add_u32 s89, s42, 0x00100000
  buffer_load_dwordx4 v9, s[8:11], s89 offen offset:0 sc1 lds
  v_mul_f32 v72, v32, v32
  v_mul_f32 v73, v33, v33
  v_fma_f32 v72, v72, v65, v64
  v_mul_f32 v74, v34, v34
  v_mfma_f32_32x32x16_bf16 v[48:63], a[184:187], v[92:95], v[48:63]
  buffer_load_dwordx4 v9, s[8:11], s89 offen offset:1024 sc1 lds
  v_fma_f32 v73, v73, v65, v64
  v_mul_f32 v72, v72, v32
  v_mul_f32 v75, v35, v35
  v_fma_f32 v74, v74, v65, v64
  v_mul_f32 v73, v73, v33
  v_mfma_f32_32x32x16_bf16 v[48:63], a[188:191], v[96:99], v[48:63]
  ds_read_b64_tr_b16 v[124:125], v25 offset:0
  ds_read_b64_tr_b16 v[126:127], v25 offset:256
  v_mul_f32 v40, v40, v32
  v_mul_f32 v76, v36, v36
  v_exp_f32 v72, v72
  v_mfma_f32_32x32x16_bf16 v[48:63], a[192:195], v[100:103], v[48:63]
  ds_read_b64_tr_b16 v[128:129], v25 offset:1024
  ds_read_b64_tr_b16 v[130:131], v25 offset:1280
  v_fma_f32 v75, v75, v65, v64
  v_mul_f32 v74, v74, v34
  v_mul_f32 v41, v41, v33
  v_mfma_f32_32x32x16_bf16 v[48:63], a[196:199], v[104:107], v[48:63]
  ds_read_b64_tr_b16 v[132:133], v25 offset:2048
  ds_read_b64_tr_b16 v[134:135], v25 offset:2304
  buffer_load_dwordx4 v9, s[8:11], s89 offen offset:2048 sc1 lds
  v_mul_f32 v77, v37, v37
  v_exp_f32 v73, v73
  v_fma_f32 v76, v76, v65, v64
  v_mfma_f32_32x32x16_bf16 v[48:63], a[200:203], v[108:111], v[48:63]
  ds_read_b64_tr_b16 v[136:137], v25 offset:3072
  ds_read_b64_tr_b16 v[138:139], v25 offset:3328
  buffer_load_dwordx4 v9, s[8:11], s89 offen offset:3072 sc1 lds
  v_mul_f32 v75, v75, v35
  v_mul_f32 v42, v42, v34
  v_mfma_f32_32x32x16_bf16 v[48:63], a[204:207], v[112:115], v[48:63]
  ds_read_b64_tr_b16 v[116:117], v25 offset:4096
  ds_read_b64_tr_b16 v[118:119], v25 offset:4352
  v_fma_f32 v72, v72, v66, v66
  v_mul_f32 v78, v38, v38
  v_exp_f32 v74, v74
  v_fma_f32 v77, v77, v65, v64
  s_waitcnt lgkmcnt(6)
  v_mfma_f32_32x32x16_bf16 v[48:63], a[208:211], v[124:127], v[48:63]
  ds_read_b64_tr_b16 v[120:121], v25 offset:5120
  ds_read_b64_tr_b16 v[122:123], v25 offset:5376
  v_mul_f32 v76, v76, v36
  v_mul_f32 v43, v43, v35
  v_fma_f32 v73, v73, v66, v66
  v_mfma_f32_32x32x16_bf16 v[48:63], a[212:215], v[128:131], v[48:63]
  ds_read_b64_tr_b16 v[124:125], v25 offset:6144
  ds_read_b64_tr_b16 v[126:127], v25 offset:6400
  s_add_u32 m0, s60, 0x00011000
  s_add_u32 s89, s42, 0x00101000
  buffer_load_dwordx4 v9, s[8:11], s89 offen offset:0 sc1 lds
  v_mul_f32 v79, v39, v39
  v_exp_f32 v75, v75
  v_fma_f32 v78, v78, v65, v64
  s_waitcnt lgkmcnt(6)
  v_mfma_f32_32x32x16_bf16 v[48:63], a[216:219], v[132:135], v[48:63]
  ds_read_b64_tr_b16 v[128:129], v25 offset:7168
  ds_read_b64_tr_b16 v[130:131], v25 offset:7424
  buffer_load_dwordx4 v9, s[8:11], s89 offen offset:1024 sc1 lds
  v_rcp_f32 v72, v72
  v_mul_f32 v77, v77, v37
  v_mfma_f32_32x32x16_bf16 v[48:63], a[220:223], v[136:139], v[48:63]
  ds_read_b64_tr_b16 v[132:133], v26 offset:0
  ds_read_b64_tr_b16 v[134:135], v26 offset:256
  v_mul_f32 v44, v44, v36
  v_fma_f32 v74, v74, v66, v66
  v_exp_f32 v76, v76
  v_fma_f32 v79, v79, v65, v64
  s_waitcnt lgkmcnt(6)
  v_mfma_f32_32x32x16_bf16 v[48:63], a[224:227], v[116:119], v[48:63]
  ds_read_b64_tr_b16 v[136:137], v26 offset:1024
  ds_read_b64_tr_b16 v[138:139], v26 offset:1280
  v_rcp_f32 v73, v73
  v_mul_f32 v78, v78, v38
  v_mul_f32 v45, v45, v37
  v_mfma_f32_32x32x16_bf16 v[48:63], a[228:231], v[120:123], v[48:63]
  ds_read_b64_tr_b16 v[116:117], v26 offset:2048
  ds_read_b64_tr_b16 v[118:119], v26 offset:2304
  buffer_load_dwordx4 v9, s[8:11], s89 offen offset:2048 sc1 lds
  v_fma_f32 v75, v75, v66, v66
  v_exp_f32 v77, v77
  v_mul_f32 v40, v40, v72
  s_waitcnt lgkmcnt(6)
  v_mfma_f32_32x32x16_bf16 v[48:63], a[232:235], v[124:127], v[48:63]
  ds_read_b64_tr_b16 v[120:121], v26 offset:3072
  ds_read_b64_tr_b16 v[122:123], v26 offset:3328
  s_add_u32 s3, s12, 0x00424000
  buffer_load_dwordx4 v[68:71], v20, s[8:11], s3 offen sc1
  buffer_load_dwordx4 v9, s[8:11], s89 offen offset:3072 sc1 lds
  v_rcp_f32 v74, v74
  v_mfma_f32_32x32x16_bf16 v[48:63], a[236:239], v[128:131], v[48:63]
  ds_read_b64_tr_b16 v[124:125], v26 offset:4096
  ds_read_b64_tr_b16 v[126:127], v26 offset:4352
  v_mul_f32 v79, v79, v39
  v_mul_f32 v46, v46, v38
  v_fma_f32 v76, v76, v66, v66
  v_exp_f32 v78, v78
  s_waitcnt lgkmcnt(6)
  v_mfma_f32_32x32x16_bf16 v[48:63], a[240:243], v[132:135], v[48:63]
  ds_read_b64_tr_b16 v[128:129], v26 offset:5120
  ds_read_b64_tr_b16 v[130:131], v26 offset:5376
  s_add_u32 s95, s55, 0x02205000
  buffer_load_dwordx4 a[80:83], v9, s[8:11], s95 offen offset:0 sc1
  v_mul_f32 v41, v41, v73
  v_rcp_f32 v75, v75
  v_mfma_f32_32x32x16_bf16 v[48:63], a[244:247], v[136:139], v[48:63]
  ds_read_b64_tr_b16 v[132:133], v26 offset:6144
  ds_read_b64_tr_b16 v[134:135], v26 offset:6400
  v_mul_f32 v47, v47, v39
  v_fma_f32 v77, v77, v66, v66
  v_exp_f32 v79, v79
  v_mul_f32 v42, v42, v74
  s_waitcnt lgkmcnt(6)
  v_mfma_f32_32x32x16_bf16 v[48:63], a[248:251], v[116:119], v[48:63]
  ds_read_b64_tr_b16 v[136:137], v26 offset:7168
  ds_read_b64_tr_b16 v[138:139], v26 offset:7424
  buffer_load_dwordx4 a[84:87], v9, s[8:11], s95 offen offset:1024 sc1
  v_cvt_pk_bf16_f32 v80, v40, v41
  v_rcp_f32 v76, v76
  v_mfma_f32_32x32x16_bf16 v[48:63], a[252:255], v[120:123], v[48:63]
  ds_read_b64_tr_b16 v[116:117], v27 offset:0
  ds_read_b64_tr_b16 v[118:119], v27 offset:256
  buffer_load_dwordx4 a[88:91], v9, s[8:11], s95 offen offset:2048 sc1
  v_fma_f32 v78, v78, v66, v66
  v_mul_f32 v43, v43, v75
  v_rcp_f32 v77, v77
  s_waitcnt lgkmcnt(6)
  v_mfma_f32_32x32x16_bf16 v[48:63], v[208:211], v[124:127], v[48:63]
  ds_read_b64_tr_b16 v[120:121], v27 offset:1024
  ds_read_b64_tr_b16 v[122:123], v27 offset:1280
  s_waitcnt vmcnt(24)
  ds_read2st64_b32 v[140:141], v0 offset0:128 offset1:132
  v_fma_f32 v79, v79, v66, v66
  v_mul_f32 v44, v44, v76
  v_mfma_f32_32x32x16_bf16 v[48:63], v[212:215], v[128:131], v[48:63]
  ds_read_b64_tr_b16 v[124:125], v27 offset:2048
  ds_read_b64_tr_b16 v[126:127], v27 offset:2304
  ds_read2st64_b32 v[142:143], v0 offset0:136 offset1:140
  buffer_load_dwordx4 a[92:95], v9, s[8:11], s95 offen offset:3072 sc1
  v_cvt_pk_bf16_f32 v81, v42, v43
  s_waitcnt lgkmcnt(8)
  v_mfma_f32_32x32x16_bf16 v[48:63], v[216:219], v[132:135], v[48:63]
  ds_read_b64_tr_b16 v[128:129], v27 offset:3072
  ds_read_b64_tr_b16 v[130:131], v27 offset:3328
  ds_read2st64_b32 v[144:145], v0 offset0:144 offset1:148
  s_add_u32 s95, s55, 0x02206000
  buffer_load_dwordx4 a[96:99], v9, s[8:11], s95 offen offset:0 sc1
  v_rcp_f32 v78, v78
  v_mul_f32 v45, v45, v77
  v_mfma_f32_32x32x16_bf16 v[48:63], v[220:223], v[136:139], v[48:63]
  ds_read_b64_tr_b16 v[132:133], v27 offset:4096
  ds_read_b64_tr_b16 v[134:135], v27 offset:4352
  ds_read2st64_b32 v[146:147], v0 offset0:152 offset1:156
  buffer_load_dwordx4 a[100:103], v9, s[8:11], s95 offen offset:1024 sc1
  v_rcp_f32 v79, v79
  v_mul_f32 v46, v46, v78
  s_waitcnt lgkmcnt(10)
  v_mfma_f32_32x32x16_bf16 v[48:63], v[224:227], v[116:119], v[48:63]
  ds_read_b64_tr_b16 v[136:137], v27 offset:5120
  ds_read_b64_tr_b16 v[138:139], v27 offset:5376
  ds_read_b64_tr_b16 v[84:85], v24 offset:32768
  v_cvt_pk_bf16_f32 v82, v44, v45
  v_mul_f32 v47, v47, v79
  v_mfma_f32_32x32x16_bf16 v[48:63], v[228:231], v[120:123], v[48:63]
  ds_read_b64_tr_b16 v[116:117], v27 offset:6144
  ds_read_b64_tr_b16 v[118:119], v27 offset:6400
  ds_read_b64_tr_b16 v[86:87], v24 offset:33024
  s_waitcnt lgkmcnt(6)
  v_max3_u32 v140, v140, v141, v142
  buffer_load_dwordx4 a[104:107], v9, s[8:11], s95 offen offset:2048 sc1
  v_cvt_pk_bf16_f32 v83, v46, v47
  v_mfma_f32_32x32x16_bf16 v[48:63], v[232:235], v[124:127], v[48:63]
  ds_read_b64_tr_b16 v[120:121], v27 offset:7168
  ds_read_b64_tr_b16 v[122:123], v27 offset:7424
  ds_read_b64_tr_b16 v[88:89], v24 offset:33792
  v_max3_u32 v143, v143, v144, v145
  buffer_load_dwordx4 a[108:111], v9, s[8:11], s95 offen offset:3072 sc1
  s_waitcnt vmcnt(28)
  s_add_u32 s98, s45, 0x00434000
  buffer_store_dwordx4 v[80:83], v9, s[24:27], s98 offen sc1
  v_mfma_f32_32x32x16_bf16 v[48:63], v[236:239], v[128:131], v[48:63]
  ds_read_b64_tr_b16 v[90:91], v24 offset:34048
  ds_read_b64_tr_b16 v[92:93], v24 offset:34816
  ds_read_b64_tr_b16 v[94:95], v24 offset:35072
  ds_read_b64_tr_b16 v[96:97], v24 offset:35840
  v_max3_u32 v140, v140, v146, v147
  v_max_u32 v140, v140, v143
  s_waitcnt lgkmcnt(11)
  v_mfma_f32_32x32x16_bf16 v[48:63], v[240:243], v[132:135], v[48:63]
  ds_read_b64_tr_b16 v[98:99], v24 offset:36096
  ds_read_b64_tr_b16 v[100:101], v24 offset:36864
  ds_read_b64_tr_b16 v[102:103], v24 offset:37120
  ds_read_b64_tr_b16 v[104:105], v24 offset:37888
  ds_read_b64_tr_b16 v[106:107], v24 offset:38144
  s_add_u32 s95, s55, 0x02207000
  buffer_load_dwordx4 a[112:115], v9, s[8:11], s95 offen offset:0 sc1
  v_mfma_f32_32x32x16_bf16 v[48:63], v[244:247], v[136:139], v[48:63]
  ds_read_b64_tr_b16 v[108:109], v24 offset:38912
  ds_read_b64_tr_b16 v[110:111], v24 offset:39168
  ds_read_b64_tr_b16 v[112:113], v24 offset:39936
  ds_read_b64_tr_b16 v[114:115], v24 offset:40192
  s_add_u32 s97, s58, 0x00a00000
  buffer_store_dwordx4 v[200:203], v16, s[8:11], s97 offen sc1
  s_waitcnt lgkmcnt(14)
  v_mfma_f32_32x32x16_bf16 v[48:63], v[248:251], v[116:119], v[48:63]
  s_waitcnt vmcnt(12)
T_b03:
  v_cmp_eq_u32 vcc, -1, v68
  s_and_b64 vcc, vcc, s[56:57]
  s_cbranch_scc1 T_r03
  v_mfma_f32_32x32x16_bf16 v[48:63], v[252:255], v[120:123], v[48:63]
  v_mov_b32 v156, v71
  v_mov_b32 v157, v71
  v_mov_b64 v[158:159], v[156:157]
  s_nop 1
  s_add_u32 s97, s58, 0x00b00000
  buffer_store_dwordx4 v[200:203], v16, s[8:11], s97 offen sc1
  v_mfma_f32_32x32x16_bf16 v[48:63], v[204:207], v[156:159], v[48:63]
  v_cmp_eq_u32 vcc, -1, v140
  s_and_b64 vcc, vcc, s[56:57]
  s_cbranch_scc1 G_r04
G_b04:
  s_waitcnt lgkmcnt(0)
  s_barrier
  v_mfma_f32_32x32x16_bf16 v[32:47], a[176:179], v[84:87], 0
  v_mfma_f32_32x32x16_bf16 v[32:47], a[180:183], v[88:91], v[32:47]
  buffer_load_dwordx4 a[116:119], v9, s[8:11], s95 offen offset:1024 sc1
  v_mul_f32 v72, v48, v48
  v_mul_f32 v73, v49, v49
  v_fma_f32 v72, v72, v69, v68
  v_mul_f32 v74, v50, v50
  v_mfma_f32_32x32x16_bf16 v[32:47], a[184:187], v[92:95], v[32:47]
  v_fma_f32 v73, v73, v69, v68
  v_mul_f32 v72, v72, v48
  v_mul_f32 v75, v51, v51
  v_fma_f32 v74, v74, v69, v68
  v_mul_f32 v73, v73, v49
  v_mfma_f32_32x32x16_bf16 v[32:47], a[188:191], v[96:99], v[32:47]
  ds_read_b64_tr_b16 v[124:125], v25 offset:32768
  ds_read_b64_tr_b16 v[126:127], v25 offset:33024
  buffer_load_dwordx4 a[120:123], v9, s[8:11], s95 offen offset:2048 sc1
  v_mul_f32 v56, v56, v48
  v_mul_f32 v76, v52, v52
  v_mfma_f32_32x32x16_bf16 v[32:47], a[192:195], v[100:103], v[32:47]
  ds_read_b64_tr_b16 v[128:129], v25 offset:33792
  ds_read_b64_tr_b16 v[130:131], v25 offset:34048
  v_exp_f32 v72, v72
  v_fma_f32 v75, v75, v69, v68
  v_mul_f32 v74, v74, v50
  v_mfma_f32_32x32x16_bf16 v[32:47], a[196:199], v[104:107], v[32:47]
  ds_read_b64_tr_b16 v[132:133], v25 offset:34816
  ds_read_b64_tr_b16 v[134:135], v25 offset:35072
  v_mul_f32 v57, v57, v49
  v_mul_f32 v77, v53, v53
  v_exp_f32 v73, v73
  v_fma_f32 v76, v76, v69, v68
  v_mfma_f32_32x32x16_bf16 v[32:47], a[200:203], v[108:111], v[32:47]
s_branch Ia4x
Ia4:
s_branch Iar
Ia4x:
  ds_read_b64_tr_b16 v[136:137], v25 offset:35840
  ds_read_b64_tr_b16 v[138:139], v25 offset:36096
  buffer_load_dwordx4 a[124:127], v9, s[8:11], s95 offen offset:3072 sc1
  v_mul_f32 v75, v75, v51
  v_mul_f32 v58, v58, v50
  v_mfma_f32_32x32x16_bf16 v[32:47], a[204:207], v[112:115], v[32:47]
  ds_read_b64_tr_b16 v[116:117], v25 offset:36864
  ds_read_b64_tr_b16 v[118:119], v25 offset:37120
  v_fma_f32 v72, v72, v70, v70
  v_mul_f32 v78, v54, v54
  v_exp_f32 v74, v74
  s_waitcnt lgkmcnt(6)
  v_mfma_f32_32x32x16_bf16 v[32:47], a[208:211], v[124:127], v[32:47]
  ds_read_b64_tr_b16 v[120:121], v25 offset:37888
  ds_read_b64_tr_b16 v[122:123], v25 offset:38144
  v_fma_f32 v77, v77, v69, v68
  v_mul_f32 v76, v76, v52
  v_mul_f32 v59, v59, v51
  v_mfma_f32_32x32x16_bf16 v[32:47], a[212:215], v[128:131], v[32:47]
  ds_read_b64_tr_b16 v[124:125], v25 offset:38912
  ds_read_b64_tr_b16 v[126:127], v25 offset:39168
  s_add_u32 s95, s55, 0x02208000
  buffer_load_dwordx4 a[128:131], v9, s[8:11], s95 offen offset:0 sc1
  v_fma_f32 v73, v73, v70, v70
  v_mul_f32 v79, v55, v55
  v_exp_f32 v75, v75
  s_waitcnt lgkmcnt(6)
  v_mfma_f32_32x32x16_bf16 v[32:47], a[216:219], v[132:135], v[32:47]
  ds_read_b64_tr_b16 v[128:129], v25 offset:39936
  ds_read_b64_tr_b16 v[130:131], v25 offset:40192
  v_fma_f32 v78, v78, v69, v68
  v_rcp_f32 v72, v72
  v_mul_f32 v77, v77, v53
  v_mfma_f32_32x32x16_bf16 v[32:47], a[220:223], v[136:139], v[32:47]
  ds_read_b64_tr_b16 v[132:133], v26 offset:32768
  ds_read_b64_tr_b16 v[134:135], v26 offset:33024
  v_mul_f32 v60, v60, v52
  v_fma_f32 v74, v74, v70, v70
  v_exp_f32 v76, v76
  s_waitcnt lgkmcnt(6)
  v_mfma_f32_32x32x16_bf16 v[32:47], a[224:227], v[116:119], v[32:47]
  ds_read_b64_tr_b16 v[136:137], v26 offset:33792
  ds_read_b64_tr_b16 v[138:139], v26 offset:34048
  buffer_load_dwordx4 a[132:135], v9, s[8:11], s95 offen offset:1024 sc1
  v_fma_f32 v79, v79, v69, v68
  v_rcp_f32 v73, v73
  v_mul_f32 v78, v78, v54
  v_mfma_f32_32x32x16_bf16 v[32:47], a[228:231], v[120:123], v[32:47]
  ds_read_b64_tr_b16 v[116:117], v26 offset:34816
  ds_read_b64_tr_b16 v[118:119], v26 offset:35072
  v_mul_f32 v61, v61, v53
  v_fma_f32 v75, v75, v70, v70
  v_exp_f32 v77, v77
  s_waitcnt lgkmcnt(6)
  v_mfma_f32_32x32x16_bf16 v[32:47], a[232:235], v[124:127], v[32:47]
  ds_read_b64_tr_b16 v[120:121], v26 offset:35840
  ds_read_b64_tr_b16 v[122:123], v26 offset:36096
  s_add_u32 s3, s13, 0x00424000
  buffer_load_dwordx4 v[64:67], v20, s[8:11], s3 offen sc1
  buffer_load_dwordx4 a[136:139], v9, s[8:11], s95 offen offset:2048 sc1
  v_mul_f32 v56, v56, v72
  v_rcp_f32 v74, v74
  v_mfma_f32_32x32x16_bf16 v[32:47], a[236:239], v[128:131], v[32:47]
  ds_read_b64_tr_b16 v[124:125], v26 offset:36864
  ds_read_b64_tr_b16 v[126:127], v26 offset:37120
  v_mul_f32 v79, v79, v55
  v_mul_f32 v62, v62, v54
  v_fma_f32 v76, v76, v70, v70
  s_waitcnt lgkmcnt(6)
  v_mfma_f32_32x32x16_bf16 v[32:47], a[240:243], v[132:135], v[32:47]
  ds_read_b64_tr_b16 v[128:129], v26 offset:37888
  ds_read_b64_tr_b16 v[130:131], v26 offset:38144
  v_exp_f32 v78, v78
  v_mul_f32 v57, v57, v73
  v_rcp_f32 v75, v75
  v_mfma_f32_32x32x16_bf16 v[32:47], a[244:247], v[136:139], v[32:47]
  ds_read_b64_tr_b16 v[132:133], v26 offset:38912
  ds_read_b64_tr_b16 v[134:135], v26 offset:39168
  buffer_load_dwordx4 a[140:143], v9, s[8:11], s95 offen offset:3072 sc1
  v_mul_f32 v63, v63, v55
  v_fma_f32 v77, v77, v70, v70
  s_waitcnt lgkmcnt(6)
  v_mfma_f32_32x32x16_bf16 v[32:47], a[248:251], v[116:119], v[32:47]
  ds_read_b64_tr_b16 v[136:137], v26 offset:39936
  ds_read_b64_tr_b16 v[138:139], v26 offset:40192
  v_exp_f32 v79, v79
  v_mul_f32 v58, v58, v74
  v_cvt_pk_bf16_f32 v80, v56, v57
  v_rcp_f32 v76, v76
  v_mfma_f32_32x32x16_bf16 v[32:47], a[252:255], v[120:123], v[32:47]
  ds_read_b64_tr_b16 v[116:117], v27 offset:32768
  ds_read_b64_tr_b16 v[118:119], v27 offset:33024
  v_add_u32 v148, 0x10000, v0
  s_add_u32 s95, s55, 0x02209000
  buffer_load_dwordx4 a[144:147], v9, s[8:11], s95 offen offset:0 sc1
  v_fma_f32 v78, v78, v70, v70
  s_waitcnt lgkmcnt(6)
  v_mfma_f32_32x32x16_bf16 v[32:47], v[208:211], v[124:127], v[32:47]
  ds_read_b64_tr_b16 v[120:121], v27 offset:33792
  ds_read_b64_tr_b16 v[122:123], v27 offset:34048
  s_waitcnt vmcnt(21)
  ds_read2st64_b32 v[140:141], v148 offset0:0 offset1:4
  v_mul_f32 v59, v59, v75
  v_rcp_f32 v77, v77
  v_mfma_f32_32x32x16_bf16 v[32:47], v[212:215], v[128:131], v[32:47]
  ds_read_b64_tr_b16 v[124:125], v27 offset:34816
  ds_read_b64_tr_b16 v[126:127], v27 offset:35072
  ds_read2st64_b32 v[142:143], v148 offset0:8 offset1:12
  v_fma_f32 v79, v79, v70, v70
  v_mul_f32 v60, v60, v76
  s_waitcnt lgkmcnt(8)
  v_mfma_f32_32x32x16_bf16 v[32:47], v[216:219], v[132:135], v[32:47]
  ds_read_b64_tr_b16 v[128:129], v27 offset:35840
  ds_read_b64_tr_b16 v[130:131], v27 offset:36096
  ds_read2st64_b32 v[144:145], v148 offset0:16 offset1:20
  buffer_load_dwordx4 a[148:151], v9, s[8:11], s95 offen offset:1024 sc1
  v_cvt_pk_bf16_f32 v81, v58, v59
  v_rcp_f32 v78, v78
  v_mfma_f32_32x32x16_bf16 v[32:47], v[220:223], v[136:139], v[32:47]
  ds_read_b64_tr_b16 v[132:133], v27 offset:36864
  ds_read_b64_tr_b16 v[134:135], v27 offset:37120
  ds_read2st64_b32 v[146:147], v148 offset0:24 offset1:28
  v_mul_f32 v61, v61, v77
  v_rcp_f32 v79, v79
  s_waitcnt lgkmcnt(10)
  v_mfma_f32_32x32x16_bf16 v[32:47], v[224:227], v[116:119], v[32:47]
  ds_read_b64_tr_b16 v[136:137], v27 offset:37888
  ds_read_b64_tr_b16 v[138:139], v27 offset:38144
  ds_read_b64_tr_b16 v[84:85], v28 offset:0
  v_mul_f32 v62, v62, v78
  v_cvt_pk_bf16_f32 v82, v60, v61
  v_mul_f32 v63, v63, v79
  v_mfma_f32_32x32x16_bf16 v[32:47], v[228:231], v[120:123], v[32:47]
  ds_read_b64_tr_b16 v[116:117], v27 offset:38912
  ds_read_b64_tr_b16 v[118:119], v27 offset:39168
  ds_read_b64_tr_b16 v[86:87], v28 offset:256
  s_waitcnt lgkmcnt(6)
  v_max3_u32 v140, v140, v141, v142
  buffer_load_dwordx4 a[152:155], v9, s[8:11], s95 offen offset:2048 sc1
  v_mfma_f32_32x32x16_bf16 v[32:47], v[232:235], v[124:127], v[32:47]
  ds_read_b64_tr_b16 v[120:121], v27 offset:39936
  ds_read_b64_tr_b16 v[122:123], v27 offset:40192
  ds_read_b64_tr_b16 v[88:89], v28 offset:1024
  v_max3_u32 v143, v143, v144, v145
  v_cvt_pk_bf16_f32 v83, v62, v63
  s_add_u32 s98, s43, 0x006f4000
  buffer_store_dwordx4 v[80:83], v9, s[20:23], s98 offen sc1
  v_mfma_f32_32x32x16_bf16 v[32:47], v[236:239], v[128:131], v[32:47]
  ds_read_b64_tr_b16 v[90:91], v28 offset:1280
  ds_read_b64_tr_b16 v[92:93], v28 offset:2048
  ds_read_b64_tr_b16 v[94:95], v28 offset:2304
  ds_read_b64_tr_b16 v[96:97], v28 offset:3072
  v_max3_u32 v140, v140, v146, v147
  v_max_u32 v140, v140, v143
  s_waitcnt lgkmcnt(11)
  v_mfma_f32_32x32x16_bf16 v[32:47], v[240:243], v[132:135], v[32:47]
  ds_read_b64_tr_b16 v[98:99], v28 offset:3328
  ds_read_b64_tr_b16 v[100:101], v28 offset:4096
  ds_read_b64_tr_b16 v[102:103], v28 offset:4352
  ds_read_b64_tr_b16 v[104:105], v28 offset:5120
  ds_read_b64_tr_b16 v[106:107], v28 offset:5376
  buffer_load_dwordx4 a[156:159], v9, s[8:11], s95 offen offset:3072 sc1
  v_mfma_f32_32x32x16_bf16 v[32:47], v[244:247], v[136:139], v[32:47]
  ds_read_b64_tr_b16 v[108:109], v28 offset:6144
  ds_read_b64_tr_b16 v[110:111], v28 offset:6400
  ds_read_b64_tr_b16 v[112:113], v28 offset:7168
  ds_read_b64_tr_b16 v[114:115], v28 offset:7424
  s_waitcnt lgkmcnt(14)
  v_mfma_f32_32x32x16_bf16 v[32:47], v[248:251], v[116:119], v[32:47]
  s_waitcnt vmcnt(7)
T_b04:
  v_cmp_eq_u32 vcc, -1, v64
  s_and_b64 vcc, vcc, s[56:57]
  s_cbranch_scc1 T_r04
  s_add_u32 s97, s47, 0x00300000
  buffer_store_dwordx4 v[200:203], v16, s[8:11], s97 offen sc1
  v_mfma_f32_32x32x16_bf16 v[32:47], v[252:255], v[120:123], v[32:47]
  v_mov_b32 v156, v67
  v_mov_b32 v157, v67
  v_mov_b64 v[158:159], v[156:157]
  s_nop 1
  v_mfma_f32_32x32x16_bf16 v[32:47], v[204:207], v[156:159], v[32:47]
  v_cmp_eq_u32 vcc, -1, v140
  s_and_b64 vcc, vcc, s[56:57]
  s_cbranch_scc1 G_r05
G_b05:
  s_waitcnt lgkmcnt(0)
  s_barrier
  v_mfma_f32_32x32x16_bf16 v[48:63], a[176:179], v[84:87], 0
  s_add_u32 s95, s55, 0x0220a000
  buffer_load_dwordx4 a[160:163], v9, s[8:11], s95 offen offset:0 sc1
  v_mfma_f32_32x32x16_bf16 v[48:63], a[180:183], v[88:91], v[48:63]
  v_mul_f32 v72, v32, v32
  v_mul_f32 v73, v33, v33
  v_fma_f32 v72, v72, v65, v64
  v_mul_f32 v74, v34, v34
  v_mfma_f32_32x32x16_bf16 v[48:63], a[184:187], v[92:95], v[48:63]
  buffer_load_dwordx4 a[164:167], v9, s[8:11], s95 offen offset:1024 sc1
  v_fma_f32 v73, v73, v65, v64
  v_mul_f32 v72, v72, v32
  v_mul_f32 v75, v35, v35
  v_fma_f32 v74, v74, v65, v64
  v_mfma_f32_32x32x16_bf16 v[48:63], a[188:191], v[96:99], v[48:63]
  ds_read_b64_tr_b16 v[124:125], v29 offset:0
  ds_read_b64_tr_b16 v[126:127], v29 offset:256
  v_mul_f32 v73, v73, v33
  v_mul_f32 v40, v40, v32
  v_mul_f32 v76, v36, v36
  v_mfma_f32_32x32x16_bf16 v[48:63], a[192:195], v[100:103], v[48:63]
  ds_read_b64_tr_b16 v[128:129], v29 offset:1024
  ds_read_b64_tr_b16 v[130:131], v29 offset:1280
  buffer_load_dwordx4 a[168:171], v9, s[8:11], s95 offen offset:2048 sc1
  v_exp_f32 v72, v72
  v_fma_f32 v75, v75, v65, v64
  v_mfma_f32_32x32x16_bf16 v[48:63], a[196:199], v[104:107], v[48:63]
  ds_read_b64_tr_b16 v[132:133], v29 offset:2048
  ds_read_b64_tr_b16 v[134:135], v29 offset:2304
  v_mul_f32 v74, v74, v34
  v_mul_f32 v41, v41, v33
  v_mfma_f32_32x32x16_bf16 v[48:63], a[200:203], v[108:111], v[48:63]
  ds_read_b64_tr_b16 v[136:137], v29 offset:3072
  ds_read_b64_tr_b16 v[138:139], v29 offset:3328
  buffer_load_dwordx4 a[172:175], v9, s[8:11], s95 offen offset:3072 sc1
  v_mul_f32 v77, v37, v37
  v_exp_f32 v73, v73
  v_fma_f32 v76, v76, v65, v64
  v_mfma_f32_32x32x16_bf16 v[48:63], a[204:207], v[112:115], v[48:63]
  ds_read_b64_tr_b16 v[116:117], v29 offset:4096
  ds_read_b64_tr_b16 v[118:119], v29 offset:4352
  v_mul_f32 v75, v75, v35
  v_mul_f32 v42, v42, v34
  s_waitcnt lgkmcnt(6)
  v_mfma_f32_32x32x16_bf16 v[48:63], a[208:211], v[124:127], v[48:63]
  ds_read_b64_tr_b16 v[120:121], v29 offset:5120
  ds_read_b64_tr_b16 v[122:123], v29 offset:5376
  s_add_u32 s96, s46, 0x00434000
  buffer_load_dwordx4 v[168:171], v9, s[8:11], s96 offen offset:0 sc1
  v_fma_f32 v72, v72, v66, v66
  v_mul_f32 v78, v38, v38
  v_exp_f32 v74, v74
  v_mfma_f32_32x32x16_bf16 v[48:63], a[212:215], v[128:131], v[48:63]
  ds_read_b64_tr_b16 v[124:125], v29 offset:6144
  ds_read_b64_tr_b16 v[126:127], v29 offset:6400
  buffer_load_dwordx4 v[172:175], v9, s[8:11], s96 offen offset:1024 sc1
  v_fma_f32 v77, v77, v65, v64
  v_mul_f32 v76, v76, v36
  s_waitcnt lgkmcnt(6)
  v_mfma_f32_32x32x16_bf16 v[48:63], a[216:219], v[132:135], v[48:63]
  ds_read_b64_tr_b16 v[128:129], v29 offset:7168
  ds_read_b64_tr_b16 v[130:131], v29 offset:7424
  v_mul_f32 v43, v43, v35
  v_fma_f32 v73, v73, v66, v66
  v_mfma_f32_32x32x16_bf16 v[48:63], a[220:223], v[136:139], v[48:63]
  ds_read_b64_tr_b16 v[132:133], v30 offset:0
  ds_read_b64_tr_b16 v[134:135], v30 offset:256
  buffer_load_dwordx4 v[176:179], v9, s[8:11], s96 offen offset:2048 sc1
  v_mul_f32 v79, v39, v39
  v_exp_f32 v75, v75
  v_fma_f32 v78, v78, v65, v64
  s_waitcnt lgkmcnt(6)
  v_mfma_f32_32x32x16_bf16 v[48:63], a[224:227], v[116:119], v[48:63]
  ds_read_b64_tr_b16 v[136:137], v30 offset:1024
  ds_read_b64_tr_b16 v[138:139], v30 offset:1280
  v_rcp_f32 v72, v72
  v_mul_f32 v77, v77, v37
  v_mfma_f32_32x32x16_bf16 v[48:63], a[228:231], v[120:123], v[48:63]
  ds_read_b64_tr_b16 v[116:117], v30 offset:2048
  ds_read_b64_tr_b16 v[118:119], v30 offset:2304
  buffer_load_dwordx4 v[180:183], v9, s[8:11], s96 offen offset:3072 sc1
  v_mul_f32 v44, v44, v36
  v_fma_f32 v74, v74, v66, v66
  s_waitcnt lgkmcnt(6)
  v_mfma_f32_32x32x16_bf16 v[48:63], a[232:235], v[124:127], v[48:63]
  ds_read_b64_tr_b16 v[120:121], v30 offset:3072
  ds_read_b64_tr_b16 v[122:123], v30 offset:3328
  s_add_u32 s3, s14, 0x00424000
  buffer_load_dwordx4 v[68:71], v20, s[8:11], s3 offen sc1
  v_exp_f32 v76, v76
  v_fma_f32 v79, v79, v65, v64
  v_rcp_f32 v73, v73
  v_mfma_f32_32x32x16_bf16 v[48:63], a[236:239], v[128:131], v[48:63]
  ds_read_b64_tr_b16 v[124:125], v30 offset:4096
  ds_read_b64_tr_b16 v[126:127], v30 offset:4352
  s_add_u32 s96, s46, 0x00435000
  buffer_load_dwordx4 v[184:187], v9, s[8:11], s96 offen offset:0 sc1
  v_mul_f32 v78, v78, v38
  v_mul_f32 v45, v45, v37
  s_waitcnt lgkmcnt(6)
  v_mfma_f32_32x32x16_bf16 v[48:63], a[240:243], v[132:135], v[48:63]
  ds_read_b64_tr_b16 v[128:129], v30 offset:5120
  ds_read_b64_tr_b16 v[130:131], v30 offset:5376
  buffer_load_dwordx4 v[188:191], v9, s[8:11], s96 offen offset:1024 sc1
  v_fma_f32 v75, v75, v66, v66
  v_exp_f32 v77, v77
  v_mfma_f32_32x32x16_bf16 v[48:63], a[244:247], v[136:139], v[48:63]
  ds_read_b64_tr_b16 v[132:133], v30 offset:6144
  ds_read_b64_tr_b16 v[134:135], v30 offset:6400
  v_mul_f32 v40, v40, v72
  v_rcp_f32 v74, v74
  v_mul_f32 v79, v79, v39
  s_waitcnt lgkmcnt(6)
  v_mfma_f32_32x32x16_bf16 v[48:63], a[248:251], v[116:119], v[48:63]
  ds_read_b64_tr_b16 v[136:137], v30 offset:7168
  ds_read_b64_tr_b16 v[138:139], v30 offset:7424
  buffer_load_dwordx4 v[192:195], v9, s[8:11], s96 offen offset:2048 sc1
  v_mul_f32 v46, v46, v38
  v_fma_f32 v76, v76, v66, v66
  v_mfma_f32_32x32x16_bf16 v[48:63], a[252:255], v[120:123], v[48:63]
  ds_read_b64_tr_b16 v[116:117], v31 offset:0
  ds_read_b64_tr_b16 v[118:119], v31 offset:256
  v_exp_f32 v78, v78
  v_mul_f32 v41, v41, v73
  v_rcp_f32 v75, v75
  s_waitcnt lgkmcnt(6)
  v_mfma_f32_32x32x16_bf16 v[48:63], v[208:211], v[124:127], v[48:63]
  ds_read_b64_tr_b16 v[120:121], v31 offset:1024
  ds_read_b64_tr_b16 v[122:123], v31 offset:1280
  buffer_load_dwordx4 v[196:199], v9, s[8:11], s96 offen offset:3072 sc1
  v_mul_f32 v47, v47, v39
  v_fma_f32 v77, v77, v66, v66
  v_mfma_f32_32x32x16_bf16 v[48:63], v[212:215], v[128:131], v[48:63]
  ds_read_b64_tr_b16 v[124:125], v31 offset:2048
  ds_read_b64_tr_b16 v[126:127], v31 offset:2304
  v_exp_f32 v79, v79
  v_mul_f32 v42, v42, v74
  v_cvt_pk_bf16_f32 v80, v40, v41
  s_waitcnt lgkmcnt(6)
  v_mfma_f32_32x32x16_bf16 v[48:63], v[216:219], v[132:135], v[48:63]
  ds_read_b64_tr_b16 v[128:129], v31 offset:3072
  ds_read_b64_tr_b16 v[130:131], v31 offset:3328
  s_add_u32 s96, s46, 0x00436000
  buffer_load_dwordx4 v[200:203], v9, s[8:11], s96 offen offset:0 sc1
  v_rcp_f32 v76, v76
  v_fma_f32 v78, v78, v66, v66
  v_mfma_f32_32x32x16_bf16 v[48:63], v[220:223], v[136:139], v[48:63]
  ds_read_b64_tr_b16 v[132:133], v31 offset:4096
  ds_read_b64_tr_b16 v[134:135], v31 offset:4352
  buffer_load_dwordx4 v[140:143], v9, s[8:11], s96 offen offset:1024 sc1
  v_mul_f32 v43, v43, v75
  v_rcp_f32 v77, v77
  s_waitcnt lgkmcnt(6)
  v_mfma_f32_32x32x16_bf16 v[48:63], v[224:227], v[116:119], v[48:63]
  ds_read_b64_tr_b16 v[136:137], v31 offset:5120
  ds_read_b64_tr_b16 v[138:139], v31 offset:5376
  v_fma_f32 v79, v79, v66, v66
  v_mul_f32 v44, v44, v76
  v_cvt_pk_bf16_f32 v81, v42, v43
  v_mfma_f32_32x32x16_bf16 v[48:63], v[228:231], v[120:123], v[48:63]
  ds_read_b64_tr_b16 v[116:117], v31 offset:6144
  ds_read_b64_tr_b16 v[118:119], v31 offset:6400
  buffer_load_dwordx4 v[144:147], v9, s[8:11], s96 offen offset:2048 sc1
  v_rcp_f32 v78, v78
  v_mul_f32 v45, v45, v77
  s_waitcnt lgkmcnt(6)
  v_mfma_f32_32x32x16_bf16 v[48:63], v[232:235], v[124:127], v[48:63]
  ds_read_b64_tr_b16 v[120:121], v31 offset:7168
  ds_read_b64_tr_b16 v[122:123], v31 offset:7424
  v_rcp_f32 v79, v79
  v_mul_f32 v46, v46, v78
  v_mfma_f32_32x32x16_bf16 v[48:63], v[236:239], v[128:131], v[48:63]
  buffer_load_dwordx4 v[148:151], v9, s[8:11], s96 offen offset:3072 sc1
  v_cvt_pk_bf16_f32 v82, v44, v45
  v_mul_f32 v47, v47, v79
  v_cvt_pk_bf16_f32 v83, v46, v47
  s_add_u32 s98, s44, 0x006f4000
  buffer_store_dwordx4 v[80:83], v9, s[20:23], s98 offen sc1
  s_waitcnt lgkmcnt(4)
  v_mfma_f32_32x32x16_bf16 v[48:63], v[240:243], v[132:135], v[48:63]
  v_mfma_f32_32x32x16_bf16 v[48:63], v[244:247], v[136:139], v[48:63]
  s_add_u32 s96, s46, 0x00437000
  buffer_load_dwordx4 v[152:155], v9, s[8:11], s96 offen offset:0 sc1
  s_waitcnt lgkmcnt(0)
  v_mfma_f32_32x32x16_bf16 v[48:63], v[248:251], v[116:119], v[48:63]
  s_waitcnt vmcnt(10)
T_b05:
  v_cmp_eq_u32 vcc, -1, v68
  s_and_b64 vcc, vcc, s[56:57]
  s_cbranch_scc1 T_r05
  v_mfma_f32_32x32x16_bf16 v[48:63], v[252:255], v[120:123], v[48:63]
  v_mov_b32 v156, v71
  v_mov_b32 v157, v71
  v_mov_b64 v[158:159], v[156:157]
  s_nop 1
  buffer_load_dwordx4 v[84:87], v9, s[8:11], s96 offen offset:1024 sc1
  v_mfma_f32_32x32x16_bf16 v[48:63], v[204:207], v[156:159], v[48:63]
G2_0:
  v_max3_u32 v136, v168, v172, v176
  v_cmp_eq_u32 vcc, -1, v136
  s_and_b64 vcc, vcc, s[56:57]
  s_cbranch_scc1 H_r000
H_b000:
  v_mfma_f32_32x32x16_bf16 v[32:47], v[168:171], a[0:3], 0
  s_add_u32 s98, s47, 0x00000000
  buffer_load_dwordx4 v[132:135], v16, s[8:11], s98 offen sc1
  s_nop 3
  v_mfma_f32_32x32x16_bf16 v[116:131], v[168:171], a[4:7], 0
  buffer_load_dwordx4 v[88:91], v9, s[8:11], s96 offen offset:2048 sc1
  v_mul_f32 v72, v48, v48
  v_mul_f32 v73, v49, v49
  v_fma_f32 v72, v72, v69, v68
  v_mul_f32 v74, v50, v50
  v_fma_f32 v73, v73, v69, v68
  v_mul_f32 v72, v72, v48
  v_mul_f32 v75, v51, v51
  v_fma_f32 v74, v74, v69, v68
  v_mul_f32 v73, v73, v49
  v_mul_f32 v56, v56, v48
  v_mul_f32 v76, v52, v52
  v_mfma_f32_32x32x16_bf16 v[32:47], v[172:175], a[8:11], v[32:47]
  buffer_load_dwordx4 v[92:95], v9, s[8:11], s96 offen offset:3072 sc1
  v_exp_f32 v72, v72
  v_fma_f32 v75, v75, v69, v68
  v_mul_f32 v74, v74, v50
  v_mul_f32 v57, v57, v49
  v_mul_f32 v77, v53, v53
  v_exp_f32 v73, v73
  v_fma_f32 v76, v76, v69, v68
  v_mul_f32 v75, v75, v51
  v_mul_f32 v58, v58, v50
  v_fma_f32 v72, v72, v70, v70
  v_mfma_f32_32x32x16_bf16 v[116:131], v[172:175], a[12:15], v[116:131]
  v_mul_f32 v78, v54, v54
  v_exp_f32 v74, v74
  v_fma_f32 v77, v77, v69, v68
  v_mul_f32 v76, v76, v52
  v_mul_f32 v59, v59, v51
  v_fma_f32 v73, v73, v70, v70
  v_mul_f32 v79, v55, v55
  v_exp_f32 v75, v75
  v_fma_f32 v78, v78, v69, v68
  v_rcp_f32 v72, v72
  v_mul_f32 v77, v77, v53
  v_mul_f32 v60, v60, v52
  v_fma_f32 v74, v74, v70, v70
  v_mfma_f32_32x32x16_bf16 v[32:47], v[176:179], a[16:19], v[32:47]
  s_waitcnt vmcnt(12)
  v_max3_u32 v136, v180, v184, v188
  v_cmp_eq_u32 vcc, -1, v136
  s_and_b64 vcc, vcc, s[56:57]
  s_cbranch_scc1 H_r001
H_b001:
  v_exp_f32 v76, v76
  v_mfma_f32_32x32x16_bf16 v[116:131], v[176:179], a[20:23], v[116:131]
  s_add_u32 s96, s46, 0x00438000
  buffer_load_dwordx4 v[96:99], v9, s[8:11], s96 offen offset:0 sc1
  v_fma_f32 v79, v79, v69, v68
  v_rcp_f32 v73, v73
  v_mul_f32 v78, v78, v54
  v_mul_f32 v61, v61, v53
  v_fma_f32 v75, v75, v70, v70
  v_exp_f32 v77, v77
  v_mul_f32 v56, v56, v72
  v_rcp_f32 v74, v74
  v_mul_f32 v79, v79, v55
  v_mul_f32 v62, v62, v54
  v_fma_f32 v76, v76, v70, v70
  v_mfma_f32_32x32x16_bf16 v[32:47], v[180:183], a[24:27], v[32:47]
  buffer_load_dwordx4 v[100:103], v9, s[8:11], s96 offen offset:1024 sc1
  v_exp_f32 v78, v78
  v_mul_f32 v57, v57, v73
  v_rcp_f32 v75, v75
  v_mul_f32 v63, v63, v55
  v_fma_f32 v77, v77, v70, v70
  v_exp_f32 v79, v79
  v_mul_f32 v58, v58, v74
  v_cvt_pk_bf16_f32 v80, v56, v57
  v_rcp_f32 v76, v76
  v_fma_f32 v78, v78, v70, v70
  v_mfma_f32_32x32x16_bf16 v[116:131], v[180:183], a[28:31], v[116:131]
  v_mul_f32 v59, v59, v75
  v_rcp_f32 v77, v77
  v_fma_f32 v79, v79, v70, v70
  v_mul_f32 v60, v60, v76
  v_cvt_pk_bf16_f32 v81, v58, v59
  v_rcp_f32 v78, v78
  v_mul_f32 v61, v61, v77
  v_rcp_f32 v79, v79
  v_mul_f32 v62, v62, v78
  v_cvt_pk_bf16_f32 v82, v60, v61
  v_mul_f32 v63, v63, v79
  v_cvt_pk_bf16_f32 v83, v62, v63
  s_add_u32 s98, s45, 0x006f4000
  buffer_store_dwordx4 v[80:83], v9, s[24:27], s98 offen sc1
  v_mfma_f32_32x32x16_bf16 v[32:47], v[184:187], a[32:35], v[32:47]
  v_mfma_f32_32x32x16_bf16 v[116:131], v[184:187], a[36:39], v[116:131]
  buffer_load_dwordx4 v[104:107], v9, s[8:11], s96 offen offset:2048 sc1
  v_mfma_f32_32x32x16_bf16 v[32:47], v[188:191], a[40:43], v[32:47]
  s_waitcnt vmcnt(13)
  v_max3_u32 v136, v192, v196, v200
  v_cmp_eq_u32 vcc, -1, v136
  s_and_b64 vcc, vcc, s[56:57]
  s_cbranch_scc1 H_r002
H_b002:
  buffer_load_dwordx4 v[108:111], v9, s[8:11], s96 offen offset:3072 sc1
  v_mfma_f32_32x32x16_bf16 v[116:131], v[188:191], a[44:47], v[116:131]
  v_mfma_f32_32x32x16_bf16 v[32:47], v[192:195], a[48:51], v[32:47]
  v_mfma_f32_32x32x16_bf16 v[116:131], v[192:195], a[52:55], v[116:131]
  s_add_u32 s96, s46, 0x00439000
  buffer_load_dwordx4 v[112:115], v9, s[8:11], s96 offen offset:0 sc1
  v_mfma_f32_32x32x16_bf16 v[32:47], v[196:199], a[56:59], v[32:47]
  buffer_load_dwordx4 v[160:163], v9, s[8:11], s96 offen offset:1024 sc1
  v_mfma_f32_32x32x16_bf16 v[116:131], v[196:199], a[60:63], v[116:131]
  v_mfma_f32_32x32x16_bf16 v[32:47], v[200:203], a[64:67], v[32:47]
  s_waitcnt vmcnt(13)
  v_max3_u32 v136, v140, v144, v148
  v_cmp_eq_u32 vcc, -1, v136
  s_and_b64 vcc, vcc, s[56:57]
  s_cbranch_scc1 H_r003
H_b003:
  v_mfma_f32_32x32x16_bf16 v[116:131], v[200:203], a[68:71], v[116:131]
  v_mfma_f32_32x32x16_bf16 v[32:47], v[140:143], a[72:75], v[32:47]
  v_mfma_f32_32x32x16_bf16 v[116:131], v[140:143], a[76:79], v[116:131]
  v_mfma_f32_32x32x16_bf16 v[32:47], v[144:147], a[80:83], v[32:47]
  v_mfma_f32_32x32x16_bf16 v[116:131], v[144:147], a[84:87], v[116:131]
  v_mfma_f32_32x32x16_bf16 v[32:47], v[148:151], a[88:91], v[32:47]
  s_waitcnt vmcnt(8)
  v_max3_u32 v136, v152, v84, v88
  v_cmp_eq_u32 vcc, -1, v136
  s_and_b64 vcc, vcc, s[56:57]
  s_cbranch_scc1 H_r004
H_b004:
  v_mfma_f32_32x32x16_bf16 v[116:131], v[148:151], a[92:95], v[116:131]
  v_mfma_f32_32x32x16_bf16 v[32:47], v[152:155], a[96:99], v[32:47]
  v_mfma_f32_32x32x16_bf16 v[116:131], v[152:155], a[100:103], v[116:131]
  v_mfma_f32_32x32x16_bf16 v[32:47], v[84:87], a[104:107], v[32:47]
  v_mfma_f32_32x32x16_bf16 v[116:131], v[84:87], a[108:111], v[116:131]
  v_mfma_f32_32x32x16_bf16 v[32:47], v[88:91], a[112:115], v[32:47]
  s_waitcnt vmcnt(5)
  v_max3_u32 v136, v92, v96, v100
  v_cmp_eq_u32 vcc, -1, v136
  s_and_b64 vcc, vcc, s[56:57]
  s_cbranch_scc1 H_r005
H_b005:
  v_mfma_f32_32x32x16_bf16 v[116:131], v[88:91], a[116:119], v[116:131]
  v_mfma_f32_32x32x16_bf16 v[32:47], v[92:95], a[120:123], v[32:47]
  v_mfma_f32_32x32x16_bf16 v[116:131], v[92:95], a[124:127], v[116:131]
  v_mfma_f32_32x32x16_bf16 v[32:47], v[96:99], a[128:131], v[32:47]
  v_mfma_f32_32x32x16_bf16 v[116:131], v[96:99], a[132:135], v[116:131]
  v_mfma_f32_32x32x16_bf16 v[32:47], v[100:103], a[136:139], v[32:47]
  s_waitcnt vmcnt(0)
  v_max3_u32 v136, v104, v108, v112
  v_max_u32 v136, v136, v160
  v_cmp_eq_u32 vcc, -1, v136
  s_and_b64 vcc, vcc, s[56:57]
  s_cbranch_scc1 H_r006
H_b006:
  v_mfma_f32_32x32x16_bf16 v[116:131], v[100:103], a[140:143], v[116:131]
  v_mfma_f32_32x32x16_bf16 v[32:47], v[104:107], a[144:147], v[32:47]
  v_mfma_f32_32x32x16_bf16 v[116:131], v[104:107], a[148:151], v[116:131]
  v_mfma_f32_32x32x16_bf16 v[32:47], v[108:111], a[152:155], v[32:47]
  v_mfma_f32_32x32x16_bf16 v[116:131], v[108:111], a[156:159], v[116:131]
  v_mfma_f32_32x32x16_bf16 v[32:47], v[112:115], a[160:163], v[32:47]
  v_mfma_f32_32x32x16_bf16 v[116:131], v[112:115], a[164:167], v[116:131]
  v_mfma_f32_32x32x16_bf16 v[32:47], v[160:163], a[168:171], v[32:47]
  v_mfma_f32_32x32x16_bf16 v[116:131], v[160:163], a[172:175], v[116:131]
  v_and_b32 v65, 0xffff0000, v132
  v_lshlrev_b32 v64, 16, v132
  v_and_b32 v67, 0xffff0000, v133
  v_lshlrev_b32 v66, 16, v133
  v_and_b32 v69, 0xffff0000, v134
  v_lshlrev_b32 v68, 16, v134
  v_and_b32 v71, 0xffff0000, v135
  v_lshlrev_b32 v70, 16, v135
  s_nop 2
  ds_write_b128 v13, v[32:35] offset:0
  ds_write_b128 v13, v[36:39] offset:1088
  ds_write_b128 v13, v[40:43] offset:2176
  s_add_u32 s96, s46, 0x006f4000
  buffer_load_dwordx4 v[168:171], v9, s[8:11], s96 offen offset:0 sc1
  ds_write_b128 v13, v[44:47] offset:3264
  ds_write_b128 v13, v[116:119] offset:4352
  ds_write_b128 v13, v[120:123] offset:5440
  ds_write_b128 v13, v[124:127] offset:6528
  buffer_load_dwordx4 v[172:175], v9, s[8:11], s96 offen offset:1024 sc1
  ds_write_b128 v13, v[128:131] offset:7616
  s_waitcnt lgkmcnt(0)
  s_barrier
  ds_read_b128 v[32:35], v14 offset:0
  buffer_load_dwordx4 v[176:179], v9, s[8:11], s96 offen offset:2048 sc1
  ds_read_b128 v[36:39], v14 offset:512
  ds_read_b128 v[40:43], v14 offset:8704
  ds_read_b128 v[44:47], v14 offset:9216
  ds_read_b128 v[48:51], v14 offset:17408
  buffer_load_dwordx4 v[180:183], v9, s[8:11], s96 offen offset:3072 sc1
  ds_read_b128 v[52:55], v14 offset:17920
  ds_read_b128 v[56:59], v14 offset:26112
  ds_read_b128 v[60:63], v14 offset:26624
  s_waitcnt lgkmcnt(4)
  s_add_u32 s96, s46, 0x006f5000
  buffer_load_dwordx4 v[184:187], v9, s[8:11], s96 offen offset:0 sc1
  v_pk_add_f32 v[32:33], v[32:33], v[40:41]
  v_pk_add_f32 v[34:35], v[34:35], v[42:43]
  v_pk_add_f32 v[36:37], v[36:37], v[44:45]
  v_pk_add_f32 v[38:39], v[38:39], v[46:47]
  buffer_load_dwordx4 v[188:191], v9, s[8:11], s96 offen offset:1024 sc1
  s_waitcnt lgkmcnt(0)
  v_pk_add_f32 v[48:49], v[48:49], v[56:57]
  v_pk_add_f32 v[50:51], v[50:51], v[58:59]
  buffer_load_dwordx4 v[192:195], v9, s[8:11], s96 offen offset:2048 sc1
  v_pk_add_f32 v[52:53], v[52:53], v[60:61]
  v_pk_add_f32 v[54:55], v[54:55], v[62:63]
  v_pk_add_f32 v[32:33], v[32:33], v[48:49]
  v_pk_add_f32 v[34:35], v[34:35], v[50:51]
  buffer_load_dwordx4 v[196:199], v9, s[8:11], s96 offen offset:3072 sc1
  v_pk_add_f32 v[36:37], v[36:37], v[52:53]
  v_pk_add_f32 v[38:39], v[38:39], v[54:55]
  v_cvt_pk_bf16_f32 v32, 0, v32
  v_cvt_pk_bf16_f32 v33, 0, v33
  s_add_u32 s96, s46, 0x006f6000
  buffer_load_dwordx4 v[200:203], v9, s[8:11], s96 offen offset:0 sc1
  v_cvt_pk_bf16_f32 v34, 0, v34
  v_cvt_pk_bf16_f32 v35, 0, v35
  v_cvt_pk_bf16_f32 v36, 0, v36
  v_cvt_pk_bf16_f32 v37, 0, v37
  buffer_load_dwordx4 v[140:143], v9, s[8:11], s96 offen offset:1024 sc1
  v_cvt_pk_bf16_f32 v38, 0, v38
  v_cvt_pk_bf16_f32 v39, 0, v39
  v_pk_add_f32 v[32:33], v[32:33], v[64:65]
  v_pk_add_f32 v[34:35], v[34:35], v[66:67]
  buffer_load_dwordx4 v[144:147], v9, s[8:11], s96 offen offset:2048 sc1
  v_pk_add_f32 v[36:37], v[36:37], v[68:69]
  v_pk_add_f32 v[38:39], v[38:39], v[70:71]
  v_cvt_pk_bf16_f32 v80, v32, v33
  v_cvt_pk_bf16_f32 v81, v34, v35
  buffer_load_dwordx4 v[148:151], v9, s[8:11], s96 offen offset:3072 sc1
  v_cvt_pk_bf16_f32 v82, v36, v37
  v_cvt_pk_bf16_f32 v83, v38, v39
  ds_write_b128 v17, v[80:83]
  s_add_u32 s96, s46, 0x006f7000
  buffer_load_dwordx4 v[152:155], v9, s[8:11], s96 offen offset:0 sc1
  s_add_u32 s98, s47, 0x00200000
s_branch Ia5x
Ia5:
s_branch Iar
Ia5x:
  buffer_store_dwordx4 v[80:83], v16, s[8:11], s98 offen sc1
  s_waitcnt lgkmcnt(0)
  s_barrier
  ds_read_b64_tr_b16 v[32:33], v18 offset:0
  buffer_load_dwordx4 v[84:87], v9, s[8:11], s96 offen offset:1024 sc1
  ds_read_b64_tr_b16 v[34:35], v18 offset:256
  ds_read_b64_tr_b16 v[36:37], v18 offset:1024
  ds_read_b64_tr_b16 v[38:39], v18 offset:1280
  ds_read_b64_tr_b16 v[40:41], v18 offset:2048
  buffer_load_dwordx4 v[88:91], v9, s[8:11], s96 offen offset:2048 sc1
  ds_read_b64_tr_b16 v[42:43], v18 offset:2304
  ds_read_b64_tr_b16 v[44:45], v18 offset:3072
  ds_read_b64_tr_b16 v[46:47], v18 offset:3328
  s_add_u32 s98, s50, 0x00400000
  buffer_load_dwordx4 v[92:95], v9, s[8:11], s96 offen offset:3072 sc1
  s_waitcnt lgkmcnt(0)
  v_mfma_f32_4x4x4_16b_bf16 v[48:51], v[32:33], v[32:33], 0
  v_mfma_f32_4x4x4_16b_bf16 v[52:55], v[22:23], v[32:33], 0
  v_mfma_f32_4x4x4_16b_bf16 v[56:59], v[34:35], v[34:35], 0
  s_add_u32 s96, s46, 0x006f8000
  buffer_load_dwordx4 v[96:99], v9, s[8:11], s96 offen offset:0 sc1
  v_mfma_f32_4x4x4_16b_bf16 v[60:63], v[22:23], v[34:35], 0
  v_mfma_f32_4x4x4_16b_bf16 v[48:51], v[36:37], v[36:37], v[48:51]
  v_mfma_f32_4x4x4_16b_bf16 v[52:55], v[22:23], v[36:37], v[52:55]
  v_mfma_f32_4x4x4_16b_bf16 v[56:59], v[38:39], v[38:39], v[56:59]
  buffer_load_dwordx4 v[100:103], v9, s[8:11], s96 offen offset:1024 sc1
  v_mfma_f32_4x4x4_16b_bf16 v[60:63], v[22:23], v[38:39], v[60:63]
  v_mfma_f32_4x4x4_16b_bf16 v[48:51], v[40:41], v[40:41], v[48:51]
  v_mfma_f32_4x4x4_16b_bf16 v[52:55], v[22:23], v[40:41], v[52:55]
  v_mfma_f32_4x4x4_16b_bf16 v[56:59], v[42:43], v[42:43], v[56:59]
  v_mfma_f32_4x4x4_16b_bf16 v[60:63], v[22:23], v[42:43], v[60:63]
  v_mfma_f32_4x4x4_16b_bf16 v[48:51], v[44:45], v[44:45], v[48:51]
  v_mfma_f32_4x4x4_16b_bf16 v[52:55], v[22:23], v[44:45], v[52:55]
  v_mfma_f32_4x4x4_16b_bf16 v[56:59], v[46:47], v[46:47], v[56:59]
  v_mfma_f32_4x4x4_16b_bf16 v[60:63], v[22:23], v[46:47], v[60:63]
  s_nop 4
  v_add_f32 v48, v48, v56
  v_add_f32 v49, v49, v57
  v_add_f32 v50, v50, v58
  v_add_f32 v51, v51, v59
  v_add_f32 v52, v52, v60
  v_cndmask_b32 v48, v48, v49, s[62:63]
  v_cndmask_b32 v50, v50, v51, s[62:63]
  v_cndmask_b32 v48, v48, v50, s[64:65]
  s_nop 1
  v_permlane32_swap_b32 v52, v48
  s_nop 0
  v_add_f32 v52, v52, v48
  v_mul_f32 v52, 0x3b000000, v52
  buffer_store_dword v52, v19, s[8:11], s98 offen sc1
  s_waitcnt vmcnt(17)
  v_max3_u32 v136, v168, v172, v176
  v_cmp_eq_u32 vcc, -1, v136
  s_and_b64 vcc, vcc, s[56:57]
  s_cbranch_scc1 H_r010
H_b010:
  v_mfma_f32_32x32x16_bf16 v[32:47], v[168:171], a[0:3], 0
  s_add_u32 s98, s47, 0x00100000
  buffer_load_dwordx4 v[132:135], v16, s[8:11], s98 offen sc1
  v_mfma_f32_32x32x16_bf16 v[116:131], v[168:171], a[4:7], 0
  buffer_load_dwordx4 v[104:107], v9, s[8:11], s96 offen offset:2048 sc1
  v_mov_b64 v[48:49], -1
  v_mov_b64 v[50:51], -1
  v_mfma_f32_32x32x16_bf16 v[32:47], v[172:175], a[8:11], v[32:47]
  buffer_load_dwordx4 v[108:111], v9, s[8:11], s96 offen offset:3072 sc1
  v_mfma_f32_32x32x16_bf16 v[116:131], v[172:175], a[12:15], v[116:131]
  v_mfma_f32_32x32x16_bf16 v[32:47], v[176:179], a[16:19], v[32:47]
  s_waitcnt vmcnt(17)
  v_max3_u32 v136, v180, v184, v188
  v_cmp_eq_u32 vcc, -1, v136
  s_and_b64 vcc, vcc, s[56:57]
  s_cbranch_scc1 H_r011
H_b011:
  v_mfma_f32_32x32x16_bf16 v[116:131], v[176:179], a[20:23], v[116:131]
  s_add_u32 s96, s46, 0x006f9000
  buffer_load_dwordx4 v[112:115], v9, s[8:11], s96 offen offset:0 sc1
  v_mfma_f32_32x32x16_bf16 v[32:47], v[180:183], a[24:27], v[32:47]
  buffer_load_dwordx4 v[160:163], v9, s[8:11], s96 offen offset:1024 sc1
  v_mfma_f32_32x32x16_bf16 v[116:131], v[180:183], a[28:31], v[116:131]
  v_mfma_f32_32x32x16_bf16 v[32:47], v[184:187], a[32:35], v[32:47]
  v_mfma_f32_32x32x16_bf16 v[116:131], v[184:187], a[36:39], v[116:131]
  v_mfma_f32_32x32x16_bf16 v[32:47], v[188:191], a[40:43], v[32:47]
  s_waitcnt vmcnt(16)
  v_max3_u32 v136, v192, v196, v200
  v_cmp_eq_u32 vcc, -1, v136
  s_and_b64 vcc, vcc, s[56:57]
  s_cbranch_scc1 H_r012
H_b012:
  v_mfma_f32_32x32x16_bf16 v[116:131], v[188:191], a[44:47], v[116:131]
  v_mfma_f32_32x32x16_bf16 v[32:47], v[192:195], a[48:51], v[32:47]
  v_mfma_f32_32x32x16_bf16 v[116:131], v[192:195], a[52:55], v[116:131]
  v_mfma_f32_32x32x16_bf16 v[32:47], v[196:199], a[56:59], v[32:47]
  v_mfma_f32_32x32x16_bf16 v[116:131], v[196:199], a[60:63], v[116:131]
  v_mfma_f32_32x32x16_bf16 v[32:47], v[200:203], a[64:67], v[32:47]
  s_waitcnt vmcnt(13)
  v_max3_u32 v136, v140, v144, v148
  v_cmp_eq_u32 vcc, -1, v136
  s_and_b64 vcc, vcc, s[56:57]
  s_cbranch_scc1 H_r013
H_b013:
  v_mfma_f32_32x32x16_bf16 v[116:131], v[200:203], a[68:71], v[116:131]
  v_mfma_f32_32x32x16_bf16 v[32:47], v[140:143], a[72:75], v[32:47]
  v_mfma_f32_32x32x16_bf16 v[116:131], v[140:143], a[76:79], v[116:131]
  v_mfma_f32_32x32x16_bf16 v[32:47], v[144:147], a[80:83], v[32:47]
  buffer_load_dword v176, v5, s[8:11], s28 offen sc1
  buffer_load_dword v177, v5, s[8:11], s29 offen sc1
  v_mfma_f32_32x32x16_bf16 v[116:131], v[144:147], a[84:87], v[116:131]
  buffer_load_dword v178, v5, s[8:11], s30 offen sc1
  buffer_load_dword v179, v5, s[8:11], s31 offen sc1
  v_mfma_f32_32x32x16_bf16 v[32:47], v[148:151], a[88:91], v[32:47]
  s_waitcnt vmcnt(13)
  v_max3_u32 v136, v152, v84, v88
  v_cmp_eq_u32 vcc, -1, v136
  s_and_b64 vcc, vcc, s[56:57]
  s_cbranch_scc1 H_r014
H_b014:
  buffer_load_dword v180, v5, s[8:11], s32 offen sc1
  buffer_load_dword v181, v5, s[8:11], s33 offen sc1
  v_mfma_f32_32x32x16_bf16 v[116:131], v[148:151], a[92:95], v[116:131]
  buffer_load_dword v182, v5, s[8:11], s34 offen sc1
  buffer_load_dword v183, v5, s[8:11], s35 offen sc1
  v_mfma_f32_32x32x16_bf16 v[32:47], v[152:155], a[96:99], v[32:47]
  v_mfma_f32_32x32x16_bf16 v[116:131], v[152:155], a[100:103], v[116:131]
  v_mfma_f32_32x32x16_bf16 v[32:47], v[84:87], a[104:107], v[32:47]
  s_add_u32 s97, s43, 0x00c00000
  buffer_store_dwordx4 v[48:51], v9, s[20:23], s97 offen sc1
  v_mfma_f32_32x32x16_bf16 v[116:131], v[84:87], a[108:111], v[116:131]
  v_mfma_f32_32x32x16_bf16 v[32:47], v[88:91], a[112:115], v[32:47]
  s_waitcnt vmcnt(15)
  v_max3_u32 v136, v92, v96, v100
  v_cmp_eq_u32 vcc, -1, v136
  s_and_b64 vcc, vcc, s[56:57]
  s_cbranch_scc1 H_r015
H_b015:
  v_mfma_f32_32x32x16_bf16 v[116:131], v[88:91], a[116:119], v[116:131]
  s_add_u32 s97, s44, 0x00c00000
  buffer_store_dwordx4 v[48:51], v9, s[20:23], s97 offen sc1
  v_mfma_f32_32x32x16_bf16 v[32:47], v[92:95], a[120:123], v[32:47]
  v_mfma_f32_32x32x16_bf16 v[116:131], v[92:95], a[124:127], v[116:131]
  v_mfma_f32_32x32x16_bf16 v[32:47], v[96:99], a[128:131], v[32:47]
  v_mfma_f32_32x32x16_bf16 v[116:131], v[96:99], a[132:135], v[116:131]
  s_add_u32 s97, s45, 0x00c00000
  buffer_store_dwordx4 v[48:51], v9, s[24:27], s97 offen sc1
  v_mfma_f32_32x32x16_bf16 v[32:47], v[100:103], a[136:139], v[32:47]
  s_waitcnt vmcnt(11)
  v_max3_u32 v136, v104, v108, v112
  v_max_u32 v136, v136, v160
  v_cmp_eq_u32 vcc, -1, v136
  s_and_b64 vcc, vcc, s[56:57]
  s_cbranch_scc1 H_r016
H_b016:
  v_mfma_f32_32x32x16_bf16 v[116:131], v[100:103], a[140:143], v[116:131]
  v_mfma_f32_32x32x16_bf16 v[32:47], v[104:107], a[144:147], v[32:47]
  s_waitcnt vmcnt(3)
CB_c0:
  v_pk_add_f32 v[176:177], v[176:177], v[180:181]
  v_pk_add_f32 v[178:179], v[178:179], v[182:183]
  v_pk_add_f32 v[176:177], v[176:177], v[178:179]
  v_add_f32 v176, v176, v177
  v_cmp_u_f32 vcc, v176, v176
  s_and_b64 vcc, vcc, s[56:57]
  s_cbranch_scc1 CB_r0
  v_mov_b32 v177, v176
  v_mfma_f32_32x32x16_bf16 v[116:131], v[104:107], a[148:151], v[116:131]
  s_nop 0
  v_permlane32_swap_b32 v176, v177
  v_mfma_f32_32x32x16_bf16 v[32:47], v[108:111], a[152:155], v[32:47]
  v_fma_f32 v177, -v176, v176, v177
  v_cvt_pk_bf16_f32 v177, 0, |v177|
  v_add_f32 v177, 0x3727c5ac, v177
  v_mfma_f32_32x32x16_bf16 v[116:131], v[108:111], a[156:159], v[116:131]
  v_cvt_pk_bf16_f32 v177, 0, v177
  v_sqrt_f32 v177, v177
  v_mfma_f32_32x32x16_bf16 v[32:47], v[112:115], a[160:163], v[32:47]
  s_mov_b32 s3, 0x00430000
  v_cvt_pk_bf16_f32 v176, v176, v177
  s_mov_b32 exec_hi, 0
  buffer_store_dword v176, v5, s[8:11], s3 offen sc1
  s_mov_b32 exec_hi, -1
  v_mfma_f32_32x32x16_bf16 v[116:131], v[112:115], a[164:167], v[116:131]
  v_mfma_f32_32x32x16_bf16 v[32:47], v[160:163], a[168:171], v[32:47]
  v_mfma_f32_32x32x16_bf16 v[116:131], v[160:163], a[172:175], v[116:131]
  v_and_b32 v65, 0xffff0000, v132
  v_lshlrev_b32 v64, 16, v132
  v_and_b32 v67, 0xffff0000, v133
  v_lshlrev_b32 v66, 16, v133
  v_and_b32 v69, 0xffff0000, v134
  v_lshlrev_b32 v68, 16, v134
  v_and_b32 v71, 0xffff0000, v135
  v_lshlrev_b32 v70, 16, v135
  s_nop 2
  ds_write_b128 v13, v[32:35] offset:0
  ds_write_b128 v13, v[36:39] offset:1088
  ds_write_b128 v13, v[40:43] offset:2176
  ds_write_b128 v13, v[44:47] offset:3264
  ds_write_b128 v13, v[116:119] offset:4352
  ds_write_b128 v13, v[120:123] offset:5440
  ds_write_b128 v13, v[124:127] offset:6528
  ds_write_b128 v13, v[128:131] offset:7616
  s_waitcnt lgkmcnt(0)
  s_barrier
  ds_read_b128 v[32:35], v14 offset:0
  ds_read_b128 v[36:39], v14 offset:512
  ds_read_b128 v[40:43], v14 offset:8704
  ds_read_b128 v[44:47], v14 offset:9216
  ds_read_b128 v[48:51], v14 offset:17408
  ds_read_b128 v[52:55], v14 offset:17920
  ds_read_b128 v[56:59], v14 offset:26112
  ds_read_b128 v[60:63], v14 offset:26624
  s_waitcnt lgkmcnt(4)
  v_pk_add_f32 v[32:33], v[32:33], v[40:41]
  v_pk_add_f32 v[34:35], v[34:35], v[42:43]
  s_add_u32 s96, s36, 0x00200000
  buffer_load_dwordx4 v[168:171], v3, s[8:11], s96 offen sc1
  v_pk_add_f32 v[36:37], v[36:37], v[44:45]
  v_pk_add_f32 v[38:39], v[38:39], v[46:47]
  s_waitcnt lgkmcnt(0)
  v_pk_add_f32 v[48:49], v[48:49], v[56:57]
  v_pk_add_f32 v[50:51], v[50:51], v[58:59]
  v_pk_add_f32 v[52:53], v[52:53], v[60:61]
  v_pk_add_f32 v[54:55], v[54:55], v[62:63]
  v_pk_add_f32 v[32:33], v[32:33], v[48:49]
  v_pk_add_f32 v[34:35], v[34:35], v[50:51]
  v_pk_add_f32 v[36:37], v[36:37], v[52:53]
  v_pk_add_f32 v[38:39], v[38:39], v[54:55]
  v_cvt_pk_bf16_f32 v32, 0, v32
  v_cvt_pk_bf16_f32 v33, 0, v33
  v_cvt_pk_bf16_f32 v34, 0, v34
  v_cvt_pk_bf16_f32 v35, 0, v35
  v_cvt_pk_bf16_f32 v36, 0, v36
  v_cvt_pk_bf16_f32 v37, 0, v37
  v_cvt_pk_bf16_f32 v38, 0, v38
  v_cvt_pk_bf16_f32 v39, 0, v39
  v_pk_add_f32 v[32:33], v[32:33], v[64:65]
  v_pk_add_f32 v[34:35], v[34:35], v[66:67]
  v_pk_add_f32 v[36:37], v[36:37], v[68:69]
  v_pk_add_f32 v[38:39], v[38:39], v[70:71]
  v_cvt_pk_bf16_f32 v80, v32, v33
  v_cvt_pk_bf16_f32 v81, v34, v35
  v_cvt_pk_bf16_f32 v82, v36, v37
  v_cvt_pk_bf16_f32 v83, v38, v39
  ds_write_b128 v17, v[80:83]
  s_add_u32 s98, s47, 0x00300000
  buffer_store_dwordx4 v[80:83], v16, s[8:11], s98 offen sc1
  s_waitcnt lgkmcnt(0)
  s_barrier
  ds_read_b64_tr_b16 v[32:33], v18 offset:0
  ds_read_b64_tr_b16 v[34:35], v18 offset:256
  ds_read_b64_tr_b16 v[36:37], v18 offset:1024
  ds_read_b64_tr_b16 v[38:39], v18 offset:1280
  ds_read_b64_tr_b16 v[40:41], v18 offset:2048
  ds_read_b64_tr_b16 v[42:43], v18 offset:2304
  ds_read_b64_tr_b16 v[44:45], v18 offset:3072
  ds_read_b64_tr_b16 v[46:47], v18 offset:3328
  s_add_u32 s98, s50, 0x00402000
  s_waitcnt lgkmcnt(0)
  v_mfma_f32_4x4x4_16b_bf16 v[48:51], v[32:33], v[32:33], 0
  v_mfma_f32_4x4x4_16b_bf16 v[52:55], v[22:23], v[32:33], 0
  v_mfma_f32_4x4x4_16b_bf16 v[56:59], v[34:35], v[34:35], 0
  v_mfma_f32_4x4x4_16b_bf16 v[60:63], v[22:23], v[34:35], 0
  v_mfma_f32_4x4x4_16b_bf16 v[48:51], v[36:37], v[36:37], v[48:51]
  v_mfma_f32_4x4x4_16b_bf16 v[52:55], v[22:23], v[36:37], v[52:55]
  v_mfma_f32_4x4x4_16b_bf16 v[56:59], v[38:39], v[38:39], v[56:59]
  v_mfma_f32_4x4x4_16b_bf16 v[60:63], v[22:23], v[38:39], v[60:63]
  v_mfma_f32_4x4x4_16b_bf16 v[48:51], v[40:41], v[40:41], v[48:51]
  s_mov_b32 s3, 0x00430000
  buffer_load_dwordx4 v[172:175], v4, s[8:11], s3 offen sc1
  v_mfma_f32_4x4x4_16b_bf16 v[52:55], v[22:23], v[40:41], v[52:55]
  v_mfma_f32_4x4x4_16b_bf16 v[56:59], v[42:43], v[42:43], v[56:59]
  v_mfma_f32_4x4x4_16b_bf16 v[60:63], v[22:23], v[42:43], v[60:63]
  v_mfma_f32_4x4x4_16b_bf16 v[48:51], v[44:45], v[44:45], v[48:51]
  v_mfma_f32_4x4x4_16b_bf16 v[52:55], v[22:23], v[44:45], v[52:55]
  v_mfma_f32_4x4x4_16b_bf16 v[56:59], v[46:47], v[46:47], v[56:59]
  v_mfma_f32_4x4x4_16b_bf16 v[60:63], v[22:23], v[46:47], v[60:63]
  s_nop 4
  v_add_f32 v48, v48, v56
  v_add_f32 v49, v49, v57
  v_add_f32 v50, v50, v58
  v_add_f32 v51, v51, v59
  v_add_f32 v52, v52, v60
  v_cndmask_b32 v48, v48, v49, s[62:63]
  v_cndmask_b32 v50, v50, v51, s[62:63]
  v_cndmask_b32 v48, v48, v50, s[64:65]
  s_nop 1
  v_permlane32_swap_b32 v52, v48
  s_nop 0
  v_add_f32 v52, v52, v48
  v_mul_f32 v52, 0x3b000000, v52
  buffer_store_dword v52, v19, s[8:11], s98 offen sc1
  s_cmp_eq_u32 s6, 0
  s_cbranch_scc1 Ib0
  s_cmp_eq_u32 s6, 1
  s_cbranch_scc1 Ib1
  s_cmp_eq_u32 s6, 2
  s_cbranch_scc1 Ib2
  s_branch Ib3
Ibr:
  s_waitcnt vmcnt(1)
C_chk0:
  v_max3_u32 v32, v168, v172, v173
  v_max3_u32 v32, v32, v174, v175
  v_cmp_eq_u32 vcc, -1, v32
  s_and_b64 vcc, vcc, s[56:57]
  s_cbranch_scc1 C_retry0
  s_mov_b64 exec, -1
  v_and_b32 v41, 0xffff0000, v172
  v_lshlrev_b32 v40, 16, v172
  v_and_b32 v43, 0xffff0000, v173
  v_lshlrev_b32 v42, 16, v173
  v_and_b32 v45, 0xffff0000, v174
  v_lshlrev_b32 v44, 16, v174
  v_and_b32 v47, 0xffff0000, v175
  v_lshlrev_b32 v46, 16, v175
  v_rcp_f32 v41, v41
  v_rcp_f32 v43, v43
  v_rcp_f32 v45, v45
  v_rcp_f32 v47, v47
  v_and_b32 v65, 0xffff0000, v168
  v_lshlrev_b32 v64, 16, v168
  v_and_b32 v67, 0xffff0000, v169
  v_lshlrev_b32 v66, 16, v169
  v_and_b32 v69, 0xffff0000, v170
  v_lshlrev_b32 v68, 16, v170
  v_and_b32 v71, 0xffff0000, v171
  v_lshlrev_b32 v70, 16, v171
  v_subrev_f32_dpp v32, v40, v64 quad_perm:[0,0,2,2] row_mask:0xf bank_mask:0xf
  v_subrev_f32_dpp v33, v42, v65 quad_perm:[0,0,2,2] row_mask:0xf bank_mask:0xf
  v_subrev_f32_dpp v34, v44, v66 quad_perm:[0,0,2,2] row_mask:0xf bank_mask:0xf
  v_subrev_f32_dpp v35, v46, v67 quad_perm:[0,0,2,2] row_mask:0xf bank_mask:0xf
  v_subrev_f32_dpp v36, v40, v68 quad_perm:[1,1,3,3] row_mask:0xf bank_mask:0xf
  v_subrev_f32_dpp v37, v42, v69 quad_perm:[1,1,3,3] row_mask:0xf bank_mask:0xf
  v_subrev_f32_dpp v38, v44, v70 quad_perm:[1,1,3,3] row_mask:0xf bank_mask:0xf
  v_subrev_f32_dpp v39, v46, v71 quad_perm:[1,1,3,3] row_mask:0xf bank_mask:0xf
  v_cvt_pk_bf16_f32 v32, 0, v32
  v_cvt_pk_bf16_f32 v33, 0, v33
  v_cvt_pk_bf16_f32 v34, 0, v34
  v_cvt_pk_bf16_f32 v35, 0, v35
  v_cvt_pk_bf16_f32 v36, 0, v36
  v_cvt_pk_bf16_f32 v37, 0, v37
  v_cvt_pk_bf16_f32 v38, 0, v38
  v_cvt_pk_bf16_f32 v39, 0, v39
  v_mul_f32_dpp v32, v41, v32 quad_perm:[0,0,2,2] row_mask:0xf bank_mask:0xf
  v_mul_f32_dpp v33, v43, v33 quad_perm:[0,0,2,2] row_mask:0xf bank_mask:0xf
  v_mul_f32_dpp v34, v45, v34 quad_perm:[0,0,2,2] row_mask:0xf bank_mask:0xf
  v_mul_f32_dpp v35, v47, v35 quad_perm:[0,0,2,2] row_mask:0xf bank_mask:0xf
  v_mul_f32_dpp v36, v41, v36 quad_perm:[1,1,3,3] row_mask:0xf bank_mask:0xf
  v_mul_f32_dpp v37, v43, v37 quad_perm:[1,1,3,3] row_mask:0xf bank_mask:0xf
  v_mul_f32_dpp v38, v45, v38 quad_perm:[1,1,3,3] row_mask:0xf bank_mask:0xf
  v_mul_f32_dpp v39, v47, v39 quad_perm:[1,1,3,3] row_mask:0xf bank_mask:0xf
  v_cvt_pk_bf16_f32 v80, v32, v33
  v_cvt_pk_bf16_f32 v81, v34, v35
  v_cvt_pk_bf16_f32 v82, v36, v37
  v_cvt_pk_bf16_f32 v83, v38, v39
  ds_write_b128 v6, v[80:83] offset:0
  s_waitcnt lgkmcnt(0)
  s_barrier
  ds_read_b64 v[100:101], v1 offset:3776
  ds_read_b64 v[102:103], v1 offset:3784
  ds_read_b128 v[104:107], v2 offset:1728
  ds_read_b128 v[108:111], v2 offset:1216
  ds_read_b64 v[112:113], v1 offset:3264
  ds_read_b64 v[114:115], v1 offset:3272
  ds_read_b128 v[116:119], v2 offset:704
  ds_read_b64 v[120:121], v1 offset:2752
  ds_read_b64 v[122:123], v1 offset:2760
  s_waitcnt lgkmcnt(6)
  v_mfma_f32_16x16x32_bf16 v[44:47], v[100:103], v[104:107], 0
  ds_read_b128 v[124:127], v2 offset:192
  ds_read_b64 v[128:129], v1 offset:2240
  v_and_b32 v73, 0xffff0000, v80
  v_add_u32 v5, 0x2000, v5
  buffer_load_dword v176, v5, s[8:11], s28 offen sc1
  s_waitcnt lgkmcnt(7)
  v_mfma_f32_16x16x32_bf16 v[40:43], v[100:103], v[108:111], 0
  ds_read_b64 v[130:131], v1 offset:2248
  ds_read_b64 v[132:133], v1 offset:3712
  buffer_load_dword v177, v5, s[8:11], s29 offen sc1
  buffer_load_dword v178, v5, s[8:11], s30 offen sc1
  s_waitcnt lgkmcnt(7)
  v_mfma_f32_16x16x32_bf16 v[44:47], v[112:115], v[108:111], v[44:47]
  ds_read_b64 v[134:135], v1 offset:3720
  ds_read_b128 v[136:139], v2 offset:1664
  v_lshlrev_b32 v72, 16, v80
  buffer_load_dword v179, v5, s[8:11], s31 offen sc1
  buffer_load_dword v180, v5, s[8:11], s32 offen sc1
  buffer_load_dword v181, v5, s[8:11], s33 offen sc1
  s_waitcnt lgkmcnt(5)
  v_mfma_f32_16x16x32_bf16 v[36:39], v[100:103], v[116:119], 0
  ds_read_b128 v[156:159], v2 offset:1152
  ds_read_b64 v[160:161], v1 offset:3200
  buffer_load_dword v182, v5, s[8:11], s34 offen sc1
  buffer_load_dword v183, v5, s[8:11], s35 offen sc1
  v_mfma_f32_16x16x32_bf16 v[40:43], v[112:115], v[116:119], v[40:43]
  ds_read_b64 v[162:163], v1 offset:3208
  ds_read_b128 v[164:167], v2 offset:640
  v_and_b32 v75, 0xffff0000, v81
  v_mfma_f32_16x16x32_bf16 v[44:47], v[120:123], v[116:119], v[44:47]
  ds_read_b64 v[104:105], v1 offset:2688
  ds_read_b64 v[106:107], v1 offset:2696
  v_lshlrev_b32 v74, 16, v81
  v_mfma_f32_16x16x32_bf16 v[32:35], v[100:103], v[124:127], 0
  ds_read_b128 v[108:111], v2 offset:128
  ds_read_b64 v[116:117], v1 offset:2176
  v_mfma_f32_16x16x32_bf16 v[36:39], v[112:115], v[124:127], v[36:39]
  v_and_b32 v77, 0xffff0000, v82
  s_waitcnt lgkmcnt(7)
  v_mfma_f32_16x16x32_bf16 v[44:47], v[128:131], v[124:127], v[44:47]
  ds_read_b64 v[118:119], v1 offset:2184
  ds_read_b64 v[100:101], v1 offset:3648
  v_mfma_f32_16x16x32_bf16 v[40:43], v[120:123], v[124:127], v[40:43]
  ds_read_b64 v[102:103], v1 offset:3656
  ds_read_b128 v[112:115], v2 offset:1600
  v_lshlrev_b32 v76, 16, v82
  v_mfma_f32_16x16x32_bf16 v[44:47], v[132:135], v[136:139], v[44:47]
  ds_read_b128 v[128:131], v2 offset:1088
  ds_read_b64 v[120:121], v1 offset:3136
  v_and_b32 v79, 0xffff0000, v83
  v_mfma_f32_16x16x32_bf16 v[40:43], v[132:135], v[156:159], v[40:43]
  s_waitcnt lgkmcnt(8)
  v_mfma_f32_16x16x32_bf16 v[44:47], v[160:163], v[156:159], v[44:47]
  ds_read_b64 v[122:123], v1 offset:3144
  ds_read_b128 v[124:127], v2 offset:576
  v_lshlrev_b32 v78, 16, v83
  v_mfma_f32_16x16x32_bf16 v[36:39], v[132:135], v[164:167], v[36:39]
  ds_read_b64 v[136:137], v1 offset:2624
  ds_read_b64 v[138:139], v1 offset:2632
  v_mfma_f32_16x16x32_bf16 v[40:43], v[160:163], v[164:167], v[40:43]
  v_mul_f32 v72, v12, v72
  v_mfma_f32_16x16x32_bf16 v[44:47], v[104:107], v[164:167], v[44:47]
  v_mul_f32 v73, v12, v73
  s_waitcnt lgkmcnt(9)
  v_mfma_f32_16x16x32_bf16 v[32:35], v[132:135], v[108:111], v[32:35]
  ds_read_b128 v[156:159], v2 offset:64
  ds_read_b64 v[164:165], v1 offset:2112
  v_mfma_f32_16x16x32_bf16 v[36:39], v[160:163], v[108:111], v[36:39]
  ds_read_b64 v[166:167], v1 offset:2120
  ds_read_b64 v[132:133], v1 offset:3584
  v_mul_f32 v74, v12, v74
  v_mfma_f32_16x16x32_bf16 v[44:47], v[116:119], v[108:111], v[44:47]
  v_mfma_f32_16x16x32_bf16 v[40:43], v[104:107], v[108:111], v[40:43]
  v_mul_f32 v75, v12, v75
  s_waitcnt lgkmcnt(6)
  v_mfma_f32_16x16x32_bf16 v[44:47], v[100:103], v[112:115], v[44:47]
  ds_read_b64 v[134:135], v1 offset:3592
  ds_read_b128 v[160:163], v2 offset:1536
  v_mul_f32 v76, v12, v76
  v_mfma_f32_16x16x32_bf16 v[40:43], v[100:103], v[128:131], v[40:43]
  ds_read_b128 v[116:119], v2 offset:1024
  ds_read_b64 v[104:105], v1 offset:3072
  v_mfma_f32_16x16x32_bf16 v[44:47], v[120:123], v[128:131], v[44:47]
  ds_read_b64 v[106:107], v1 offset:3080
  ds_read_b128 v[108:111], v2 offset:512
  v_mul_f32 v77, v12, v77
  s_waitcnt vmcnt(0)
CB_c1:
  v_pk_add_f32 v[176:177], v[176:177], v[180:181]
  v_pk_add_f32 v[178:179], v[178:179], v[182:183]
  v_pk_add_f32 v[176:177], v[176:177], v[178:179]
  v_add_f32 v176, v176, v177
  v_cmp_u_f32 vcc, v176, v176
  s_and_b64 vcc, vcc, s[56:57]
  s_cbranch_scc1 CB_r1
  v_mov_b32 v177, v176
  v_mfma_f32_16x16x32_bf16 v[36:39], v[100:103], v[124:127], v[36:39]
  s_nop 0
  v_permlane32_swap_b32 v176, v177
  v_mfma_f32_16x16x32_bf16 v[40:43], v[120:123], v[124:127], v[40:43]
  v_mul_f32 v78, v12, v78
  v_fma_f32 v177, -v176, v176, v177
  v_cvt_pk_bf16_f32 v177, 0, |v177|
  v_add_f32 v177, 0x3727c5ac, v177
  s_waitcnt lgkmcnt(7)
  v_mfma_f32_16x16x32_bf16 v[44:47], v[136:139], v[124:127], v[44:47]
  ds_read_b64 v[112:113], v1 offset:2560
  ds_read_b64 v[114:115], v1 offset:2568
  v_mul_f32 v79, v12, v79
  v_cvt_pk_bf16_f32 v177, 0, v177
  v_sqrt_f32 v177, v177
  v_mfma_f32_16x16x32_bf16 v[32:35], v[100:103], v[156:159], v[32:35]
  ds_read_b128 v[128:131], v2 offset:0
  ds_read_b64 v[124:125], v1 offset:2048
  s_mov_b32 s3, 0x00430000
  v_cvt_pk_bf16_f32 v176, v176, v177
  s_mov_b32 exec_hi, 0
  buffer_store_dword v176, v5, s[8:11], s3 offen sc1
  s_mov_b32 exec_hi, -1
  v_mfma_f32_16x16x32_bf16 v[36:39], v[120:123], v[156:159], v[36:39]
  ds_read_b64 v[126:127], v1 offset:2056
  ds_read_b64 v[100:101], v1 offset:3264
  v_cvt_pk_bf16_f32 v72, 0, v72
  v_mfma_f32_16x16x32_bf16 v[44:47], v[164:167], v[156:159], v[44:47]
  v_mfma_f32_16x16x32_bf16 v[40:43], v[136:139], v[156:159], v[40:43]
  v_cvt_pk_bf16_f32 v73, 0, v73
  s_waitcnt lgkmcnt(6)
  v_mfma_f32_16x16x32_bf16 v[44:47], v[132:135], v[160:163], v[44:47]
  ds_read_b64 v[102:103], v1 offset:3272
  ds_read_b128 v[120:123], v2 offset:1728
  v_cvt_pk_bf16_f32 v74, 0, v74
  v_mfma_f32_16x16x32_bf16 v[40:43], v[132:135], v[116:119], v[40:43]
  ds_read_b64 v[164:165], v1 offset:2752
  ds_read_b64 v[166:167], v1 offset:2760
  v_mfma_f32_16x16x32_bf16 v[44:47], v[104:107], v[116:119], v[44:47]
  ds_read_b128 v[136:139], v2 offset:1216
  ds_read_b64 v[156:157], v1 offset:2240
  v_cvt_pk_bf16_f32 v75, 0, v75
  v_mfma_f32_16x16x32_bf16 v[36:39], v[132:135], v[108:111], v[36:39]
  v_mfma_f32_16x16x32_bf16 v[40:43], v[104:107], v[108:111], v[40:43]
  v_cvt_pk_bf16_f32 v76, 0, v76
  s_waitcnt lgkmcnt(7)
  v_mfma_f32_16x16x32_bf16 v[44:47], v[112:115], v[108:111], v[44:47]
  ds_read_b64 v[158:159], v1 offset:2248
  ds_read_b128 v[160:163], v2 offset:704
  v_cvt_pk_bf16_f32 v77, 0, v77
  v_mfma_f32_16x16x32_bf16 v[32:35], v[132:135], v[128:131], v[32:35]
  ds_read_b64 v[116:117], v1 offset:1728
  ds_read_b64 v[118:119], v1 offset:1736
  v_mfma_f32_16x16x32_bf16 v[36:39], v[104:107], v[128:131], v[36:39]
  ds_read_b128 v[108:111], v2 offset:192
  ds_read_b64 v[132:133], v1 offset:1216
  v_cvt_pk_bf16_f32 v78, 0, v78
  v_mfma_f32_16x16x32_bf16 v[44:47], v[124:127], v[128:131], v[44:47]
  v_mfma_f32_16x16x32_bf16 v[40:43], v[112:115], v[128:131], v[40:43]
  v_cvt_pk_bf16_f32 v79, 0, v79
  s_waitcnt lgkmcnt(5)
  v_mfma_f32_16x16x32_bf16 v[48:51], v[100:103], v[120:123], 0
  ds_read_b64 v[134:135], v1 offset:1224
  ds_read_b64 v[104:105], v1 offset:704
  v_mfma_f32_16x16x32_bf16 v[52:55], v[164:167], v[120:123], 0
  ds_read_b64 v[106:107], v1 offset:712
  ds_read_b64 v[124:125], v1 offset:192
  v_mfma_f32_16x16x32_bf16 v[48:51], v[164:167], v[136:139], v[48:51]
  ds_read_b64 v[126:127], v1 offset:200
  ds_read_b64 v[112:113], v1 offset:3200
  ds_write_b128 v7, v[32:35] offset:0
  v_mfma_f32_16x16x32_bf16 v[56:59], v[156:159], v[120:123], 0
  ds_write_b128 v7, v[36:39] offset:1280
  v_mfma_f32_16x16x32_bf16 v[52:55], v[156:159], v[136:139], v[52:55]
  ds_write_b128 v7, v[44:47] offset:3840
  s_waitcnt lgkmcnt(11)
  v_mfma_f32_16x16x32_bf16 v[48:51], v[156:159], v[160:163], v[48:51]
  ds_read_b64 v[114:115], v1 offset:3208
  ds_read_b128 v[128:131], v2 offset:1664
  ds_write_b128 v7, v[40:43] offset:2560
  v_mfma_f32_16x16x32_bf16 v[60:63], v[116:119], v[120:123], 0
  v_mfma_f32_16x16x32_bf16 v[56:59], v[116:119], v[136:139], v[56:59]
  s_waitcnt lgkmcnt(0)
  s_barrier
  ds_read_b128 v[32:35], v8 offset:0
  ds_read_b128 v[36:39], v8 offset:16
  ds_read_b128 v[40:43], v8 offset:5120
  ds_read_b128 v[44:47], v8 offset:5136
  v_mfma_f32_16x16x32_bf16 v[52:55], v[116:119], v[160:163], v[52:55]
  ds_read_b64 v[100:101], v1 offset:2688
  ds_read_b64 v[102:103], v1 offset:2696
  v_mfma_f32_16x16x32_bf16 v[48:51], v[116:119], v[108:111], v[48:51]
  ds_read_b128 v[164:167], v2 offset:1152
  ds_read_b64 v[156:157], v1 offset:2176
  v_mfma_f32_16x16x32_bf16 v[60:63], v[132:135], v[136:139], v[60:63]
  ds_read_b64 v[158:159], v1 offset:2184
  ds_read_b128 v[120:123], v2 offset:640
  v_mfma_f32_16x16x32_bf16 v[56:59], v[132:135], v[160:163], v[56:59]
  ds_read_b64 v[116:117], v1 offset:1664
  ds_read_b64 v[118:119], v1 offset:1672
  s_waitcnt lgkmcnt(8)
  v_add_f32 v32, v32, v40
  v_add_f32 v33, v33, v41
  v_mfma_f32_16x16x32_bf16 v[52:55], v[132:135], v[108:111], v[52:55]
  ds_read_b128 v[136:139], v2 offset:128
  ds_read_b64 v[132:133], v1 offset:1152
  v_add_f32 v34, v34, v42
  v_add_f32 v35, v35, v43
  v_add_f32 v36, v36, v44
  v_mfma_f32_16x16x32_bf16 v[60:63], v[104:107], v[160:163], v[60:63]
  ds_read_b64 v[134:135], v1 offset:1160
  ds_read_b64 v[160:161], v1 offset:640
  v_add_f32 v37, v37, v45
  v_add_f32 v38, v38, v46
  v_add_f32 v39, v39, v47
  v_mfma_f32_16x16x32_bf16 v[56:59], v[104:107], v[108:111], v[56:59]
  v_cvt_pk_bf16_f32 v32, 0, v32
  v_cvt_pk_bf16_f32 v33, 0, v33
  v_cvt_pk_bf16_f32 v34, 0, v34
  v_mfma_f32_16x16x32_bf16 v[60:63], v[124:127], v[108:111], v[60:63]
  v_cvt_pk_bf16_f32 v35, 0, v35
  v_cvt_pk_bf16_f32 v36, 0, v36
  v_cvt_pk_bf16_f32 v37, 0, v37
  v_mfma_f32_16x16x32_bf16 v[48:51], v[112:115], v[128:131], v[48:51]
  v_cvt_pk_bf16_f32 v38, 0, v38
  v_cvt_pk_bf16_f32 v39, 0, v39
  v_add_f32 v32, v32, v72
  s_waitcnt lgkmcnt(7)
  v_mfma_f32_16x16x32_bf16 v[52:55], v[100:103], v[128:131], v[52:55]
  ds_read_b64 v[162:163], v1 offset:648
  ds_read_b64 v[104:105], v1 offset:128
  v_add_f32 v33, v33, v73
  v_add_f32 v34, v34, v74
  v_add_f32 v35, v35, v75
  v_mfma_f32_16x16x32_bf16 v[48:51], v[100:103], v[164:167], v[48:51]
  ds_read_b64 v[106:107], v1 offset:136
s_branch Ib0x
Ib0:
s_branch Ibr
Ib0x:
  ds_read_b64 v[124:125], v1 offset:3136
  v_add_f32 v36, v36, v76
  v_add_f32 v37, v37, v77
  v_add_f32 v38, v38, v78
  v_mfma_f32_16x16x32_bf16 v[56:59], v[156:159], v[128:131], v[56:59]
  ds_read_b64 v[126:127], v1 offset:3144
  ds_read_b128 v[108:111], v2 offset:1600
  v_add_f32 v39, v39, v79
  v_cvt_pk_bf16_f32 v32, 0, v32
  v_mfma_f32_16x16x32_bf16 v[52:55], v[156:159], v[164:167], v[52:55]
  s_add_u32 s96, s36, 0x00300000
  buffer_load_dwordx4 v[168:171], v3, s[8:11], s96 offen sc1
  v_cvt_pk_bf16_f32 v33, 0, v33
  v_cvt_pk_bf16_f32 v34, 0, v34
  v_cvt_pk_bf16_f32 v35, 0, v35
  s_waitcnt lgkmcnt(10)
  v_mfma_f32_16x16x32_bf16 v[48:51], v[156:159], v[120:123], v[48:51]
  ds_read_b64 v[112:113], v1 offset:2624
  ds_read_b64 v[114:115], v1 offset:2632
  v_cvt_pk_bf16_f32 v36, 0, v36
  v_cvt_pk_bf16_f32 v37, 0, v37
  v_cvt_pk_bf16_f32 v38, 0, v38
  v_mfma_f32_16x16x32_bf16 v[60:63], v[116:119], v[128:131], v[60:63]
  v_cvt_pk_bf16_f32 v39, 0, v39
  v_add_f32 v32, v32, v64
  v_add_f32 v33, v33, v65
  v_mfma_f32_16x16x32_bf16 v[56:59], v[116:119], v[164:167], v[56:59]
  v_add_f32 v34, v34, v66
  v_add_f32 v35, v35, v67
  v_add_f32 v36, v36, v68
  v_mfma_f32_16x16x32_bf16 v[52:55], v[116:119], v[120:123], v[52:55]
  v_add_f32 v37, v37, v69
  v_add_f32 v38, v38, v70
  v_add_f32 v39, v39, v71
  s_waitcnt lgkmcnt(9)
  v_mfma_f32_16x16x32_bf16 v[48:51], v[116:119], v[136:139], v[48:51]
  ds_read_b128 v[100:103], v2 offset:1088
  ds_read_b64 v[156:157], v1 offset:2112
  v_cvt_pk_bf16_f32 v80, v32, v33
  v_cvt_pk_bf16_f32 v81, v34, v35
  v_cvt_pk_bf16_f32 v82, v36, v37
  v_mfma_f32_16x16x32_bf16 v[60:63], v[132:135], v[164:167], v[60:63]
  ds_read_b64 v[158:159], v1 offset:2120
  ds_read_b128 v[128:131], v2 offset:576
  v_cvt_pk_bf16_f32 v83, v38, v39
  s_add_u32 s98, s36, 0x00a00000
  buffer_store_dwordx4 v[80:83], v3, s[8:11], s98 offen sc1
  v_mfma_f32_16x16x32_bf16 v[56:59], v[132:135], v[120:123], v[56:59]
  v_mfma_f32_16x16x32_bf16 v[52:55], v[132:135], v[136:139], v[52:55]
  s_waitcnt lgkmcnt(6)
  v_mfma_f32_16x16x32_bf16 v[60:63], v[160:163], v[120:123], v[60:63]
  ds_read_b64 v[116:117], v1 offset:1600
  ds_read_b64 v[118:119], v1 offset:1608
  v_mfma_f32_16x16x32_bf16 v[56:59], v[160:163], v[136:139], v[56:59]
  ds_read_b128 v[164:167], v2 offset:64
  ds_read_b64 v[132:133], v1 offset:1088
  v_mfma_f32_16x16x32_bf16 v[60:63], v[104:107], v[136:139], v[60:63]
  ds_read_b64 v[134:135], v1 offset:1096
  ds_read_b64 v[120:121], v1 offset:576
  v_mfma_f32_16x16x32_bf16 v[48:51], v[124:127], v[108:111], v[48:51]
  s_mov_b32 s3, 0x00432000
  buffer_load_dwordx4 v[172:175], v4, s[8:11], s3 offen sc1
  s_waitcnt lgkmcnt(7)
  v_mfma_f32_16x16x32_bf16 v[52:55], v[112:115], v[108:111], v[52:55]
  ds_read_b64 v[122:123], v1 offset:584
  ds_read_b64 v[160:161], v1 offset:64
  v_mfma_f32_16x16x32_bf16 v[48:51], v[112:115], v[100:103], v[48:51]
  ds_read_b64 v[162:163], v1 offset:72
  ds_read_b64 v[104:105], v1 offset:3072
  v_mfma_f32_16x16x32_bf16 v[56:59], v[156:159], v[108:111], v[56:59]
  ds_read_b64 v[106:107], v1 offset:3080
  ds_read_b128 v[136:139], v2 offset:1536
  v_mfma_f32_16x16x32_bf16 v[52:55], v[156:159], v[100:103], v[52:55]
  s_waitcnt lgkmcnt(10)
  v_mfma_f32_16x16x32_bf16 v[48:51], v[156:159], v[128:131], v[48:51]
  ds_read_b64 v[124:125], v1 offset:2560
  ds_read_b64 v[126:127], v1 offset:2568
  v_mfma_f32_16x16x32_bf16 v[60:63], v[116:119], v[108:111], v[60:63]
  v_mfma_f32_16x16x32_bf16 v[56:59], v[116:119], v[100:103], v[56:59]
  v_mfma_f32_16x16x32_bf16 v[52:55], v[116:119], v[128:131], v[52:55]
  s_waitcnt lgkmcnt(9)
  v_mfma_f32_16x16x32_bf16 v[48:51], v[116:119], v[164:167], v[48:51]
  ds_read_b128 v[112:115], v2 offset:1024
  ds_read_b64 v[156:157], v1 offset:2048
  v_mfma_f32_16x16x32_bf16 v[60:63], v[132:135], v[100:103], v[60:63]
  ds_read_b64 v[158:159], v1 offset:2056
  ds_read_b128 v[108:111], v2 offset:512
  v_mfma_f32_16x16x32_bf16 v[56:59], v[132:135], v[128:131], v[56:59]
  v_mfma_f32_16x16x32_bf16 v[52:55], v[132:135], v[164:167], v[52:55]
  s_waitcnt lgkmcnt(6)
  v_mfma_f32_16x16x32_bf16 v[60:63], v[120:123], v[128:131], v[60:63]
  ds_read_b64 v[116:117], v1 offset:1536
  ds_read_b64 v[118:119], v1 offset:1544
  v_mfma_f32_16x16x32_bf16 v[56:59], v[120:123], v[164:167], v[56:59]
  ds_read_b128 v[100:103], v2 offset:0
  ds_read_b64 v[132:133], v1 offset:1024
  v_mfma_f32_16x16x32_bf16 v[60:63], v[160:163], v[164:167], v[60:63]
  ds_read_b64 v[134:135], v1 offset:1032
  ds_read_b64 v[128:129], v1 offset:512
  v_mfma_f32_16x16x32_bf16 v[48:51], v[104:107], v[136:139], v[48:51]
  s_waitcnt lgkmcnt(7)
  v_mfma_f32_16x16x32_bf16 v[52:55], v[124:127], v[136:139], v[52:55]
  ds_read_b64 v[130:131], v1 offset:520
  ds_read_b64 v[120:121], v1 offset:0
  v_mfma_f32_16x16x32_bf16 v[48:51], v[124:127], v[112:115], v[48:51]
  ds_read_b64 v[122:123], v1 offset:8
  v_mfma_f32_16x16x32_bf16 v[56:59], v[156:159], v[136:139], v[56:59]
  v_mfma_f32_16x16x32_bf16 v[52:55], v[156:159], v[112:115], v[52:55]
  s_waitcnt lgkmcnt(7)
  v_mfma_f32_16x16x32_bf16 v[48:51], v[156:159], v[108:111], v[48:51]
  v_mfma_f32_16x16x32_bf16 v[60:63], v[116:119], v[136:139], v[60:63]
  v_mfma_f32_16x16x32_bf16 v[56:59], v[116:119], v[112:115], v[56:59]
  v_mfma_f32_16x16x32_bf16 v[52:55], v[116:119], v[108:111], v[52:55]
  s_waitcnt lgkmcnt(4)
  v_mfma_f32_16x16x32_bf16 v[48:51], v[116:119], v[100:103], v[48:51]
  v_mfma_f32_16x16x32_bf16 v[60:63], v[132:135], v[112:115], v[60:63]
  v_mfma_f32_16x16x32_bf16 v[56:59], v[132:135], v[108:111], v[56:59]
  v_mfma_f32_16x16x32_bf16 v[52:55], v[132:135], v[100:103], v[52:55]
  s_waitcnt lgkmcnt(0)
  v_mfma_f32_16x16x32_bf16 v[60:63], v[128:131], v[108:111], v[60:63]
  v_mfma_f32_16x16x32_bf16 v[56:59], v[128:131], v[100:103], v[56:59]
  v_mfma_f32_16x16x32_bf16 v[60:63], v[120:123], v[100:103], v[60:63]
  s_waitcnt vmcnt(0)
C_chk1:
  v_max3_u32 v32, v168, v172, v173
  v_max3_u32 v32, v32, v174, v175
  v_cmp_eq_u32 vcc, -1, v32
  s_and_b64 vcc, vcc, s[56:57]
  s_cbranch_scc1 C_retry1
  s_mov_b64 exec, -1
  v_and_b32 v41, 0xffff0000, v172
  v_lshlrev_b32 v40, 16, v172
  v_and_b32 v43, 0xffff0000, v173
  v_lshlrev_b32 v42, 16, v173
  v_and_b32 v45, 0xffff0000, v174
  v_lshlrev_b32 v44, 16, v174
  v_and_b32 v47, 0xffff0000, v175
  v_lshlrev_b32 v46, 16, v175
  v_rcp_f32 v41, v41
  v_rcp_f32 v43, v43
  v_rcp_f32 v45, v45
  v_rcp_f32 v47, v47
  v_and_b32 v65, 0xffff0000, v168
  v_lshlrev_b32 v64, 16, v168
  v_and_b32 v67, 0xffff0000, v169
  v_lshlrev_b32 v66, 16, v169
  v_and_b32 v69, 0xffff0000, v170
  v_lshlrev_b32 v68, 16, v170
  v_and_b32 v71, 0xffff0000, v171
  v_lshlrev_b32 v70, 16, v171
  v_subrev_f32_dpp v32, v40, v64 quad_perm:[0,0,2,2] row_mask:0xf bank_mask:0xf
  v_subrev_f32_dpp v33, v42, v65 quad_perm:[0,0,2,2] row_mask:0xf bank_mask:0xf
  v_subrev_f32_dpp v34, v44, v66 quad_perm:[0,0,2,2] row_mask:0xf bank_mask:0xf
  v_subrev_f32_dpp v35, v46, v67 quad_perm:[0,0,2,2] row_mask:0xf bank_mask:0xf
  v_subrev_f32_dpp v36, v40, v68 quad_perm:[1,1,3,3] row_mask:0xf bank_mask:0xf
  v_subrev_f32_dpp v37, v42, v69 quad_perm:[1,1,3,3] row_mask:0xf bank_mask:0xf
  v_subrev_f32_dpp v38, v44, v70 quad_perm:[1,1,3,3] row_mask:0xf bank_mask:0xf
  v_subrev_f32_dpp v39, v46, v71 quad_perm:[1,1,3,3] row_mask:0xf bank_mask:0xf
  v_cvt_pk_bf16_f32 v32, 0, v32
  v_cvt_pk_bf16_f32 v33, 0, v33
  v_cvt_pk_bf16_f32 v34, 0, v34
  v_cvt_pk_bf16_f32 v35, 0, v35
  v_cvt_pk_bf16_f32 v36, 0, v36
  v_cvt_pk_bf16_f32 v37, 0, v37
  v_cvt_pk_bf16_f32 v38, 0, v38
  v_cvt_pk_bf16_f32 v39, 0, v39
  v_mul_f32_dpp v32, v41, v32 quad_perm:[0,0,2,2] row_mask:0xf bank_mask:0xf
  v_mul_f32_dpp v33, v43, v33 quad_perm:[0,0,2,2] row_mask:0xf bank_mask:0xf
  v_mul_f32_dpp v34, v45, v34 quad_perm:[0,0,2,2] row_mask:0xf bank_mask:0xf
  v_mul_f32_dpp v35, v47, v35 quad_perm:[0,0,2,2] row_mask:0xf bank_mask:0xf
  v_mul_f32_dpp v36, v41, v36 quad_perm:[1,1,3,3] row_mask:0xf bank_mask:0xf
  v_mul_f32_dpp v37, v43, v37 quad_perm:[1,1,3,3] row_mask:0xf bank_mask:0xf
  v_mul_f32_dpp v38, v45, v38 quad_perm:[1,1,3,3] row_mask:0xf bank_mask:0xf
  v_mul_f32_dpp v39, v47, v39 quad_perm:[1,1,3,3] row_mask:0xf bank_mask:0xf
  v_cvt_pk_bf16_f32 v80, v32, v33
  v_cvt_pk_bf16_f32 v81, v34, v35
  v_cvt_pk_bf16_f32 v82, v36, v37
  v_cvt_pk_bf16_f32 v83, v38, v39
  ds_write_b128 v6, v[80:83] offset:2048
  s_waitcnt lgkmcnt(0)
  s_barrier
  ds_read_b64 v[100:101], v1 offset:3776
  ds_read_b64 v[102:103], v1 offset:3784
  ds_read_b128 v[104:107], v2 offset:3776
  ds_read_b128 v[108:111], v2 offset:3264
  ds_read_b64 v[112:113], v1 offset:3264
  ds_read_b64 v[114:115], v1 offset:3272
  ds_read_b128 v[116:119], v2 offset:2752
  ds_read_b64 v[120:121], v1 offset:2752
  ds_read_b64 v[122:123], v1 offset:2760
  s_waitcnt lgkmcnt(6)
  v_mfma_f32_16x16x32_bf16 v[60:63], v[100:103], v[104:107], v[60:63]
  ds_read_b128 v[124:127], v2 offset:2240
  ds_read_b64 v[128:129], v1 offset:2240
  v_and_b32 v73, 0xffff0000, v80
  s_waitcnt lgkmcnt(7)
  v_mfma_f32_16x16x32_bf16 v[56:59], v[100:103], v[108:111], v[56:59]
  ds_read_b64 v[130:131], v1 offset:2248
  ds_read_b64 v[132:133], v1 offset:3712
  s_waitcnt lgkmcnt(7)
  v_mfma_f32_16x16x32_bf16 v[60:63], v[112:115], v[108:111], v[60:63]
  ds_read_b64 v[134:135], v1 offset:3720
  ds_read_b128 v[136:139], v2 offset:3712
  v_lshlrev_b32 v72, 16, v80
  s_waitcnt lgkmcnt(5)
  v_mfma_f32_16x16x32_bf16 v[52:55], v[100:103], v[116:119], v[52:55]
  ds_read_b128 v[156:159], v2 offset:3200
  ds_read_b64 v[160:161], v1 offset:3200
  v_mfma_f32_16x16x32_bf16 v[56:59], v[112:115], v[116:119], v[56:59]
  ds_read_b64 v[162:163], v1 offset:3208
  ds_read_b128 v[164:167], v2 offset:2688
  v_and_b32 v75, 0xffff0000, v81
  v_mfma_f32_16x16x32_bf16 v[60:63], v[120:123], v[116:119], v[60:63]
  ds_read_b64 v[104:105], v1 offset:2688
  ds_read_b64 v[106:107], v1 offset:2696
  v_lshlrev_b32 v74, 16, v81
  v_mfma_f32_16x16x32_bf16 v[48:51], v[100:103], v[124:127], v[48:51]
  ds_read_b128 v[108:111], v2 offset:2176
  ds_read_b64 v[116:117], v1 offset:2176
  v_mfma_f32_16x16x32_bf16 v[52:55], v[112:115], v[124:127], v[52:55]
  v_and_b32 v77, 0xffff0000, v82
  s_waitcnt lgkmcnt(7)
  v_mfma_f32_16x16x32_bf16 v[60:63], v[128:131], v[124:127], v[60:63]
  ds_read_b64 v[118:119], v1 offset:2184
  ds_read_b64 v[100:101], v1 offset:3648
  v_mfma_f32_16x16x32_bf16 v[56:59], v[120:123], v[124:127], v[56:59]
  ds_read_b64 v[102:103], v1 offset:3656
  ds_read_b128 v[112:115], v2 offset:3648
  v_lshlrev_b32 v76, 16, v82
  v_mfma_f32_16x16x32_bf16 v[60:63], v[132:135], v[136:139], v[60:63]
  ds_read_b128 v[128:131], v2 offset:3136
  ds_read_b64 v[120:121], v1 offset:3136
  v_and_b32 v79, 0xffff0000, v83
  v_mfma_f32_16x16x32_bf16 v[56:59], v[132:135], v[156:159], v[56:59]
  s_waitcnt lgkmcnt(8)
  v_mfma_f32_16x16x32_bf16 v[60:63], v[160:163], v[156:159], v[60:63]
  ds_read_b64 v[122:123], v1 offset:3144
  ds_read_b128 v[124:127], v2 offset:2624
  v_lshlrev_b32 v78, 16, v83
  v_mfma_f32_16x16x32_bf16 v[52:55], v[132:135], v[164:167], v[52:55]
  ds_read_b64 v[136:137], v1 offset:2624
  ds_read_b64 v[138:139], v1 offset:2632
  v_mfma_f32_16x16x32_bf16 v[56:59], v[160:163], v[164:167], v[56:59]
  v_mul_f32 v72, v12, v72
  v_mfma_f32_16x16x32_bf16 v[60:63], v[104:107], v[164:167], v[60:63]
  v_mul_f32 v73, v12, v73
  s_waitcnt lgkmcnt(9)
  v_mfma_f32_16x16x32_bf16 v[48:51], v[132:135], v[108:111], v[48:51]
  ds_read_b128 v[156:159], v2 offset:2112
  ds_read_b64 v[164:165], v1 offset:2112
  v_mfma_f32_16x16x32_bf16 v[52:55], v[160:163], v[108:111], v[52:55]
  ds_read_b64 v[166:167], v1 offset:2120
  ds_read_b64 v[132:133], v1 offset:3584
  v_mul_f32 v74, v12, v74
  s_add_u32 m0, s60, 0x00000000
  s_add_u32 s89, s40, 0x00a00000
  buffer_load_dwordx4 v9, s[8:11], s89 offen offset:0 sc1 lds
  v_mfma_f32_16x16x32_bf16 v[60:63], v[116:119], v[108:111], v[60:63]
  v_mfma_f32_16x16x32_bf16 v[56:59], v[104:107], v[108:111], v[56:59]
  v_mul_f32 v75, v12, v75
  s_waitcnt lgkmcnt(6)
  v_mfma_f32_16x16x32_bf16 v[60:63], v[100:103], v[112:115], v[60:63]
  ds_read_b64 v[134:135], v1 offset:3592
  ds_read_b128 v[160:163], v2 offset:3584
  v_mul_f32 v76, v12, v76
  buffer_load_dwordx4 v9, s[8:11], s89 offen offset:1024 sc1 lds
  v_mfma_f32_16x16x32_bf16 v[56:59], v[100:103], v[128:131], v[56:59]
  ds_read_b128 v[116:119], v2 offset:3072
  ds_read_b64 v[104:105], v1 offset:3072
  v_mfma_f32_16x16x32_bf16 v[60:63], v[120:123], v[128:131], v[60:63]
  ds_read_b64 v[106:107], v1 offset:3080
  ds_read_b128 v[108:111], v2 offset:2560
  v_mul_f32 v77, v12, v77
  v_mfma_f32_16x16x32_bf16 v[52:55], v[100:103], v[124:127], v[52:55]
  buffer_load_dwordx4 v9, s[8:11], s89 offen offset:2048 sc1 lds
  v_mfma_f32_16x16x32_bf16 v[56:59], v[120:123], v[124:127], v[56:59]
  v_mul_f32 v78, v12, v78
  s_waitcnt lgkmcnt(7)
  v_mfma_f32_16x16x32_bf16 v[60:63], v[136:139], v[124:127], v[60:63]
  ds_read_b64 v[112:113], v1 offset:2560
  ds_read_b64 v[114:115], v1 offset:2568
  v_mul_f32 v79, v12, v79
  v_mfma_f32_16x16x32_bf16 v[48:51], v[100:103], v[156:159], v[48:51]
  ds_read_b128 v[128:131], v2 offset:2048
  ds_read_b64 v[124:125], v1 offset:2048
  buffer_load_dwordx4 v9, s[8:11], s89 offen offset:3072 sc1 lds
  v_mfma_f32_16x16x32_bf16 v[52:55], v[120:123], v[156:159], v[52:55]
  ds_read_b64 v[126:127], v1 offset:2056
  v_cvt_pk_bf16_f32 v72, 0, v72
  v_mfma_f32_16x16x32_bf16 v[60:63], v[164:167], v[156:159], v[60:63]
  v_mfma_f32_16x16x32_bf16 v[56:59], v[136:139], v[156:159], v[56:59]
  v_cvt_pk_bf16_f32 v73, 0, v73
  s_add_u32 m0, s60, 0x00001000
  s_add_u32 s89, s40, 0x00a01000
  buffer_load_dwordx4 v9, s[8:11], s89 offen offset:0 sc1 lds
  s_waitcnt lgkmcnt(5)
  v_mfma_f32_16x16x32_bf16 v[60:63], v[132:135], v[160:163], v[60:63]
  v_cvt_pk_bf16_f32 v74, 0, v74
  v_mfma_f32_16x16x32_bf16 v[56:59], v[132:135], v[116:119], v[56:59]
  v_mfma_f32_16x16x32_bf16 v[60:63], v[104:107], v[116:119], v[60:63]
  v_cvt_pk_bf16_f32 v75, 0, v75
  buffer_load_dwordx4 v9, s[8:11], s89 offen offset:1024 sc1 lds
  v_mfma_f32_16x16x32_bf16 v[52:55], v[132:135], v[108:111], v[52:55]
  v_mfma_f32_16x16x32_bf16 v[56:59], v[104:107], v[108:111], v[56:59]
  v_cvt_pk_bf16_f32 v76, 0, v76
  s_waitcnt lgkmcnt(0)
  v_mfma_f32_16x16x32_bf16 v[60:63], v[112:115], v[108:111], v[60:63]
  v_cvt_pk_bf16_f32 v77, 0, v77
  buffer_load_dwordx4 v9, s[8:11], s89 offen offset:2048 sc1 lds
  v_mfma_f32_16x16x32_bf16 v[48:51], v[132:135], v[128:131], v[48:51]
  v_mfma_f32_16x16x32_bf16 v[52:55], v[104:107], v[128:131], v[52:55]
  v_cvt_pk_bf16_f32 v78, 0, v78
  v_mfma_f32_16x16x32_bf16 v[60:63], v[124:127], v[128:131], v[60:63]
  buffer_load_dwordx4 v9, s[8:11], s89 offen offset:3072 sc1 lds
  v_mfma_f32_16x16x32_bf16 v[56:59], v[112:115], v[128:131], v[56:59]
  v_cvt_pk_bf16_f32 v79, 0, v79
  s_nop 4
  ds_write_b128 v7, v[48:51] offset:0
  ds_write_b128 v7, v[52:55] offset:1280
  ds_write_b128 v7, v[60:63] offset:3840
  ds_write_b128 v7, v[56:59] offset:2560
  s_waitcnt lgkmcnt(0)
  s_barrier
  ds_read_b128 v[32:35], v8 offset:0
  ds_read_b128 v[36:39], v8 offset:16
  ds_read_b128 v[40:43], v8 offset:5120
  ds_read_b128 v[44:47], v8 offset:5136
  s_waitcnt lgkmcnt(0)
  v_pk_add_f32 v[32:33], v[32:33], v[40:41]
  s_add_u32 m0, s60, 0x00008000
  s_add_u32 s89, s41, 0x00a00000
  buffer_load_dwordx4 v9, s[8:11], s89 offen offset:0 sc1 lds
  v_pk_add_f32 v[34:35], v[34:35], v[42:43]
  v_pk_add_f32 v[36:37], v[36:37], v[44:45]
  v_pk_add_f32 v[38:39], v[38:39], v[46:47]
  v_cvt_pk_bf16_f32 v32, 0, v32
  buffer_load_dwordx4 v9, s[8:11], s89 offen offset:1024 sc1 lds
  v_cvt_pk_bf16_f32 v33, 0, v33
  v_cvt_pk_bf16_f32 v34, 0, v34
  v_cvt_pk_bf16_f32 v35, 0, v35
  v_cvt_pk_bf16_f32 v36, 0, v36
  buffer_load_dwordx4 v9, s[8:11], s89 offen offset:2048 sc1 lds
  v_cvt_pk_bf16_f32 v37, 0, v37
  v_cvt_pk_bf16_f32 v38, 0, v38
  v_cvt_pk_bf16_f32 v39, 0, v39
  v_pk_add_f32 v[32:33], v[32:33], v[72:73]
  buffer_load_dwordx4 v9, s[8:11], s89 offen offset:3072 sc1 lds
  v_pk_add_f32 v[34:35], v[34:35], v[74:75]
  v_pk_add_f32 v[36:37], v[36:37], v[76:77]
  v_pk_add_f32 v[38:39], v[38:39], v[78:79]
  v_cvt_pk_bf16_f32 v32, 0, v32
  s_add_u32 m0, s60, 0x00009000
  s_add_u32 s89, s41, 0x00a01000
  buffer_load_dwordx4 v9, s[8:11], s89 offen offset:0 sc1 lds
  v_cvt_pk_bf16_f32 v33, 0, v33
  v_cvt_pk_bf16_f32 v34, 0, v34
  v_cvt_pk_bf16_f32 v35, 0, v35
  v_cvt_pk_bf16_f32 v36, 0, v36
  buffer_load_dwordx4 v9, s[8:11], s89 offen offset:1024 sc1 lds
  v_cvt_pk_bf16_f32 v37, 0, v37
  s_waitcnt vmcnt(6)
  v_cvt_pk_bf16_f32 v38, 0, v38
  ds_read_b64_tr_b16 v[84:85], v24 offset:0
  v_cvt_pk_bf16_f32 v39, 0, v39
  ds_read_b64_tr_b16 v[86:87], v24 offset:256
  v_pk_add_f32 v[32:33], v[32:33], v[64:65]
  ds_read_b64_tr_b16 v[88:89], v24 offset:1024
  buffer_load_dwordx4 v9, s[8:11], s89 offen offset:2048 sc1 lds
  ds_read_b64_tr_b16 v[90:91], v24 offset:1280
  ds_read_b64_tr_b16 v[92:93], v24 offset:2048
  v_pk_add_f32 v[34:35], v[34:35], v[66:67]
  ds_read_b64_tr_b16 v[94:95], v24 offset:2304
  v_pk_add_f32 v[36:37], v[36:37], v[68:69]
  ds_read_b64_tr_b16 v[96:97], v24 offset:3072
  v_pk_add_f32 v[38:39], v[38:39], v[70:71]
  ds_read_b64_tr_b16 v[98:99], v24 offset:3328
  v_cvt_pk_bf16_f32 v80, v32, v33
  ds_read_b64_tr_b16 v[100:101], v24 offset:4096
  buffer_load_dwordx4 v9, s[8:11], s89 offen offset:3072 sc1 lds
  ds_read_b64_tr_b16 v[102:103], v24 offset:4352
  v_cvt_pk_bf16_f32 v81, v34, v35
  ds_read_b64_tr_b16 v[104:105], v24 offset:5120
  ds_read_b64_tr_b16 v[106:107], v24 offset:5376
  v_cvt_pk_bf16_f32 v82, v36, v37
  ds_read_b64_tr_b16 v[108:109], v24 offset:6144
  v_cvt_pk_bf16_f32 v83, v38, v39
  ds_read_b64_tr_b16 v[110:111], v24 offset:6400
  s_add_u32 s98, s36, 0x00b00000
  ds_read_b64_tr_b16 v[112:113], v24 offset:7168
  buffer_store_dwordx4 v[80:83], v3, s[8:11], s98 offen sc1
  ds_read_b64_tr_b16 v[114:115], v24 offset:7424
  s_waitcnt lgkmcnt(0)
  v_mfma_f32_4x4x4_16b_bf16 v[140:143], v[84:85], v[84:85], 0
  v_mfma_f32_4x4x4_16b_bf16 v[144:147], v[22:23], v[84:85], 0
  v_mfma_f32_4x4x4_16b_bf16 v[148:151], v[86:87], v[86:87], 0
  v_mfma_f32_4x4x4_16b_bf16 v[152:155], v[22:23], v[86:87], 0
  v_mfma_f32_4x4x4_16b_bf16 v[140:143], v[88:89], v[88:89], v[140:143]
  v_mfma_f32_4x4x4_16b_bf16 v[144:147], v[22:23], v[88:89], v[144:147]
  v_mfma_f32_4x4x4_16b_bf16 v[148:151], v[90:91], v[90:91], v[148:151]
  v_mfma_f32_4x4x4_16b_bf16 v[152:155], v[22:23], v[90:91], v[152:155]
  v_mfma_f32_4x4x4_16b_bf16 v[140:143], v[92:93], v[92:93], v[140:143]
  v_mfma_f32_4x4x4_16b_bf16 v[144:147], v[22:23], v[92:93], v[144:147]
  v_mfma_f32_4x4x4_16b_bf16 v[148:151], v[94:95], v[94:95], v[148:151]
  v_mfma_f32_4x4x4_16b_bf16 v[152:155], v[22:23], v[94:95], v[152:155]
  v_mfma_f32_4x4x4_16b_bf16 v[140:143], v[96:97], v[96:97], v[140:143]
  v_mfma_f32_4x4x4_16b_bf16 v[144:147], v[22:23], v[96:97], v[144:147]
  v_mfma_f32_4x4x4_16b_bf16 v[148:151], v[98:99], v[98:99], v[148:151]
  v_mfma_f32_4x4x4_16b_bf16 v[152:155], v[22:23], v[98:99], v[152:155]
  v_mfma_f32_4x4x4_16b_bf16 v[140:143], v[100:101], v[100:101], v[140:143]
  v_mfma_f32_4x4x4_16b_bf16 v[144:147], v[22:23], v[100:101], v[144:147]
  v_mfma_f32_4x4x4_16b_bf16 v[148:151], v[102:103], v[102:103], v[148:151]
  v_mfma_f32_4x4x4_16b_bf16 v[152:155], v[22:23], v[102:103], v[152:155]
  v_mfma_f32_4x4x4_16b_bf16 v[140:143], v[104:105], v[104:105], v[140:143]
  v_mfma_f32_4x4x4_16b_bf16 v[144:147], v[22:23], v[104:105], v[144:147]
  v_mfma_f32_4x4x4_16b_bf16 v[148:151], v[106:107], v[106:107], v[148:151]
  v_mfma_f32_4x4x4_16b_bf16 v[152:155], v[22:23], v[106:107], v[152:155]
  v_mfma_f32_4x4x4_16b_bf16 v[140:143], v[108:109], v[108:109], v[140:143]
  v_mfma_f32_4x4x4_16b_bf16 v[144:147], v[22:23], v[108:109], v[144:147]
  v_mfma_f32_4x4x4_16b_bf16 v[148:151], v[110:111], v[110:111], v[148:151]
  v_mfma_f32_4x4x4_16b_bf16 v[152:155], v[22:23], v[110:111], v[152:155]
  v_mfma_f32_4x4x4_16b_bf16 v[140:143], v[112:113], v[112:113], v[140:143]
  v_mfma_f32_4x4x4_16b_bf16 v[144:147], v[22:23], v[112:113], v[144:147]
  v_mfma_f32_4x4x4_16b_bf16 v[148:151], v[114:115], v[114:115], v[148:151]
  v_mfma_f32_4x4x4_16b_bf16 v[152:155], v[22:23], v[114:115], v[152:155]
  s_nop 4
  v_add_f32 v140, v140, v148
  v_add_f32 v141, v141, v149
  v_add_f32 v142, v142, v150
  v_add_f32 v143, v143, v151
  v_add_f32 v144, v144, v152
  v_cndmask_b32 v140, v140, v141, s[62:63]
  v_cndmask_b32 v142, v142, v143, s[62:63]
  v_cndmask_b32 v140, v140, v142, s[64:65]
  s_nop 1
  v_permlane32_swap_b32 v144, v140
  s_nop 0
  v_add_f32 v144, v144, v140
  v_cmp_u_f32 vcc, v144, v144
  s_and_b64 vcc, vcc, s[56:57]
  s_cbranch_scc1 G_r10
G_b10:
  ds_write_b32 v10, v144 offset:0
  v_and_b32 v20, 0x1ff, v9
  s_cmp_eq_u32 s22, 0
  s_cbranch_scc1 S_1
  s_waitcnt lgkmcnt(0)
  s_barrier
  v_mfma_f32_32x32x16_bf16 v[32:47], a[176:179], v[84:87], 0
  ds_read_b128 v[160:163], v11 offset:0
  ds_read_b128 v[164:167], v11 offset:16
  v_mfma_f32_32x32x16_bf16 v[32:47], a[180:183], v[88:91], v[32:47]
  s_add_u32 m0, s60, 0x00010000
  s_add_u32 s89, s42, 0x00a00000
  buffer_load_dwordx4 v9, s[8:11], s89 offen offset:0 sc1 lds
  v_mfma_f32_32x32x16_bf16 v[32:47], a[184:187], v[92:95], v[32:47]
  buffer_load_dwordx4 v9, s[8:11], s89 offen offset:1024 sc1 lds
  v_mfma_f32_32x32x16_bf16 v[32:47], a[188:191], v[96:99], v[32:47]
  ds_read_b64_tr_b16 v[124:125], v25 offset:0
  ds_read_b64_tr_b16 v[126:127], v25 offset:256
  s_waitcnt lgkmcnt(2)
  v_mfma_f32_32x32x16_bf16 v[32:47], a[192:195], v[100:103], v[32:47]
  ds_read_b64_tr_b16 v[128:129], v25 offset:1024
  ds_read_b64_tr_b16 v[130:131], v25 offset:1280
  v_add_f32 v160, v160, v161
  v_mfma_f32_32x32x16_bf16 v[32:47], a[196:199], v[104:107], v[32:47]
  ds_read_b64_tr_b16 v[132:133], v25 offset:2048
  ds_read_b64_tr_b16 v[134:135], v25 offset:2304
  buffer_load_dwordx4 v9, s[8:11], s89 offen offset:2048 sc1 lds
  v_add_f32 v162, v162, v163
  v_mfma_f32_32x32x16_bf16 v[32:47], a[200:203], v[108:111], v[32:47]
  ds_read_b64_tr_b16 v[136:137], v25 offset:3072
  ds_read_b64_tr_b16 v[138:139], v25 offset:3328
  buffer_load_dwordx4 v9, s[8:11], s89 offen offset:3072 sc1 lds
  v_add_f32 v164, v164, v165
  v_mfma_f32_32x32x16_bf16 v[32:47], a[204:207], v[112:115], v[32:47]
  ds_read_b64_tr_b16 v[116:117], v25 offset:4096
  ds_read_b64_tr_b16 v[118:119], v25 offset:4352
  v_add_f32 v166, v166, v167
  v_add_f32 v160, v160, v162
  s_waitcnt lgkmcnt(6)
  v_mfma_f32_32x32x16_bf16 v[32:47], a[208:211], v[124:127], v[32:47]
  ds_read_b64_tr_b16 v[120:121], v25 offset:5120
  ds_read_b64_tr_b16 v[122:123], v25 offset:5376
  v_add_f32 v164, v164, v166
  v_mfma_f32_32x32x16_bf16 v[32:47], a[212:215], v[128:131], v[32:47]
  ds_read_b64_tr_b16 v[124:125], v25 offset:6144
  ds_read_b64_tr_b16 v[126:127], v25 offset:6400
  s_add_u32 m0, s60, 0x00011000
  s_add_u32 s89, s42, 0x00a01000
  buffer_load_dwordx4 v9, s[8:11], s89 offen offset:0 sc1 lds
  v_mul_f32 v160, 0xbb000000, v160
  s_waitcnt lgkmcnt(6)
  v_mfma_f32_32x32x16_bf16 v[32:47], a[216:219], v[132:135], v[32:47]
  ds_read_b64_tr_b16 v[128:129], v25 offset:7168
  ds_read_b64_tr_b16 v[130:131], v25 offset:7424
  buffer_load_dwordx4 v9, s[8:11], s89 offen offset:1024 sc1 lds
  v_mul_f32 v164, 0x3b000000, v164
  v_mfma_f32_32x32x16_bf16 v[32:47], a[220:223], v[136:139], v[32:47]
  ds_read_b64_tr_b16 v[132:133], v26 offset:0
  ds_read_b64_tr_b16 v[134:135], v26 offset:256
  v_cvt_pk_bf16_f32 v156, v160, v160
  s_waitcnt lgkmcnt(6)
  v_mfma_f32_32x32x16_bf16 v[32:47], a[224:227], v[116:119], v[32:47]
  ds_read_b64_tr_b16 v[136:137], v26 offset:1024
  ds_read_b64_tr_b16 v[138:139], v26 offset:1280
  v_fma_f32 v164, -v160, v160, v164
  v_mfma_f32_32x32x16_bf16 v[32:47], a[228:231], v[120:123], v[32:47]
  ds_read_b64_tr_b16 v[116:117], v26 offset:2048
  ds_read_b64_tr_b16 v[118:119], v26 offset:2304
  buffer_load_dwordx4 v9, s[8:11], s89 offen offset:2048 sc1 lds
  v_cvt_pk_bf16_f32 v164, 0, |v164|
  s_waitcnt lgkmcnt(6)
  v_mfma_f32_32x32x16_bf16 v[32:47], a[232:235], v[124:127], v[32:47]
  ds_read_b64_tr_b16 v[120:121], v26 offset:3072
  ds_read_b64_tr_b16 v[122:123], v26 offset:3328
  buffer_load_dwordx4 v9, s[8:11], s89 offen offset:3072 sc1 lds
  v_add_f32 v164, 0x3727c5ac, v164
  v_mfma_f32_32x32x16_bf16 v[32:47], a[236:239], v[128:131], v[32:47]
  ds_read_b64_tr_b16 v[124:125], v26 offset:4096
  ds_read_b64_tr_b16 v[126:127], v26 offset:4352
  v_cvt_pk_bf16_f32 v164, 0, v164
  s_waitcnt lgkmcnt(6)
  v_mfma_f32_32x32x16_bf16 v[32:47], a[240:243], v[132:135], v[32:47]
  ds_read_b64_tr_b16 v[128:129], v26 offset:5120
  ds_read_b64_tr_b16 v[130:131], v26 offset:5376
  v_sqrt_f32 v164, v164
  v_mfma_f32_32x32x16_bf16 v[32:47], a[244:247], v[136:139], v[32:47]
  ds_read_b64_tr_b16 v[132:133], v26 offset:6144
  ds_read_b64_tr_b16 v[134:135], v26 offset:6400
  v_mov_b32 v157, v156
  v_cvt_pk_bf16_f32 v164, 0, v164
  s_waitcnt lgkmcnt(6)
  v_mfma_f32_32x32x16_bf16 v[32:47], a[248:251], v[116:119], v[32:47]
  ds_read_b64_tr_b16 v[136:137], v26 offset:7168
  ds_read_b64_tr_b16 v[138:139], v26 offset:7424
  v_rcp_f32 v160, v164
  v_mfma_f32_32x32x16_bf16 v[32:47], a[252:255], v[120:123], v[32:47]
  ds_read_b64_tr_b16 v[116:117], v27 offset:0
  ds_read_b64_tr_b16 v[118:119], v27 offset:256
  v_mul_f32 v66, v164, v164
  s_waitcnt lgkmcnt(6)
  v_mfma_f32_32x32x16_bf16 v[32:47], v[208:211], v[124:127], v[32:47]
  ds_read_b64_tr_b16 v[120:121], v27 offset:1024
  ds_read_b64_tr_b16 v[122:123], v27 offset:1280
  s_waitcnt vmcnt(9)
  ds_read2st64_b32 v[140:141], v0 offset0:128 offset1:132
  v_mov_b64 v[200:201], -1
  v_mov_b64 v[202:203], -1
  v_mfma_f32_32x32x16_bf16 v[32:47], v[212:215], v[128:131], v[32:47]
  ds_read_b64_tr_b16 v[124:125], v27 offset:2048
  ds_read_b64_tr_b16 v[126:127], v27 offset:2304
  ds_read2st64_b32 v[142:143], v0 offset0:136 offset1:140
  v_mul_f32 v161, v160, v160
  s_waitcnt lgkmcnt(8)
  v_mfma_f32_32x32x16_bf16 v[32:47], v[216:219], v[132:135], v[32:47]
  ds_read_b64_tr_b16 v[128:129], v27 offset:3072
  ds_read_b64_tr_b16 v[130:131], v27 offset:3328
  ds_read2st64_b32 v[144:145], v0 offset0:144 offset1:148
  v_mul_f32 v64, 0xc0135761, v160
  v_mfma_f32_32x32x16_bf16 v[32:47], v[220:223], v[136:139], v[32:47]
  ds_read_b64_tr_b16 v[132:133], v27 offset:4096
  ds_read_b64_tr_b16 v[134:135], v27 offset:4352
  ds_read2st64_b32 v[146:147], v0 offset0:152 offset1:156
  v_mul_f32 v161, 0x3d372713, v161
  s_waitcnt lgkmcnt(10)
  v_mfma_f32_32x32x16_bf16 v[32:47], v[224:227], v[116:119], v[32:47]
  ds_read_b64_tr_b16 v[136:137], v27 offset:5120
  ds_read_b64_tr_b16 v[138:139], v27 offset:5376
  ds_read_b64_tr_b16 v[84:85], v24 offset:32768
  v_mul_f32 v65, v161, v64
s_branch Ib1x
Ib1:
s_branch Ibr
Ib1x:
  v_mfma_f32_32x32x16_bf16 v[32:47], v[228:231], v[120:123], v[32:47]
  ds_read_b64_tr_b16 v[116:117], v27 offset:6144
  ds_read_b64_tr_b16 v[118:119], v27 offset:6400
  ds_read_b64_tr_b16 v[86:87], v24 offset:33024
  s_waitcnt lgkmcnt(6)
  v_max3_u32 v140, v140, v141, v142
  v_mfma_f32_32x32x16_bf16 v[32:47], v[232:235], v[124:127], v[32:47]
  ds_read_b64_tr_b16 v[120:121], v27 offset:7168
  ds_read_b64_tr_b16 v[122:123], v27 offset:7424
  ds_read_b64_tr_b16 v[88:89], v24 offset:33792
  v_max3_u32 v143, v143, v144, v145
  v_mov_b64 v[158:159], v[156:157]
  v_mfma_f32_32x32x16_bf16 v[32:47], v[236:239], v[128:131], v[32:47]
  ds_read_b64_tr_b16 v[90:91], v24 offset:34048
  ds_read_b64_tr_b16 v[92:93], v24 offset:34816
  ds_read_b64_tr_b16 v[94:95], v24 offset:35072
  ds_read_b64_tr_b16 v[96:97], v24 offset:35840
  v_max3_u32 v140, v140, v146, v147
  v_max_u32 v140, v140, v143
  s_add_u32 s97, s43, 0x00ec0000
  buffer_store_dwordx4 v[200:203], v9, s[20:23], s97 offen sc1
  s_waitcnt lgkmcnt(11)
  v_mfma_f32_32x32x16_bf16 v[32:47], v[240:243], v[132:135], v[32:47]
  ds_read_b64_tr_b16 v[98:99], v24 offset:36096
  ds_read_b64_tr_b16 v[100:101], v24 offset:36864
  ds_read_b64_tr_b16 v[102:103], v24 offset:37120
  ds_read_b64_tr_b16 v[104:105], v24 offset:37888
  ds_read_b64_tr_b16 v[106:107], v24 offset:38144
  v_mfma_f32_32x32x16_bf16 v[32:47], v[244:247], v[136:139], v[32:47]
  ds_read_b64_tr_b16 v[108:109], v24 offset:38912
  ds_read_b64_tr_b16 v[110:111], v24 offset:39168
  ds_read_b64_tr_b16 v[112:113], v24 offset:39936
  ds_read_b64_tr_b16 v[114:115], v24 offset:40192
  s_waitcnt lgkmcnt(14)
  v_mfma_f32_32x32x16_bf16 v[32:47], v[248:251], v[116:119], v[32:47]
  v_mfma_f32_32x32x16_bf16 v[32:47], v[252:255], v[120:123], v[32:47]
  v_mfma_f32_32x32x16_bf16 v[32:47], v[204:207], v[156:159], v[32:47]
  v_cmp_eq_u32 vcc, -1, v140
  s_and_b64 vcc, vcc, s[56:57]
  s_cbranch_scc1 G_r11
G_b11:
  s_waitcnt lgkmcnt(0)
  s_barrier
  v_mfma_f32_32x32x16_bf16 v[48:63], a[176:179], v[84:87], 0
  v_mfma_f32_32x32x16_bf16 v[48:63], a[180:183], v[88:91], v[48:63]
  v_mul_f32 v72, v32, v32
  v_mul_f32 v73, v33, v33
  v_fma_f32 v72, v72, v65, v64
  v_mul_f32 v74, v34, v34
  v_fma_f32 v73, v73, v65, v64
  v_mfma_f32_32x32x16_bf16 v[48:63], a[184:187], v[92:95], v[48:63]
  v_mul_f32 v72, v72, v32
  v_mul_f32 v75, v35, v35
  v_fma_f32 v74, v74, v65, v64
  v_mul_f32 v73, v73, v33
  v_mfma_f32_32x32x16_bf16 v[48:63], a[188:191], v[96:99], v[48:63]
  ds_read_b64_tr_b16 v[124:125], v25 offset:32768
  ds_read_b64_tr_b16 v[126:127], v25 offset:33024
  v_mul_f32 v40, v40, v32
  v_mul_f32 v76, v36, v36
  v_exp_f32 v72, v72
  v_mfma_f32_32x32x16_bf16 v[48:63], a[192:195], v[100:103], v[48:63]
  ds_read_b64_tr_b16 v[128:129], v25 offset:33792
  ds_read_b64_tr_b16 v[130:131], v25 offset:34048
  v_fma_f32 v75, v75, v65, v64
  v_mul_f32 v74, v74, v34
  v_mul_f32 v41, v41, v33
  v_mul_f32 v77, v37, v37
  v_mfma_f32_32x32x16_bf16 v[48:63], a[196:199], v[104:107], v[48:63]
  ds_read_b64_tr_b16 v[132:133], v25 offset:34816
  ds_read_b64_tr_b16 v[134:135], v25 offset:35072
  v_exp_f32 v73, v73
  v_fma_f32 v76, v76, v65, v64
  v_mul_f32 v75, v75, v35
  v_mfma_f32_32x32x16_bf16 v[48:63], a[200:203], v[108:111], v[48:63]
  ds_read_b64_tr_b16 v[136:137], v25 offset:35840
  ds_read_b64_tr_b16 v[138:139], v25 offset:36096
  v_mul_f32 v42, v42, v34
  v_fma_f32 v72, v72, v66, v66
  v_mul_f32 v78, v38, v38
  v_mfma_f32_32x32x16_bf16 v[48:63], a[204:207], v[112:115], v[48:63]
  ds_read_b64_tr_b16 v[116:117], v25 offset:36864
  ds_read_b64_tr_b16 v[118:119], v25 offset:37120
  v_exp_f32 v74, v74
  v_fma_f32 v77, v77, v65, v64
  v_mul_f32 v76, v76, v36
  s_waitcnt lgkmcnt(6)
  v_mfma_f32_32x32x16_bf16 v[48:63], a[208:211], v[124:127], v[48:63]
  ds_read_b64_tr_b16 v[120:121], v25 offset:37888
  ds_read_b64_tr_b16 v[122:123], v25 offset:38144
  s_add_u32 s97, s44, 0x00ec0000
  buffer_store_dwordx4 v[200:203], v9, s[20:23], s97 offen sc1
  v_mul_f32 v43, v43, v35
  v_fma_f32 v73, v73, v66, v66
  v_mfma_f32_32x32x16_bf16 v[48:63], a[212:215], v[128:131], v[48:63]
  ds_read_b64_tr_b16 v[124:125], v25 offset:38912
  ds_read_b64_tr_b16 v[126:127], v25 offset:39168
  v_mul_f32 v79, v39, v39
  v_exp_f32 v75, v75
  v_fma_f32 v78, v78, v65, v64
  s_waitcnt lgkmcnt(6)
  v_mfma_f32_32x32x16_bf16 v[48:63], a[216:219], v[132:135], v[48:63]
  ds_read_b64_tr_b16 v[128:129], v25 offset:39936
  ds_read_b64_tr_b16 v[130:131], v25 offset:40192
  v_rcp_f32 v72, v72
  v_mul_f32 v77, v77, v37
  v_mul_f32 v44, v44, v36
  v_mfma_f32_32x32x16_bf16 v[48:63], a[220:223], v[136:139], v[48:63]
  ds_read_b64_tr_b16 v[132:133], v26 offset:32768
  ds_read_b64_tr_b16 v[134:135], v26 offset:33024
  v_fma_f32 v74, v74, v66, v66
  v_exp_f32 v76, v76
  v_fma_f32 v79, v79, v65, v64
  s_waitcnt lgkmcnt(6)
  v_mfma_f32_32x32x16_bf16 v[48:63], a[224:227], v[116:119], v[48:63]
  ds_read_b64_tr_b16 v[136:137], v26 offset:33792
  ds_read_b64_tr_b16 v[138:139], v26 offset:34048
  v_rcp_f32 v73, v73
  v_mul_f32 v78, v78, v38
  v_mul_f32 v45, v45, v37
  v_fma_f32 v75, v75, v66, v66
  v_mfma_f32_32x32x16_bf16 v[48:63], a[228:231], v[120:123], v[48:63]
  ds_read_b64_tr_b16 v[116:117], v26 offset:34816
  ds_read_b64_tr_b16 v[118:119], v26 offset:35072
  v_exp_f32 v77, v77
  v_mul_f32 v40, v40, v72
  v_rcp_f32 v74, v74
  s_waitcnt lgkmcnt(6)
  v_mfma_f32_32x32x16_bf16 v[48:63], a[232:235], v[124:127], v[48:63]
  ds_read_b64_tr_b16 v[120:121], v26 offset:35840
  ds_read_b64_tr_b16 v[122:123], v26 offset:36096
  s_add_u32 s3, s13, 0x00428000
  buffer_load_dwordx4 v[68:71], v20, s[8:11], s3 offen sc1
  v_mul_f32 v79, v79, v39
  v_mul_f32 v46, v46, v38
  v_mfma_f32_32x32x16_bf16 v[48:63], a[236:239], v[128:131], v[48:63]
  ds_read_b64_tr_b16 v[124:125], v26 offset:36864
  ds_read_b64_tr_b16 v[126:127], v26 offset:37120
  v_fma_f32 v76, v76, v66, v66
  v_exp_f32 v78, v78
  v_mul_f32 v41, v41, v73
  s_waitcnt lgkmcnt(6)
  v_mfma_f32_32x32x16_bf16 v[48:63], a[240:243], v[132:135], v[48:63]
  ds_read_b64_tr_b16 v[128:129], v26 offset:37888
  ds_read_b64_tr_b16 v[130:131], v26 offset:38144
  s_add_u32 m0, s60, 0x00000000
  s_add_u32 s89, s40, 0x00b00000
  buffer_load_dwordx4 v9, s[8:11], s89 offen offset:0 sc1 lds
  v_rcp_f32 v75, v75
  v_mul_f32 v47, v47, v39
  v_mfma_f32_32x32x16_bf16 v[48:63], a[244:247], v[136:139], v[48:63]
  ds_read_b64_tr_b16 v[132:133], v26 offset:38912
  ds_read_b64_tr_b16 v[134:135], v26 offset:39168
  buffer_load_dwordx4 v9, s[8:11], s89 offen offset:1024 sc1 lds
  v_fma_f32 v77, v77, v66, v66
  v_exp_f32 v79, v79
  v_mul_f32 v42, v42, v74
  s_waitcnt lgkmcnt(6)
  v_mfma_f32_32x32x16_bf16 v[48:63], a[248:251], v[116:119], v[48:63]
  ds_read_b64_tr_b16 v[136:137], v26 offset:39936
  ds_read_b64_tr_b16 v[138:139], v26 offset:40192
  v_cvt_pk_bf16_f32 v80, v40, v41
  v_rcp_f32 v76, v76
  v_fma_f32 v78, v78, v66, v66
  v_mfma_f32_32x32x16_bf16 v[48:63], a[252:255], v[120:123], v[48:63]
  ds_read_b64_tr_b16 v[116:117], v27 offset:32768
  ds_read_b64_tr_b16 v[118:119], v27 offset:33024
  v_add_u32 v148, 0x10000, v0
  v_mul_f32 v43, v43, v75
  v_rcp_f32 v77, v77
  s_waitcnt lgkmcnt(6)
  v_mfma_f32_32x32x16_bf16 v[48:63], v[208:211], v[124:127], v[48:63]
  ds_read_b64_tr_b16 v[120:121], v27 offset:33792
  ds_read_b64_tr_b16 v[122:123], v27 offset:34048
  s_waitcnt vmcnt(5)
  ds_read2st64_b32 v[140:141], v148 offset0:0 offset1:4
  buffer_load_dwordx4 v9, s[8:11], s89 offen offset:2048 sc1 lds
  v_fma_f32 v79, v79, v66, v66
  v_mfma_f32_32x32x16_bf16 v[48:63], v[212:215], v[128:131], v[48:63]
  ds_read_b64_tr_b16 v[124:125], v27 offset:34816
  ds_read_b64_tr_b16 v[126:127], v27 offset:35072
  ds_read2st64_b32 v[142:143], v148 offset0:8 offset1:12
  buffer_load_dwordx4 v9, s[8:11], s89 offen offset:3072 sc1 lds
  v_mul_f32 v44, v44, v76
  s_waitcnt lgkmcnt(8)
  v_mfma_f32_32x32x16_bf16 v[48:63], v[216:219], v[132:135], v[48:63]
  ds_read_b64_tr_b16 v[128:129], v27 offset:35840
  ds_read_b64_tr_b16 v[130:131], v27 offset:36096
  ds_read2st64_b32 v[144:145], v148 offset0:16 offset1:20
  v_cvt_pk_bf16_f32 v81, v42, v43
  v_rcp_f32 v78, v78
  v_mul_f32 v45, v45, v77
  v_mfma_f32_32x32x16_bf16 v[48:63], v[220:223], v[136:139], v[48:63]
  ds_read_b64_tr_b16 v[132:133], v27 offset:36864
  ds_read_b64_tr_b16 v[134:135], v27 offset:37120
  ds_read2st64_b32 v[146:147], v148 offset0:24 offset1:28
  v_rcp_f32 v79, v79
  v_mul_f32 v46, v46, v78
  s_waitcnt lgkmcnt(10)
  v_mfma_f32_32x32x16_bf16 v[48:63], v[224:227], v[116:119], v[48:63]
  ds_read_b64_tr_b16 v[136:137], v27 offset:37888
  ds_read_b64_tr_b16 v[138:139], v27 offset:38144
  ds_read_b64_tr_b16 v[84:85], v28 offset:0
  s_add_u32 m0, s60, 0x00001000
  s_add_u32 s89, s40, 0x00b01000
  buffer_load_dwordx4 v9, s[8:11], s89 offen offset:0 sc1 lds
  v_cvt_pk_bf16_f32 v82, v44, v45
  v_mul_f32 v47, v47, v79
  v_mfma_f32_32x32x16_bf16 v[48:63], v[228:231], v[120:123], v[48:63]
  ds_read_b64_tr_b16 v[116:117], v27 offset:38912
  ds_read_b64_tr_b16 v[118:119], v27 offset:39168
  ds_read_b64_tr_b16 v[86:87], v28 offset:256
  s_waitcnt lgkmcnt(6)
  v_max3_u32 v140, v140, v141, v142
  buffer_load_dwordx4 v9, s[8:11], s89 offen offset:1024 sc1 lds
  v_mfma_f32_32x32x16_bf16 v[48:63], v[232:235], v[124:127], v[48:63]
  ds_read_b64_tr_b16 v[120:121], v27 offset:39936
  ds_read_b64_tr_b16 v[122:123], v27 offset:40192
  ds_read_b64_tr_b16 v[88:89], v28 offset:1024
  v_max3_u32 v143, v143, v144, v145
  v_cvt_pk_bf16_f32 v83, v46, v47
  s_waitcnt vmcnt(8)
  s_add_u32 s98, s43, 0x00c00000
  buffer_store_dwordx4 v[80:83], v9, s[20:23], s98 offen sc1
  v_mfma_f32_32x32x16_bf16 v[48:63], v[236:239], v[128:131], v[48:63]
  ds_read_b64_tr_b16 v[90:91], v28 offset:1280
  ds_read_b64_tr_b16 v[92:93], v28 offset:2048
  ds_read_b64_tr_b16 v[94:95], v28 offset:2304
  ds_read_b64_tr_b16 v[96:97], v28 offset:3072
  v_max3_u32 v140, v140, v146, v147
  v_max_u32 v140, v140, v143
  s_waitcnt lgkmcnt(11)
  v_mfma_f32_32x32x16_bf16 v[48:63], v[240:243], v[132:135], v[48:63]
  ds_read_b64_tr_b16 v[98:99], v28 offset:3328
  ds_read_b64_tr_b16 v[100:101], v28 offset:4096
  ds_read_b64_tr_b16 v[102:103], v28 offset:4352
  ds_read_b64_tr_b16 v[104:105], v28 offset:5120
  ds_read_b64_tr_b16 v[106:107], v28 offset:5376
  buffer_load_dwordx4 v9, s[8:11], s89 offen offset:2048 sc1 lds
  v_mfma_f32_32x32x16_bf16 v[48:63], v[244:247], v[136:139], v[48:63]
  ds_read_b64_tr_b16 v[108:109], v28 offset:6144
  ds_read_b64_tr_b16 v[110:111], v28 offset:6400
  ds_read_b64_tr_b16 v[112:113], v28 offset:7168
  ds_read_b64_tr_b16 v[114:115], v28 offset:7424
  buffer_load_dwordx4 v9, s[8:11], s89 offen offset:3072 sc1 lds
  s_waitcnt lgkmcnt(14)
  v_mfma_f32_32x32x16_bf16 v[48:63], v[248:251], v[116:119], v[48:63]
  s_waitcnt vmcnt(9)
T_b11:
  v_cmp_eq_u32 vcc, -1, v68
  s_and_b64 vcc, vcc, s[56:57]
  s_cbranch_scc1 T_r11
  v_mfma_f32_32x32x16_bf16 v[48:63], v[252:255], v[120:123], v[48:63]
  v_mov_b32 v156, v71
  v_mov_b32 v157, v71
  v_mov_b64 v[158:159], v[156:157]
  s_nop 1
  v_mfma_f32_32x32x16_bf16 v[48:63], v[204:207], v[156:159], v[48:63]
  v_cmp_eq_u32 vcc, -1, v140
  s_and_b64 vcc, vcc, s[56:57]
  s_cbranch_scc1 G_r12
G_b12:
  s_waitcnt lgkmcnt(0)
  s_barrier
  v_mfma_f32_32x32x16_bf16 v[32:47], a[176:179], v[84:87], 0
  v_mfma_f32_32x32x16_bf16 v[32:47], a[180:183], v[88:91], v[32:47]
  s_add_u32 m0, s60, 0x00008000
  s_add_u32 s89, s41, 0x00b00000
  buffer_load_dwordx4 v9, s[8:11], s89 offen offset:0 sc1 lds
  v_mul_f32 v72, v48, v48
  v_mul_f32 v73, v49, v49
  v_fma_f32 v72, v72, v69, v68
  v_mul_f32 v74, v50, v50
  v_mfma_f32_32x32x16_bf16 v[32:47], a[184:187], v[92:95], v[32:47]
  buffer_load_dwordx4 v9, s[8:11], s89 offen offset:1024 sc1 lds
  v_fma_f32 v73, v73, v69, v68
  v_mul_f32 v72, v72, v48
  v_mul_f32 v75, v51, v51
  v_fma_f32 v74, v74, v69, v68
  v_mfma_f32_32x32x16_bf16 v[32:47], a[188:191], v[96:99], v[32:47]
  ds_read_b64_tr_b16 v[124:125], v29 offset:0
  ds_read_b64_tr_b16 v[126:127], v29 offset:256
  v_mul_f32 v73, v73, v49
  v_mul_f32 v56, v56, v48
  v_mul_f32 v76, v52, v52
  v_mfma_f32_32x32x16_bf16 v[32:47], a[192:195], v[100:103], v[32:47]
  ds_read_b64_tr_b16 v[128:129], v29 offset:1024
  ds_read_b64_tr_b16 v[130:131], v29 offset:1280
  v_exp_f32 v72, v72
  v_fma_f32 v75, v75, v69, v68
  v_mul_f32 v74, v74, v50
  v_mfma_f32_32x32x16_bf16 v[32:47], a[196:199], v[104:107], v[32:47]
  ds_read_b64_tr_b16 v[132:133], v29 offset:2048
  ds_read_b64_tr_b16 v[134:135], v29 offset:2304
  buffer_load_dwordx4 v9, s[8:11], s89 offen offset:2048 sc1 lds
  v_mul_f32 v57, v57, v49
  v_mul_f32 v77, v53, v53
  v_exp_f32 v73, v73
  v_mfma_f32_32x32x16_bf16 v[32:47], a[200:203], v[108:111], v[32:47]
  ds_read_b64_tr_b16 v[136:137], v29 offset:3072
  ds_read_b64_tr_b16 v[138:139], v29 offset:3328
  buffer_load_dwordx4 v9, s[8:11], s89 offen offset:3072 sc1 lds
  v_fma_f32 v76, v76, v69, v68
  v_mul_f32 v75, v75, v51
  v_mfma_f32_32x32x16_bf16 v[32:47], a[204:207], v[112:115], v[32:47]
  ds_read_b64_tr_b16 v[116:117], v29 offset:4096
  ds_read_b64_tr_b16 v[118:119], v29 offset:4352
  v_mul_f32 v58, v58, v50
  v_fma_f32 v72, v72, v70, v70
  v_mul_f32 v78, v54, v54
  s_waitcnt lgkmcnt(6)
  v_mfma_f32_32x32x16_bf16 v[32:47], a[208:211], v[124:127], v[32:47]
  ds_read_b64_tr_b16 v[120:121], v29 offset:5120
  ds_read_b64_tr_b16 v[122:123], v29 offset:5376
  v_exp_f32 v74, v74
  v_fma_f32 v77, v77, v69, v68
  v_mul_f32 v76, v76, v52
  v_mfma_f32_32x32x16_bf16 v[32:47], a[212:215], v[128:131], v[32:47]
  ds_read_b64_tr_b16 v[124:125], v29 offset:6144
  ds_read_b64_tr_b16 v[126:127], v29 offset:6400
  s_add_u32 m0, s60, 0x00009000
  s_add_u32 s89, s41, 0x00b01000
  buffer_load_dwordx4 v9, s[8:11], s89 offen offset:0 sc1 lds
  v_mul_f32 v59, v59, v51
  v_fma_f32 v73, v73, v70, v70
  v_mul_f32 v79, v55, v55
  s_waitcnt lgkmcnt(6)
  v_mfma_f32_32x32x16_bf16 v[32:47], a[216:219], v[132:135], v[32:47]
  ds_read_b64_tr_b16 v[128:129], v29 offset:7168
  ds_read_b64_tr_b16 v[130:131], v29 offset:7424
  buffer_load_dwordx4 v9, s[8:11], s89 offen offset:1024 sc1 lds
  v_exp_f32 v75, v75
  v_fma_f32 v78, v78, v69, v68
  v_mfma_f32_32x32x16_bf16 v[32:47], a[220:223], v[136:139], v[32:47]
  ds_read_b64_tr_b16 v[132:133], v30 offset:0
  ds_read_b64_tr_b16 v[134:135], v30 offset:256
  v_rcp_f32 v72, v72
  v_mul_f32 v77, v77, v53
  v_mul_f32 v60, v60, v52
  s_waitcnt lgkmcnt(6)
  v_mfma_f32_32x32x16_bf16 v[32:47], a[224:227], v[116:119], v[32:47]
  ds_read_b64_tr_b16 v[136:137], v30 offset:1024
  ds_read_b64_tr_b16 v[138:139], v30 offset:1280
  v_fma_f32 v74, v74, v70, v70
  v_exp_f32 v76, v76
  v_fma_f32 v79, v79, v69, v68
  v_mfma_f32_32x32x16_bf16 v[32:47], a[228:231], v[120:123], v[32:47]
  ds_read_b64_tr_b16 v[116:117], v30 offset:2048
  ds_read_b64_tr_b16 v[118:119], v30 offset:2304
  buffer_load_dwordx4 v9, s[8:11], s89 offen offset:2048 sc1 lds
  v_rcp_f32 v73, v73
  v_mul_f32 v78, v78, v54
  v_mul_f32 v61, v61, v53
  s_waitcnt lgkmcnt(6)
  v_mfma_f32_32x32x16_bf16 v[32:47], a[232:235], v[124:127], v[32:47]
  ds_read_b64_tr_b16 v[120:121], v30 offset:3072
  ds_read_b64_tr_b16 v[122:123], v30 offset:3328
  s_add_u32 s3, s14, 0x00428000
  buffer_load_dwordx4 v[64:67], v20, s[8:11], s3 offen sc1
  buffer_load_dwordx4 v9, s[8:11], s89 offen offset:3072 sc1 lds
  v_fma_f32 v75, v75, v70, v70
  v_mfma_f32_32x32x16_bf16 v[32:47], a[236:239], v[128:131], v[32:47]
  ds_read_b64_tr_b16 v[124:125], v30 offset:4096
  ds_read_b64_tr_b16 v[126:127], v30 offset:4352
  v_exp_f32 v77, v77
  v_mul_f32 v56, v56, v72
  v_rcp_f32 v74, v74
  s_waitcnt lgkmcnt(6)
  v_mfma_f32_32x32x16_bf16 v[32:47], a[240:243], v[132:135], v[32:47]
  ds_read_b64_tr_b16 v[128:129], v30 offset:5120
  ds_read_b64_tr_b16 v[130:131], v30 offset:5376
  v_mul_f32 v79, v79, v55
  v_mul_f32 v62, v62, v54
  v_fma_f32 v76, v76, v70, v70
  v_exp_f32 v78, v78
  v_mfma_f32_32x32x16_bf16 v[32:47], a[244:247], v[136:139], v[32:47]
  ds_read_b64_tr_b16 v[132:133], v30 offset:6144
  ds_read_b64_tr_b16 v[134:135], v30 offset:6400
  v_mul_f32 v57, v57, v73
  v_rcp_f32 v75, v75
  v_mul_f32 v63, v63, v55
  s_waitcnt lgkmcnt(6)
  v_mfma_f32_32x32x16_bf16 v[32:47], a[248:251], v[116:119], v[32:47]
  ds_read_b64_tr_b16 v[136:137], v30 offset:7168
  ds_read_b64_tr_b16 v[138:139], v30 offset:7424
  v_fma_f32 v77, v77, v70, v70
  v_exp_f32 v79, v79
  v_mul_f32 v58, v58, v74
  v_mfma_f32_32x32x16_bf16 v[32:47], a[252:255], v[120:123], v[32:47]
  ds_read_b64_tr_b16 v[116:117], v31 offset:0
  ds_read_b64_tr_b16 v[118:119], v31 offset:256
  v_cvt_pk_bf16_f32 v80, v56, v57
  v_rcp_f32 v76, v76
  v_fma_f32 v78, v78, v70, v70
  s_waitcnt lgkmcnt(6)
  v_mfma_f32_32x32x16_bf16 v[32:47], v[208:211], v[124:127], v[32:47]
  ds_read_b64_tr_b16 v[120:121], v31 offset:1024
  ds_read_b64_tr_b16 v[122:123], v31 offset:1280
  s_waitcnt vmcnt(9)
  ds_read2st64_b32 v[140:141], v0 offset0:0 offset1:4
  v_mul_f32 v59, v59, v75
  v_rcp_f32 v77, v77
  v_mfma_f32_32x32x16_bf16 v[32:47], v[212:215], v[128:131], v[32:47]
  ds_read_b64_tr_b16 v[124:125], v31 offset:2048
  ds_read_b64_tr_b16 v[126:127], v31 offset:2304
  ds_read2st64_b32 v[142:143], v0 offset0:8 offset1:12
  v_fma_f32 v79, v79, v70, v70
  v_mul_f32 v60, v60, v76
  s_waitcnt lgkmcnt(8)
  v_mfma_f32_32x32x16_bf16 v[32:47], v[216:219], v[132:135], v[32:47]
  ds_read_b64_tr_b16 v[128:129], v31 offset:3072
  ds_read_b64_tr_b16 v[130:131], v31 offset:3328
  ds_read2st64_b32 v[144:145], v0 offset0:16 offset1:20
  v_cvt_pk_bf16_f32 v81, v58, v59
  v_rcp_f32 v78, v78
  v_mfma_f32_32x32x16_bf16 v[32:47], v[220:223], v[136:139], v[32:47]
  ds_read_b64_tr_b16 v[132:133], v31 offset:4096
  ds_read_b64_tr_b16 v[134:135], v31 offset:4352
  ds_read2st64_b32 v[146:147], v0 offset0:24 offset1:28
  v_mul_f32 v61, v61, v77
  v_rcp_f32 v79, v79
  v_mul_f32 v62, v62, v78
  s_waitcnt lgkmcnt(10)
  v_mfma_f32_32x32x16_bf16 v[32:47], v[224:227], v[116:119], v[32:47]
  ds_read_b64_tr_b16 v[136:137], v31 offset:5120
  ds_read_b64_tr_b16 v[138:139], v31 offset:5376
  ds_read_b64_tr_b16 v[84:85], v24 offset:0
  s_add_u32 s97, s45, 0x00ec0000
  buffer_store_dwordx4 v[200:203], v9, s[24:27], s97 offen sc1
  v_cvt_pk_bf16_f32 v82, v60, v61
  v_mfma_f32_32x32x16_bf16 v[32:47], v[228:231], v[120:123], v[32:47]
  ds_read_b64_tr_b16 v[116:117], v31 offset:6144
  ds_read_b64_tr_b16 v[118:119], v31 offset:6400
  ds_read_b64_tr_b16 v[86:87], v24 offset:256
  s_waitcnt lgkmcnt(6)
  v_max3_u32 v140, v140, v141, v142
  v_mul_f32 v63, v63, v79
  v_mfma_f32_32x32x16_bf16 v[32:47], v[232:235], v[124:127], v[32:47]
  ds_read_b64_tr_b16 v[120:121], v31 offset:7168
  ds_read_b64_tr_b16 v[122:123], v31 offset:7424
  ds_read_b64_tr_b16 v[88:89], v24 offset:1024
  v_max3_u32 v143, v143, v144, v145
  v_cvt_pk_bf16_f32 v83, v62, v63
  s_add_u32 s98, s44, 0x00c00000
  buffer_store_dwordx4 v[80:83], v9, s[20:23], s98 offen sc1
  v_mfma_f32_32x32x16_bf16 v[32:47], v[236:239], v[128:131], v[32:47]
  ds_read_b64_tr_b16 v[90:91], v24 offset:1280
  ds_read_b64_tr_b16 v[92:93], v24 offset:2048
  ds_read_b64_tr_b16 v[94:95], v24 offset:2304
  ds_read_b64_tr_b16 v[96:97], v24 offset:3072
  v_max3_u32 v140, v140, v146, v147
  v_max_u32 v140, v140, v143
  s_waitcnt lgkmcnt(11)
  v_mfma_f32_32x32x16_bf16 v[32:47], v[240:243], v[132:135], v[32:47]
  ds_read_b64_tr_b16 v[98:99], v24 offset:3328
  ds_read_b64_tr_b16 v[100:101], v24 offset:4096
  ds_read_b64_tr_b16 v[102:103], v24 offset:4352
  ds_read_b64_tr_b16 v[104:105], v24 offset:5120
  ds_read_b64_tr_b16 v[106:107], v24 offset:5376
  v_mfma_f32_32x32x16_bf16 v[32:47], v[244:247], v[136:139], v[32:47]
  ds_read_b64_tr_b16 v[108:109], v24 offset:6144
  ds_read_b64_tr_b16 v[110:111], v24 offset:6400
  ds_read_b64_tr_b16 v[112:113], v24 offset:7168
  ds_read_b64_tr_b16 v[114:115], v24 offset:7424
  s_waitcnt lgkmcnt(14)
  v_mfma_f32_32x32x16_bf16 v[32:47], v[248:251], v[116:119], v[32:47]
  s_waitcnt vmcnt(3)
T_b12:
  v_cmp_eq_u32 vcc, -1, v64
  s_and_b64 vcc, vcc, s[56:57]
  s_cbranch_scc1 T_r12
  v_mfma_f32_32x32x16_bf16 v[32:47], v[252:255], v[120:123], v[32:47]
  v_mov_b32 v156, v67
  v_mov_b32 v157, v67
  v_mov_b64 v[158:159], v[156:157]
  s_nop 1
  v_mfma_f32_32x32x16_bf16 v[32:47], v[204:207], v[156:159], v[32:47]
  v_cmp_eq_u32 vcc, -1, v140
  s_and_b64 vcc, vcc, s[56:57]
  s_cbranch_scc1 G_r13
G_b13:
  s_waitcnt lgkmcnt(0)
  s_barrier
  v_mfma_f32_32x32x16_bf16 v[48:63], a[176:179], v[84:87], 0
  v_mfma_f32_32x32x16_bf16 v[48:63], a[180:183], v[88:91], v[48:63]
  s_add_u32 m0, s60, 0x00010000
  s_add_u32 s89, s42, 0x00b00000
  buffer_load_dwordx4 v9, s[8:11], s89 offen offset:0 sc1 lds
  v_mul_f32 v72, v32, v32
  v_mul_f32 v73, v33, v33
  v_fma_f32 v72, v72, v65, v64
  v_mul_f32 v74, v34, v34
  v_mfma_f32_32x32x16_bf16 v[48:63], a[184:187], v[92:95], v[48:63]
  buffer_load_dwordx4 v9, s[8:11], s89 offen offset:1024 sc1 lds
  v_fma_f32 v73, v73, v65, v64
  v_mul_f32 v72, v72, v32
  v_mul_f32 v75, v35, v35
  v_fma_f32 v74, v74, v65, v64
  v_mfma_f32_32x32x16_bf16 v[48:63], a[188:191], v[96:99], v[48:63]
  ds_read_b64_tr_b16 v[124:125], v25 offset:0
  ds_read_b64_tr_b16 v[126:127], v25 offset:256
  v_mul_f32 v73, v73, v33
  v_mul_f32 v40, v40, v32
  v_mul_f32 v76, v36, v36
  v_mfma_f32_32x32x16_bf16 v[48:63], a[192:195], v[100:103], v[48:63]
  ds_read_b64_tr_b16 v[128:129], v25 offset:1024
  ds_read_b64_tr_b16 v[130:131], v25 offset:1280
  v_exp_f32 v72, v72
  v_fma_f32 v75, v75, v65, v64
  v_mul_f32 v74, v74, v34
  v_mfma_f32_32x32x16_bf16 v[48:63], a[196:199], v[104:107], v[48:63]
  ds_read_b64_tr_b16 v[132:133], v25 offset:2048
  ds_read_b64_tr_b16 v[134:135], v25 offset:2304
  buffer_load_dwordx4 v9, s[8:11], s89 offen offset:2048 sc1 lds
  v_mul_f32 v41, v41, v33
  v_mul_f32 v77, v37, v37
  v_mfma_f32_32x32x16_bf16 v[48:63], a[200:203], v[108:111], v[48:63]
  ds_read_b64_tr_b16 v[136:137], v25 offset:3072
  ds_read_b64_tr_b16 v[138:139], v25 offset:3328
  buffer_load_dwordx4 v9, s[8:11], s89 offen offset:3072 sc1 lds
  v_exp_f32 v73, v73
  v_fma_f32 v76, v76, v65, v64
  v_mul_f32 v75, v75, v35
  v_mfma_f32_32x32x16_bf16 v[48:63], a[204:207], v[112:115], v[48:63]
  ds_read_b64_tr_b16 v[116:117], v25 offset:4096
  ds_read_b64_tr_b16 v[118:119], v25 offset:4352
  v_mul_f32 v42, v42, v34
  v_fma_f32 v72, v72, v66, v66
  v_mul_f32 v78, v38, v38
  s_waitcnt lgkmcnt(6)
  v_mfma_f32_32x32x16_bf16 v[48:63], a[208:211], v[124:127], v[48:63]
  ds_read_b64_tr_b16 v[120:121], v25 offset:5120
  ds_read_b64_tr_b16 v[122:123], v25 offset:5376
  v_exp_f32 v74, v74
  v_fma_f32 v77, v77, v65, v64
  v_mul_f32 v76, v76, v36
  v_mfma_f32_32x32x16_bf16 v[48:63], a[212:215], v[128:131], v[48:63]
  ds_read_b64_tr_b16 v[124:125], v25 offset:6144
  ds_read_b64_tr_b16 v[126:127], v25 offset:6400
  s_add_u32 m0, s60, 0x00011000
  s_add_u32 s89, s42, 0x00b01000
  buffer_load_dwordx4 v9, s[8:11], s89 offen offset:0 sc1 lds
  v_mul_f32 v43, v43, v35
  v_fma_f32 v73, v73, v66, v66
  s_waitcnt lgkmcnt(6)
  v_mfma_f32_32x32x16_bf16 v[48:63], a[216:219], v[132:135], v[48:63]
  ds_read_b64_tr_b16 v[128:129], v25 offset:7168
  ds_read_b64_tr_b16 v[130:131], v25 offset:7424
  buffer_load_dwordx4 v9, s[8:11], s89 offen offset:1024 sc1 lds
  v_mul_f32 v79, v39, v39
  v_exp_f32 v75, v75
  v_fma_f32 v78, v78, v65, v64
  v_mfma_f32_32x32x16_bf16 v[48:63], a[220:223], v[136:139], v[48:63]
  ds_read_b64_tr_b16 v[132:133], v26 offset:0
  ds_read_b64_tr_b16 v[134:135], v26 offset:256
  v_rcp_f32 v72, v72
  v_mul_f32 v77, v77, v37
  v_mul_f32 v44, v44, v36
  s_waitcnt lgkmcnt(6)
  v_mfma_f32_32x32x16_bf16 v[48:63], a[224:227], v[116:119], v[48:63]
  ds_read_b64_tr_b16 v[136:137], v26 offset:1024
  ds_read_b64_tr_b16 v[138:139], v26 offset:1280
  v_fma_f32 v74, v74, v66, v66
  v_exp_f32 v76, v76
  v_fma_f32 v79, v79, v65, v64
  v_mfma_f32_32x32x16_bf16 v[48:63], a[228:231], v[120:123], v[48:63]
  ds_read_b64_tr_b16 v[116:117], v26 offset:2048
  ds_read_b64_tr_b16 v[118:119], v26 offset:2304
  buffer_load_dwordx4 v9, s[8:11], s89 offen offset:2048 sc1 lds
  v_rcp_f32 v73, v73
  v_mul_f32 v78, v78, v38
  s_waitcnt lgkmcnt(6)
  v_mfma_f32_32x32x16_bf16 v[48:63], a[232:235], v[124:127], v[48:63]
  ds_read_b64_tr_b16 v[120:121], v26 offset:3072
  ds_read_b64_tr_b16 v[122:123], v26 offset:3328
  s_add_u32 s3, s12, 0x0042c000
  buffer_load_dwordx4 v[68:71], v20, s[8:11], s3 offen sc1
  buffer_load_dwordx4 v9, s[8:11], s89 offen offset:3072 sc1 lds
  v_mul_f32 v45, v45, v37
  v_fma_f32 v75, v75, v66, v66
  v_mfma_f32_32x32x16_bf16 v[48:63], a[236:239], v[128:131], v[48:63]
  ds_read_b64_tr_b16 v[124:125], v26 offset:4096
  ds_read_b64_tr_b16 v[126:127], v26 offset:4352
  v_exp_f32 v77, v77
  v_mul_f32 v40, v40, v72
  v_rcp_f32 v74, v74
  s_waitcnt lgkmcnt(6)
  v_mfma_f32_32x32x16_bf16 v[48:63], a[240:243], v[132:135], v[48:63]
  ds_read_b64_tr_b16 v[128:129], v26 offset:5120
  ds_read_b64_tr_b16 v[130:131], v26 offset:5376
  v_mul_f32 v79, v79, v39
  v_mul_f32 v46, v46, v38
  v_fma_f32 v76, v76, v66, v66
  v_mfma_f32_32x32x16_bf16 v[48:63], a[244:247], v[136:139], v[48:63]
  ds_read_b64_tr_b16 v[132:133], v26 offset:6144
  ds_read_b64_tr_b16 v[134:135], v26 offset:6400
  v_exp_f32 v78, v78
  v_mul_f32 v41, v41, v73
  v_rcp_f32 v75, v75
  s_waitcnt lgkmcnt(6)
  v_mfma_f32_32x32x16_bf16 v[48:63], a[248:251], v[116:119], v[48:63]
  ds_read_b64_tr_b16 v[136:137], v26 offset:7168
  ds_read_b64_tr_b16 v[138:139], v26 offset:7424
  v_mul_f32 v47, v47, v39
  v_fma_f32 v77, v77, v66, v66
  v_exp_f32 v79, v79
  v_mfma_f32_32x32x16_bf16 v[48:63], a[252:255], v[120:123], v[48:63]
  ds_read_b64_tr_b16 v[116:117], v27 offset:0
  ds_read_b64_tr_b16 v[118:119], v27 offset:256
  v_mul_f32 v42, v42, v74
  v_cvt_pk_bf16_f32 v80, v40, v41
  v_rcp_f32 v76, v76
  s_waitcnt lgkmcnt(6)
  v_mfma_f32_32x32x16_bf16 v[48:63], v[208:211], v[124:127], v[48:63]
  ds_read_b64_tr_b16 v[120:121], v27 offset:1024
  ds_read_b64_tr_b16 v[122:123], v27 offset:1280
  s_waitcnt vmcnt(11)
  ds_read2st64_b32 v[140:141], v0 offset0:128 offset1:132
  v_fma_f32 v78, v78, v66, v66
  v_mul_f32 v43, v43, v75
  v_mfma_f32_32x32x16_bf16 v[48:63], v[212:215], v[128:131], v[48:63]
  ds_read_b64_tr_b16 v[124:125], v27 offset:2048
s_branch Ib2x
Ib2:
s_branch Ibr
Ib2x:
  ds_read_b64_tr_b16 v[126:127], v27 offset:2304
  ds_read2st64_b32 v[142:143], v0 offset0:136 offset1:140
  v_rcp_f32 v77, v77
  v_fma_f32 v79, v79, v66, v66
  s_waitcnt lgkmcnt(8)
  v_mfma_f32_32x32x16_bf16 v[48:63], v[216:219], v[132:135], v[48:63]
  ds_read_b64_tr_b16 v[128:129], v27 offset:3072
  ds_read_b64_tr_b16 v[130:131], v27 offset:3328
  ds_read2st64_b32 v[144:145], v0 offset0:144 offset1:148
  v_mul_f32 v44, v44, v76
  v_cvt_pk_bf16_f32 v81, v42, v43
  v_rcp_f32 v78, v78
  v_mfma_f32_32x32x16_bf16 v[48:63], v[220:223], v[136:139], v[48:63]
  ds_read_b64_tr_b16 v[132:133], v27 offset:4096
  ds_read_b64_tr_b16 v[134:135], v27 offset:4352
  ds_read2st64_b32 v[146:147], v0 offset0:152 offset1:156
  v_mul_f32 v45, v45, v77
  v_rcp_f32 v79, v79
  s_waitcnt lgkmcnt(10)
  v_mfma_f32_32x32x16_bf16 v[48:63], v[224:227], v[116:119], v[48:63]
  ds_read_b64_tr_b16 v[136:137], v27 offset:5120
  ds_read_b64_tr_b16 v[138:139], v27 offset:5376
  ds_read_b64_tr_b16 v[84:85], v24 offset:32768
  v_mul_f32 v46, v46, v78
  v_cvt_pk_bf16_f32 v82, v44, v45
  v_mfma_f32_32x32x16_bf16 v[48:63], v[228:231], v[120:123], v[48:63]
  ds_read_b64_tr_b16 v[116:117], v27 offset:6144
  ds_read_b64_tr_b16 v[118:119], v27 offset:6400
  ds_read_b64_tr_b16 v[86:87], v24 offset:33024
  s_waitcnt lgkmcnt(6)
  v_max3_u32 v140, v140, v141, v142
  v_mul_f32 v47, v47, v79
  v_mfma_f32_32x32x16_bf16 v[48:63], v[232:235], v[124:127], v[48:63]
  ds_read_b64_tr_b16 v[120:121], v27 offset:7168
  ds_read_b64_tr_b16 v[122:123], v27 offset:7424
  ds_read_b64_tr_b16 v[88:89], v24 offset:33792
  v_max3_u32 v143, v143, v144, v145
  v_cvt_pk_bf16_f32 v83, v46, v47
  s_waitcnt vmcnt(10)
  s_add_u32 s98, s45, 0x00c00000
  buffer_store_dwordx4 v[80:83], v9, s[24:27], s98 offen sc1
  v_mfma_f32_32x32x16_bf16 v[48:63], v[236:239], v[128:131], v[48:63]
  ds_read_b64_tr_b16 v[90:91], v24 offset:34048
  ds_read_b64_tr_b16 v[92:93], v24 offset:34816
  ds_read_b64_tr_b16 v[94:95], v24 offset:35072
  ds_read_b64_tr_b16 v[96:97], v24 offset:35840
  v_max3_u32 v140, v140, v146, v147
  v_max_u32 v140, v140, v143
  s_waitcnt lgkmcnt(11)
  v_mfma_f32_32x32x16_bf16 v[48:63], v[240:243], v[132:135], v[48:63]
  ds_read_b64_tr_b16 v[98:99], v24 offset:36096
  ds_read_b64_tr_b16 v[100:101], v24 offset:36864
  ds_read_b64_tr_b16 v[102:103], v24 offset:37120
  ds_read_b64_tr_b16 v[104:105], v24 offset:37888
  ds_read_b64_tr_b16 v[106:107], v24 offset:38144
  v_mfma_f32_32x32x16_bf16 v[48:63], v[244:247], v[136:139], v[48:63]
  ds_read_b64_tr_b16 v[108:109], v24 offset:38912
  ds_read_b64_tr_b16 v[110:111], v24 offset:39168
  ds_read_b64_tr_b16 v[112:113], v24 offset:39936
  ds_read_b64_tr_b16 v[114:115], v24 offset:40192
  s_waitcnt lgkmcnt(14)
  v_mfma_f32_32x32x16_bf16 v[48:63], v[248:251], v[116:119], v[48:63]
  s_waitcnt vmcnt(2)
T_b13:
  v_cmp_eq_u32 vcc, -1, v68
  s_and_b64 vcc, vcc, s[56:57]
  s_cbranch_scc1 T_r13
  v_mfma_f32_32x32x16_bf16 v[48:63], v[252:255], v[120:123], v[48:63]
  v_mov_b32 v156, v71
  v_mov_b32 v157, v71
  v_mov_b64 v[158:159], v[156:157]
  s_nop 1
  v_mfma_f32_32x32x16_bf16 v[48:63], v[204:207], v[156:159], v[48:63]
  v_cmp_eq_u32 vcc, -1, v140
  s_and_b64 vcc, vcc, s[56:57]
  s_cbranch_scc1 G_r14
G_b14:
  s_waitcnt lgkmcnt(0)
  s_barrier
  v_mfma_f32_32x32x16_bf16 v[32:47], a[176:179], v[84:87], 0
  v_mfma_f32_32x32x16_bf16 v[32:47], a[180:183], v[88:91], v[32:47]
  v_mul_f32 v72, v48, v48
  v_mul_f32 v73, v49, v49
  v_fma_f32 v72, v72, v69, v68
  v_mul_f32 v74, v50, v50
  v_mfma_f32_32x32x16_bf16 v[32:47], a[184:187], v[92:95], v[32:47]
  v_fma_f32 v73, v73, v69, v68
  v_mul_f32 v72, v72, v48
  v_mul_f32 v75, v51, v51
  v_fma_f32 v74, v74, v69, v68
  v_mul_f32 v73, v73, v49
  v_mfma_f32_32x32x16_bf16 v[32:47], a[188:191], v[96:99], v[32:47]
  ds_read_b64_tr_b16 v[124:125], v25 offset:32768
  ds_read_b64_tr_b16 v[126:127], v25 offset:33024
  v_mul_f32 v56, v56, v48
  v_mul_f32 v76, v52, v52
  v_exp_f32 v72, v72
  v_mfma_f32_32x32x16_bf16 v[32:47], a[192:195], v[100:103], v[32:47]
  ds_read_b64_tr_b16 v[128:129], v25 offset:33792
  ds_read_b64_tr_b16 v[130:131], v25 offset:34048
  v_fma_f32 v75, v75, v69, v68
  v_mul_f32 v74, v74, v50
  v_mfma_f32_32x32x16_bf16 v[32:47], a[196:199], v[104:107], v[32:47]
  ds_read_b64_tr_b16 v[132:133], v25 offset:34816
  ds_read_b64_tr_b16 v[134:135], v25 offset:35072
  v_mul_f32 v57, v57, v49
  v_mul_f32 v77, v53, v53
  v_exp_f32 v73, v73
  v_mfma_f32_32x32x16_bf16 v[32:47], a[200:203], v[108:111], v[32:47]
  ds_read_b64_tr_b16 v[136:137], v25 offset:35840
  ds_read_b64_tr_b16 v[138:139], v25 offset:36096
  v_fma_f32 v76, v76, v69, v68
  v_mul_f32 v75, v75, v51
  v_mul_f32 v58, v58, v50
  v_mfma_f32_32x32x16_bf16 v[32:47], a[204:207], v[112:115], v[32:47]
  ds_read_b64_tr_b16 v[116:117], v25 offset:36864
  ds_read_b64_tr_b16 v[118:119], v25 offset:37120
  v_fma_f32 v72, v72, v70, v70
  v_mul_f32 v78, v54, v54
  v_exp_f32 v74, v74
  s_waitcnt lgkmcnt(6)
  v_mfma_f32_32x32x16_bf16 v[32:47], a[208:211], v[124:127], v[32:47]
  ds_read_b64_tr_b16 v[120:121], v25 offset:37888
  ds_read_b64_tr_b16 v[122:123], v25 offset:38144
  v_fma_f32 v77, v77, v69, v68
  v_mul_f32 v76, v76, v52
  v_mul_f32 v59, v59, v51
  v_mfma_f32_32x32x16_bf16 v[32:47], a[212:215], v[128:131], v[32:47]
  ds_read_b64_tr_b16 v[124:125], v25 offset:38912
  ds_read_b64_tr_b16 v[126:127], v25 offset:39168
  v_fma_f32 v73, v73, v70, v70
  v_mul_f32 v79, v55, v55
  v_exp_f32 v75, v75
  s_waitcnt lgkmcnt(6)
  v_mfma_f32_32x32x16_bf16 v[32:47], a[216:219], v[132:135], v[32:47]
  ds_read_b64_tr_b16 v[128:129], v25 offset:39936
  ds_read_b64_tr_b16 v[130:131], v25 offset:40192
  v_fma_f32 v78, v78, v69, v68
  v_rcp_f32 v72, v72
  v_mul_f32 v77, v77, v53
  v_mfma_f32_32x32x16_bf16 v[32:47], a[220:223], v[136:139], v[32:47]
  ds_read_b64_tr_b16 v[132:133], v26 offset:32768
  ds_read_b64_tr_b16 v[134:135], v26 offset:33024
  v_mul_f32 v60, v60, v52
  v_fma_f32 v74, v74, v70, v70
  v_exp_f32 v76, v76
  s_waitcnt lgkmcnt(6)
  v_mfma_f32_32x32x16_bf16 v[32:47], a[224:227], v[116:119], v[32:47]
  ds_read_b64_tr_b16 v[136:137], v26 offset:33792
  ds_read_b64_tr_b16 v[138:139], v26 offset:34048
  v_fma_f32 v79, v79, v69, v68
  v_rcp_f32 v73, v73
  v_mul_f32 v78, v78, v54
  v_mfma_f32_32x32x16_bf16 v[32:47], a[228:231], v[120:123], v[32:47]
  ds_read_b64_tr_b16 v[116:117], v26 offset:34816
  ds_read_b64_tr_b16 v[118:119], v26 offset:35072
  v_mul_f32 v61, v61, v53
  v_fma_f32 v75, v75, v70, v70
  s_waitcnt lgkmcnt(6)
  v_mfma_f32_32x32x16_bf16 v[32:47], a[232:235], v[124:127], v[32:47]
  ds_read_b64_tr_b16 v[120:121], v26 offset:35840
  ds_read_b64_tr_b16 v[122:123], v26 offset:36096
  s_add_u32 s3, s13, 0x0042c000
  buffer_load_dwordx4 v[64:67], v20, s[8:11], s3 offen sc1
  v_exp_f32 v77, v77
  v_mul_f32 v56, v56, v72
  v_rcp_f32 v74, v74
  v_mfma_f32_32x32x16_bf16 v[32:47], a[236:239], v[128:131], v[32:47]
  ds_read_b64_tr_b16 v[124:125], v26 offset:36864
  ds_read_b64_tr_b16 v[126:127], v26 offset:37120
  v_mul_f32 v79, v79, v55
  v_mul_f32 v62, v62, v54
  v_fma_f32 v76, v76, v70, v70
  s_waitcnt lgkmcnt(6)
  v_mfma_f32_32x32x16_bf16 v[32:47], a[240:243], v[132:135], v[32:47]
  ds_read_b64_tr_b16 v[128:129], v26 offset:37888
  ds_read_b64_tr_b16 v[130:131], v26 offset:38144
  v_exp_f32 v78, v78
  v_mul_f32 v57, v57, v73
  v_mfma_f32_32x32x16_bf16 v[32:47], a[244:247], v[136:139], v[32:47]
  ds_read_b64_tr_b16 v[132:133], v26 offset:38912
  ds_read_b64_tr_b16 v[134:135], v26 offset:39168
  v_rcp_f32 v75, v75
  v_mul_f32 v63, v63, v55
  v_fma_f32 v77, v77, v70, v70
  s_waitcnt lgkmcnt(6)
  v_mfma_f32_32x32x16_bf16 v[32:47], a[248:251], v[116:119], v[32:47]
  ds_read_b64_tr_b16 v[136:137], v26 offset:39936
  ds_read_b64_tr_b16 v[138:139], v26 offset:40192
  v_exp_f32 v79, v79
  v_mul_f32 v58, v58, v74
  v_cvt_pk_bf16_f32 v80, v56, v57
  v_mfma_f32_32x32x16_bf16 v[32:47], a[252:255], v[120:123], v[32:47]
  ds_read_b64_tr_b16 v[116:117], v27 offset:32768
  ds_read_b64_tr_b16 v[118:119], v27 offset:33024
  v_add_u32 v148, 0x10000, v0
  v_rcp_f32 v76, v76
  v_fma_f32 v78, v78, v70, v70
  s_waitcnt lgkmcnt(6)
  v_mfma_f32_32x32x16_bf16 v[32:47], v[208:211], v[124:127], v[32:47]
  ds_read_b64_tr_b16 v[120:121], v27 offset:33792
  ds_read_b64_tr_b16 v[122:123], v27 offset:34048
  s_waitcnt vmcnt(2)
  ds_read2st64_b32 v[140:141], v148 offset0:0 offset1:4
  v_mul_f32 v59, v59, v75
  v_rcp_f32 v77, v77
  v_mfma_f32_32x32x16_bf16 v[32:47], v[212:215], v[128:131], v[32:47]
  ds_read_b64_tr_b16 v[124:125], v27 offset:34816
  ds_read_b64_tr_b16 v[126:127], v27 offset:35072
  ds_read2st64_b32 v[142:143], v148 offset0:8 offset1:12
  v_fma_f32 v79, v79, v70, v70
  v_mul_f32 v60, v60, v76
  s_waitcnt lgkmcnt(8)
  v_mfma_f32_32x32x16_bf16 v[32:47], v[216:219], v[132:135], v[32:47]
  ds_read_b64_tr_b16 v[128:129], v27 offset:35840
  ds_read_b64_tr_b16 v[130:131], v27 offset:36096
  ds_read2st64_b32 v[144:145], v148 offset0:16 offset1:20
  v_cvt_pk_bf16_f32 v81, v58, v59
  v_rcp_f32 v78, v78
  v_mfma_f32_32x32x16_bf16 v[32:47], v[220:223], v[136:139], v[32:47]
  ds_read_b64_tr_b16 v[132:133], v27 offset:36864
  ds_read_b64_tr_b16 v[134:135], v27 offset:37120
  ds_read2st64_b32 v[146:147], v148 offset0:24 offset1:28
  v_mul_f32 v61, v61, v77
  v_rcp_f32 v79, v79
  s_waitcnt lgkmcnt(10)
  v_mfma_f32_32x32x16_bf16 v[32:47], v[224:227], v[116:119], v[32:47]
  ds_read_b64_tr_b16 v[136:137], v27 offset:37888
  ds_read_b64_tr_b16 v[138:139], v27 offset:38144
  ds_read_b64_tr_b16 v[84:85], v28 offset:0
  v_mul_f32 v62, v62, v78
  v_cvt_pk_bf16_f32 v82, v60, v61
  v_mfma_f32_32x32x16_bf16 v[32:47], v[228:231], v[120:123], v[32:47]
  ds_read_b64_tr_b16 v[116:117], v27 offset:38912
  ds_read_b64_tr_b16 v[118:119], v27 offset:39168
  ds_read_b64_tr_b16 v[86:87], v28 offset:256
  s_waitcnt lgkmcnt(6)
  v_max3_u32 v140, v140, v141, v142
  v_mul_f32 v63, v63, v79
  v_mfma_f32_32x32x16_bf16 v[32:47], v[232:235], v[124:127], v[32:47]
  ds_read_b64_tr_b16 v[120:121], v27 offset:39936
  ds_read_b64_tr_b16 v[122:123], v27 offset:40192
  ds_read_b64_tr_b16 v[88:89], v28 offset:1024
  v_max3_u32 v143, v143, v144, v145
  v_cvt_pk_bf16_f32 v83, v62, v63
  s_add_u32 s98, s43, 0x00ec0000
  buffer_store_dwordx4 v[80:83], v9, s[20:23], s98 offen sc1
  v_mfma_f32_32x32x16_bf16 v[32:47], v[236:239], v[128:131], v[32:47]
  ds_read_b64_tr_b16 v[90:91], v28 offset:1280
  ds_read_b64_tr_b16 v[92:93], v28 offset:2048
  ds_read_b64_tr_b16 v[94:95], v28 offset:2304
  ds_read_b64_tr_b16 v[96:97], v28 offset:3072
  v_max3_u32 v140, v140, v146, v147
  v_max_u32 v140, v140, v143
  s_waitcnt lgkmcnt(11)
  v_mfma_f32_32x32x16_bf16 v[32:47], v[240:243], v[132:135], v[32:47]
  ds_read_b64_tr_b16 v[98:99], v28 offset:3328
  ds_read_b64_tr_b16 v[100:101], v28 offset:4096
  ds_read_b64_tr_b16 v[102:103], v28 offset:4352
  ds_read_b64_tr_b16 v[104:105], v28 offset:5120
  ds_read_b64_tr_b16 v[106:107], v28 offset:5376
  v_mfma_f32_32x32x16_bf16 v[32:47], v[244:247], v[136:139], v[32:47]
  ds_read_b64_tr_b16 v[108:109], v28 offset:6144
  ds_read_b64_tr_b16 v[110:111], v28 offset:6400
  ds_read_b64_tr_b16 v[112:113], v28 offset:7168
  ds_read_b64_tr_b16 v[114:115], v28 offset:7424
  s_waitcnt lgkmcnt(14)
  v_mfma_f32_32x32x16_bf16 v[32:47], v[248:251], v[116:119], v[32:47]
  s_waitcnt vmcnt(1)
T_b14:
  v_cmp_eq_u32 vcc, -1, v64
  s_and_b64 vcc, vcc, s[56:57]
  s_cbranch_scc1 T_r14
  v_mfma_f32_32x32x16_bf16 v[32:47], v[252:255], v[120:123], v[32:47]
  v_mov_b32 v156, v67
  v_mov_b32 v157, v67
  v_mov_b64 v[158:159], v[156:157]
  s_nop 1
  v_mfma_f32_32x32x16_bf16 v[32:47], v[204:207], v[156:159], v[32:47]
  v_cmp_eq_u32 vcc, -1, v140
  s_and_b64 vcc, vcc, s[56:57]
  s_cbranch_scc1 G_r15
G_b15:
  s_waitcnt lgkmcnt(0)
  s_barrier
  v_mfma_f32_32x32x16_bf16 v[48:63], a[176:179], v[84:87], 0
  v_mfma_f32_32x32x16_bf16 v[48:63], a[180:183], v[88:91], v[48:63]
  s_add_u32 s96, s46, 0x00c00000
  buffer_load_dwordx4 v[168:171], v9, s[8:11], s96 offen offset:0 sc1
  v_mul_f32 v72, v32, v32
  v_mul_f32 v73, v33, v33
  v_fma_f32 v72, v72, v65, v64
  v_mfma_f32_32x32x16_bf16 v[48:63], a[184:187], v[92:95], v[48:63]
  v_mul_f32 v74, v34, v34
  v_fma_f32 v73, v73, v65, v64
  v_mul_f32 v72, v72, v32
  v_mul_f32 v75, v35, v35
  v_fma_f32 v74, v74, v65, v64
  v_mfma_f32_32x32x16_bf16 v[48:63], a[188:191], v[96:99], v[48:63]
  ds_read_b64_tr_b16 v[124:125], v29 offset:0
  ds_read_b64_tr_b16 v[126:127], v29 offset:256
  buffer_load_dwordx4 v[172:175], v9, s[8:11], s96 offen offset:1024 sc1
  v_mul_f32 v73, v73, v33
  v_mul_f32 v40, v40, v32
  v_mfma_f32_32x32x16_bf16 v[48:63], a[192:195], v[100:103], v[48:63]
  ds_read_b64_tr_b16 v[128:129], v29 offset:1024
  ds_read_b64_tr_b16 v[130:131], v29 offset:1280
  v_mul_f32 v76, v36, v36
  v_exp_f32 v72, v72
  v_mfma_f32_32x32x16_bf16 v[48:63], a[196:199], v[104:107], v[48:63]
  ds_read_b64_tr_b16 v[132:133], v29 offset:2048
  ds_read_b64_tr_b16 v[134:135], v29 offset:2304
  buffer_load_dwordx4 v[176:179], v9, s[8:11], s96 offen offset:2048 sc1
  v_fma_f32 v75, v75, v65, v64
  v_mul_f32 v74, v74, v34
  v_mfma_f32_32x32x16_bf16 v[48:63], a[200:203], v[108:111], v[48:63]
  ds_read_b64_tr_b16 v[136:137], v29 offset:3072
  ds_read_b64_tr_b16 v[138:139], v29 offset:3328
  v_mul_f32 v41, v41, v33
  v_mul_f32 v77, v37, v37
  v_exp_f32 v73, v73
  v_mfma_f32_32x32x16_bf16 v[48:63], a[204:207], v[112:115], v[48:63]
  ds_read_b64_tr_b16 v[116:117], v29 offset:4096
  ds_read_b64_tr_b16 v[118:119], v29 offset:4352
  buffer_load_dwordx4 v[180:183], v9, s[8:11], s96 offen offset:3072 sc1
  v_fma_f32 v76, v76, v65, v64
  v_mul_f32 v75, v75, v35
  s_waitcnt lgkmcnt(6)
  v_mfma_f32_32x32x16_bf16 v[48:63], a[208:211], v[124:127], v[48:63]
  ds_read_b64_tr_b16 v[120:121], v29 offset:5120
  ds_read_b64_tr_b16 v[122:123], v29 offset:5376
  v_mul_f32 v42, v42, v34
  v_fma_f32 v72, v72, v66, v66
  v_mul_f32 v78, v38, v38
  v_mfma_f32_32x32x16_bf16 v[48:63], a[212:215], v[128:131], v[48:63]
  ds_read_b64_tr_b16 v[124:125], v29 offset:6144
  ds_read_b64_tr_b16 v[126:127], v29 offset:6400
  v_exp_f32 v74, v74
  v_fma_f32 v77, v77, v65, v64
  v_mul_f32 v76, v76, v36
  s_waitcnt lgkmcnt(6)
  v_mfma_f32_32x32x16_bf16 v[48:63], a[216:219], v[132:135], v[48:63]
  ds_read_b64_tr_b16 v[128:129], v29 offset:7168
  ds_read_b64_tr_b16 v[130:131], v29 offset:7424
  s_add_u32 s96, s46, 0x00c01000
  buffer_load_dwordx4 v[184:187], v9, s[8:11], s96 offen offset:0 sc1
  v_mul_f32 v43, v43, v35
  v_fma_f32 v73, v73, v66, v66
  v_mfma_f32_32x32x16_bf16 v[48:63], a[220:223], v[136:139], v[48:63]
  ds_read_b64_tr_b16 v[132:133], v30 offset:0
  ds_read_b64_tr_b16 v[134:135], v30 offset:256
  v_mul_f32 v79, v39, v39
  v_exp_f32 v75, v75
  s_waitcnt lgkmcnt(6)
  v_mfma_f32_32x32x16_bf16 v[48:63], a[224:227], v[116:119], v[48:63]
  ds_read_b64_tr_b16 v[136:137], v30 offset:1024
  ds_read_b64_tr_b16 v[138:139], v30 offset:1280
  buffer_load_dwordx4 v[188:191], v9, s[8:11], s96 offen offset:1024 sc1
  v_fma_f32 v78, v78, v65, v64
  v_rcp_f32 v72, v72
  v_mfma_f32_32x32x16_bf16 v[48:63], a[228:231], v[120:123], v[48:63]
  ds_read_b64_tr_b16 v[116:117], v30 offset:2048
  ds_read_b64_tr_b16 v[118:119], v30 offset:2304
  v_mul_f32 v77, v77, v37
  v_mul_f32 v44, v44, v36
  v_fma_f32 v74, v74, v66, v66
  s_waitcnt lgkmcnt(6)
  v_mfma_f32_32x32x16_bf16 v[48:63], a[232:235], v[124:127], v[48:63]
  ds_read_b64_tr_b16 v[120:121], v30 offset:3072
  ds_read_b64_tr_b16 v[122:123], v30 offset:3328
  s_add_u32 s3, s14, 0x0042c000
  buffer_load_dwordx4 v[68:71], v20, s[8:11], s3 offen sc1
  buffer_load_dwordx4 v[192:195], v9, s[8:11], s96 offen offset:2048 sc1
  v_exp_f32 v76, v76
  v_fma_f32 v79, v79, v65, v64
  v_mfma_f32_32x32x16_bf16 v[48:63], a[236:239], v[128:131], v[48:63]
  ds_read_b64_tr_b16 v[124:125], v30 offset:4096
  ds_read_b64_tr_b16 v[126:127], v30 offset:4352
  v_rcp_f32 v73, v73
  v_mul_f32 v78, v78, v38
  s_waitcnt lgkmcnt(6)
  v_mfma_f32_32x32x16_bf16 v[48:63], a[240:243], v[132:135], v[48:63]
  ds_read_b64_tr_b16 v[128:129], v30 offset:5120
  ds_read_b64_tr_b16 v[130:131], v30 offset:5376
  v_mul_f32 v45, v45, v37
  v_fma_f32 v75, v75, v66, v66
  v_exp_f32 v77, v77
  v_mfma_f32_32x32x16_bf16 v[48:63], a[244:247], v[136:139], v[48:63]
  ds_read_b64_tr_b16 v[132:133], v30 offset:6144
  ds_read_b64_tr_b16 v[134:135], v30 offset:6400
  buffer_load_dwordx4 v[196:199], v9, s[8:11], s96 offen offset:3072 sc1
  v_mul_f32 v40, v40, v72
  v_rcp_f32 v74, v74
  s_waitcnt lgkmcnt(6)
  v_mfma_f32_32x32x16_bf16 v[48:63], a[248:251], v[116:119], v[48:63]
  ds_read_b64_tr_b16 v[136:137], v30 offset:7168
  ds_read_b64_tr_b16 v[138:139], v30 offset:7424
  v_mul_f32 v79, v79, v39
  v_mul_f32 v46, v46, v38
  v_fma_f32 v76, v76, v66, v66
  v_mfma_f32_32x32x16_bf16 v[48:63], a[252:255], v[120:123], v[48:63]
  ds_read_b64_tr_b16 v[116:117], v31 offset:0
  ds_read_b64_tr_b16 v[118:119], v31 offset:256
  s_add_u32 s96, s46, 0x00c02000
  buffer_load_dwordx4 v[200:203], v9, s[8:11], s96 offen offset:0 sc1
  v_exp_f32 v78, v78
  v_mul_f32 v41, v41, v73
  s_waitcnt lgkmcnt(6)
  v_mfma_f32_32x32x16_bf16 v[48:63], v[208:211], v[124:127], v[48:63]
  ds_read_b64_tr_b16 v[120:121], v31 offset:1024
  ds_read_b64_tr_b16 v[122:123], v31 offset:1280
  v_rcp_f32 v75, v75
  v_mul_f32 v47, v47, v39
  v_fma_f32 v77, v77, v66, v66
  v_mfma_f32_32x32x16_bf16 v[48:63], v[212:215], v[128:131], v[48:63]
  ds_read_b64_tr_b16 v[124:125], v31 offset:2048
  ds_read_b64_tr_b16 v[126:127], v31 offset:2304
  buffer_load_dwordx4 v[140:143], v9, s[8:11], s96 offen offset:1024 sc1
  v_exp_f32 v79, v79
  v_mul_f32 v42, v42, v74
  s_waitcnt lgkmcnt(6)
  v_mfma_f32_32x32x16_bf16 v[48:63], v[216:219], v[132:135], v[48:63]
  ds_read_b64_tr_b16 v[128:129], v31 offset:3072
  ds_read_b64_tr_b16 v[130:131], v31 offset:3328
  v_cvt_pk_bf16_f32 v80, v40, v41
  v_rcp_f32 v76, v76
  v_mfma_f32_32x32x16_bf16 v[48:63], v[220:223], v[136:139], v[48:63]
  ds_read_b64_tr_b16 v[132:133], v31 offset:4096
  ds_read_b64_tr_b16 v[134:135], v31 offset:4352
  v_fma_f32 v78, v78, v66, v66
  v_mul_f32 v43, v43, v75
  v_rcp_f32 v77, v77
  s_waitcnt lgkmcnt(6)
  v_mfma_f32_32x32x16_bf16 v[48:63], v[224:227], v[116:119], v[48:63]
  ds_read_b64_tr_b16 v[136:137], v31 offset:5120
  ds_read_b64_tr_b16 v[138:139], v31 offset:5376
  buffer_load_dwordx4 v[144:147], v9, s[8:11], s96 offen offset:2048 sc1
  v_fma_f32 v79, v79, v66, v66
  v_mul_f32 v44, v44, v76
  v_mfma_f32_32x32x16_bf16 v[48:63], v[228:231], v[120:123], v[48:63]
  ds_read_b64_tr_b16 v[116:117], v31 offset:6144
  ds_read_b64_tr_b16 v[118:119], v31 offset:6400
  v_cvt_pk_bf16_f32 v81, v42, v43
  v_rcp_f32 v78, v78
  v_mul_f32 v45, v45, v77
  s_waitcnt lgkmcnt(6)
  v_mfma_f32_32x32x16_bf16 v[48:63], v[232:235], v[124:127], v[48:63]
  ds_read_b64_tr_b16 v[120:121], v31 offset:7168
  ds_read_b64_tr_b16 v[122:123], v31 offset:7424
  buffer_load_dwordx4 v[148:151], v9, s[8:11], s96 offen offset:3072 sc1
  v_rcp_f32 v79, v79
  v_mul_f32 v46, v46, v78
  v_mfma_f32_32x32x16_bf16 v[48:63], v[236:239], v[128:131], v[48:63]
  v_cvt_pk_bf16_f32 v82, v44, v45
  v_mul_f32 v47, v47, v79
  v_cvt_pk_bf16_f32 v83, v46, v47
  s_add_u32 s98, s44, 0x00ec0000
  buffer_store_dwordx4 v[80:83], v9, s[20:23], s98 offen sc1
  s_waitcnt lgkmcnt(4)
  v_mfma_f32_32x32x16_bf16 v[48:63], v[240:243], v[132:135], v[48:63]
  s_add_u32 s96, s46, 0x00c03000
  buffer_load_dwordx4 v[152:155], v9, s[8:11], s96 offen offset:0 sc1
  v_mfma_f32_32x32x16_bf16 v[48:63], v[244:247], v[136:139], v[48:63]
  s_waitcnt lgkmcnt(0)
  v_mfma_f32_32x32x16_bf16 v[48:63], v[248:251], v[116:119], v[48:63]
  s_waitcnt vmcnt(8)
T_b15:
  v_cmp_eq_u32 vcc, -1, v68
  s_and_b64 vcc, vcc, s[56:57]
  s_cbranch_scc1 T_r15
  buffer_load_dwordx4 v[84:87], v9, s[8:11], s96 offen offset:1024 sc1
  v_mfma_f32_32x32x16_bf16 v[48:63], v[252:255], v[120:123], v[48:63]
  v_mov_b32 v156, v71
  v_mov_b32 v157, v71
  v_mov_b64 v[158:159], v[156:157]
  s_nop 1
  v_mfma_f32_32x32x16_bf16 v[48:63], v[204:207], v[156:159], v[48:63]
G2_1:
  v_max3_u32 v136, v168, v172, v176
  v_cmp_eq_u32 vcc, -1, v136
  s_and_b64 vcc, vcc, s[56:57]
  s_cbranch_scc1 H_r100
H_b100:
  v_mfma_f32_32x32x16_bf16 v[32:47], v[168:171], a[0:3], 0
  s_add_u32 s98, s47, 0x00a00000
  buffer_load_dwordx4 v[132:135], v16, s[8:11], s98 offen sc1
  s_nop 3
  v_mfma_f32_32x32x16_bf16 v[116:131], v[168:171], a[4:7], 0
  buffer_load_dwordx4 v[88:91], v9, s[8:11], s96 offen offset:2048 sc1
  v_mul_f32 v72, v48, v48
  v_mul_f32 v73, v49, v49
  v_fma_f32 v72, v72, v69, v68
  v_mul_f32 v74, v50, v50
  v_fma_f32 v73, v73, v69, v68
  v_mul_f32 v72, v72, v48
  v_mul_f32 v75, v51, v51
  v_fma_f32 v74, v74, v69, v68
  v_mul_f32 v73, v73, v49
  v_mul_f32 v56, v56, v48
  v_mul_f32 v76, v52, v52
  v_mfma_f32_32x32x16_bf16 v[32:47], v[172:175], a[8:11], v[32:47]
  buffer_load_dwordx4 v[92:95], v9, s[8:11], s96 offen offset:3072 sc1
  v_exp_f32 v72, v72
  v_fma_f32 v75, v75, v69, v68
  v_mul_f32 v74, v74, v50
  v_mul_f32 v57, v57, v49
  v_mul_f32 v77, v53, v53
  v_exp_f32 v73, v73
  v_fma_f32 v76, v76, v69, v68
  v_mul_f32 v75, v75, v51
  v_mul_f32 v58, v58, v50
  v_fma_f32 v72, v72, v70, v70
  v_mfma_f32_32x32x16_bf16 v[116:131], v[172:175], a[12:15], v[116:131]
  v_mul_f32 v78, v54, v54
  v_exp_f32 v74, v74
  v_fma_f32 v77, v77, v69, v68
  v_mul_f32 v76, v76, v52
  v_mul_f32 v59, v59, v51
  v_fma_f32 v73, v73, v70, v70
  v_mul_f32 v79, v55, v55
  v_exp_f32 v75, v75
  v_fma_f32 v78, v78, v69, v68
  v_rcp_f32 v72, v72
  v_mul_f32 v77, v77, v53
  v_mul_f32 v60, v60, v52
  v_fma_f32 v74, v74, v70, v70
  v_mfma_f32_32x32x16_bf16 v[32:47], v[176:179], a[16:19], v[32:47]
  v_max3_u32 v136, v180, v184, v188
  v_cmp_eq_u32 vcc, -1, v136
  s_and_b64 vcc, vcc, s[56:57]
  s_cbranch_scc1 H_r101
H_b101:
  v_exp_f32 v76, v76
  v_mfma_f32_32x32x16_bf16 v[116:131], v[176:179], a[20:23], v[116:131]
  s_add_u32 s96, s46, 0x00c04000
  buffer_load_dwordx4 v[96:99], v9, s[8:11], s96 offen offset:0 sc1
  v_fma_f32 v79, v79, v69, v68
  v_rcp_f32 v73, v73
  v_mul_f32 v78, v78, v54
  v_mul_f32 v61, v61, v53
  v_fma_f32 v75, v75, v70, v70
  v_exp_f32 v77, v77
  v_mul_f32 v56, v56, v72
  v_rcp_f32 v74, v74
  v_mul_f32 v79, v79, v55
  v_mul_f32 v62, v62, v54
  v_fma_f32 v76, v76, v70, v70
  v_mfma_f32_32x32x16_bf16 v[32:47], v[180:183], a[24:27], v[32:47]
  buffer_load_dwordx4 v[100:103], v9, s[8:11], s96 offen offset:1024 sc1
  v_exp_f32 v78, v78
  v_mul_f32 v57, v57, v73
  v_rcp_f32 v75, v75
  v_mul_f32 v63, v63, v55
  v_fma_f32 v77, v77, v70, v70
  v_exp_f32 v79, v79
  v_mul_f32 v58, v58, v74
  v_cvt_pk_bf16_f32 v80, v56, v57
  v_rcp_f32 v76, v76
  v_fma_f32 v78, v78, v70, v70
  v_mfma_f32_32x32x16_bf16 v[116:131], v[180:183], a[28:31], v[116:131]
  v_mul_f32 v59, v59, v75
  v_rcp_f32 v77, v77
  v_fma_f32 v79, v79, v70, v70
  v_mul_f32 v60, v60, v76
  v_cvt_pk_bf16_f32 v81, v58, v59
  v_rcp_f32 v78, v78
  v_mul_f32 v61, v61, v77
  v_rcp_f32 v79, v79
  v_mul_f32 v62, v62, v78
  v_cvt_pk_bf16_f32 v82, v60, v61
  v_mul_f32 v63, v63, v79
  v_cvt_pk_bf16_f32 v83, v62, v63
  s_add_u32 s98, s45, 0x00ec0000
  buffer_store_dwordx4 v[80:83], v9, s[24:27], s98 offen sc1
  v_mfma_f32_32x32x16_bf16 v[32:47], v[184:187], a[32:35], v[32:47]
  v_mfma_f32_32x32x16_bf16 v[116:131], v[184:187], a[36:39], v[116:131]
  buffer_load_dwordx4 v[104:107], v9, s[8:11], s96 offen offset:2048 sc1
  v_mfma_f32_32x32x16_bf16 v[32:47], v[188:191], a[40:43], v[32:47]
  s_waitcnt vmcnt(13)
  v_max3_u32 v136, v192, v196, v200
  v_cmp_eq_u32 vcc, -1, v136
  s_and_b64 vcc, vcc, s[56:57]
  s_cbranch_scc1 H_r102
H_b102:
  buffer_load_dwordx4 v[108:111], v9, s[8:11], s96 offen offset:3072 sc1
  v_mfma_f32_32x32x16_bf16 v[116:131], v[188:191], a[44:47], v[116:131]
  v_mfma_f32_32x32x16_bf16 v[32:47], v[192:195], a[48:51], v[32:47]
  v_mfma_f32_32x32x16_bf16 v[116:131], v[192:195], a[52:55], v[116:131]
  s_add_u32 s96, s46, 0x00c05000
  buffer_load_dwordx4 v[112:115], v9, s[8:11], s96 offen offset:0 sc1
  v_mfma_f32_32x32x16_bf16 v[32:47], v[196:199], a[56:59], v[32:47]
  buffer_load_dwordx4 v[160:163], v9, s[8:11], s96 offen offset:1024 sc1
  v_mfma_f32_32x32x16_bf16 v[116:131], v[196:199], a[60:63], v[116:131]
  v_mfma_f32_32x32x16_bf16 v[32:47], v[200:203], a[64:67], v[32:47]
  s_waitcnt vmcnt(13)
  v_max3_u32 v136, v140, v144, v148
  v_cmp_eq_u32 vcc, -1, v136
  s_and_b64 vcc, vcc, s[56:57]
  s_cbranch_scc1 H_r103
H_b103:
  v_mfma_f32_32x32x16_bf16 v[116:131], v[200:203], a[68:71], v[116:131]
  v_mfma_f32_32x32x16_bf16 v[32:47], v[140:143], a[72:75], v[32:47]
  v_mfma_f32_32x32x16_bf16 v[116:131], v[140:143], a[76:79], v[116:131]
  v_mfma_f32_32x32x16_bf16 v[32:47], v[144:147], a[80:83], v[32:47]
  v_mfma_f32_32x32x16_bf16 v[116:131], v[144:147], a[84:87], v[116:131]
  v_mfma_f32_32x32x16_bf16 v[32:47], v[148:151], a[88:91], v[32:47]
  s_waitcnt vmcnt(8)
  v_max3_u32 v136, v152, v84, v88
  v_cmp_eq_u32 vcc, -1, v136
  s_and_b64 vcc, vcc, s[56:57]
  s_cbranch_scc1 H_r104
H_b104:
  v_mfma_f32_32x32x16_bf16 v[116:131], v[148:151], a[92:95], v[116:131]
  v_mfma_f32_32x32x16_bf16 v[32:47], v[152:155], a[96:99], v[32:47]
  v_mfma_f32_32x32x16_bf16 v[116:131], v[152:155], a[100:103], v[116:131]
  v_mfma_f32_32x32x16_bf16 v[32:47], v[84:87], a[104:107], v[32:47]
  v_mfma_f32_32x32x16_bf16 v[116:131], v[84:87], a[108:111], v[116:131]
  v_mfma_f32_32x32x16_bf16 v[32:47], v[88:91], a[112:115], v[32:47]
  s_waitcnt vmcnt(5)
  v_max3_u32 v136, v92, v96, v100
  v_cmp_eq_u32 vcc, -1, v136
  s_and_b64 vcc, vcc, s[56:57]
  s_cbranch_scc1 H_r105
H_b105:
  v_mfma_f32_32x32x16_bf16 v[116:131], v[88:91], a[116:119], v[116:131]
  v_mfma_f32_32x32x16_bf16 v[32:47], v[92:95], a[120:123], v[32:47]
  v_mfma_f32_32x32x16_bf16 v[116:131], v[92:95], a[124:127], v[116:131]
  v_mfma_f32_32x32x16_bf16 v[32:47], v[96:99], a[128:131], v[32:47]
  v_mfma_f32_32x32x16_bf16 v[116:131], v[96:99], a[132:135], v[116:131]
  v_mfma_f32_32x32x16_bf16 v[32:47], v[100:103], a[136:139], v[32:47]
  s_waitcnt vmcnt(0)
  v_max3_u32 v136, v104, v108, v112
  v_max_u32 v136, v136, v160
  v_cmp_eq_u32 vcc, -1, v136
  s_and_b64 vcc, vcc, s[56:57]
  s_cbranch_scc1 H_r106
H_b106:
  v_mfma_f32_32x32x16_bf16 v[116:131], v[100:103], a[140:143], v[116:131]
  v_mfma_f32_32x32x16_bf16 v[32:47], v[104:107], a[144:147], v[32:47]
  v_mfma_f32_32x32x16_bf16 v[116:131], v[104:107], a[148:151], v[116:131]
  v_mfma_f32_32x32x16_bf16 v[32:47], v[108:111], a[152:155], v[32:47]
  v_mfma_f32_32x32x16_bf16 v[116:131], v[108:111], a[156:159], v[116:131]
  v_mfma_f32_32x32x16_bf16 v[32:47], v[112:115], a[160:163], v[32:47]
  v_mfma_f32_32x32x16_bf16 v[116:131], v[112:115], a[164:167], v[116:131]
  v_mfma_f32_32x32x16_bf16 v[32:47], v[160:163], a[168:171], v[32:47]
  v_mfma_f32_32x32x16_bf16 v[116:131], v[160:163], a[172:175], v[116:131]
  v_and_b32 v65, 0xffff0000, v132
s_branch Ib3x
Ib3:
s_branch Ibr
Ib3x:
  v_lshlrev_b32 v64, 16, v132
  v_and_b32 v67, 0xffff0000, v133
  v_lshlrev_b32 v66, 16, v133
  v_and_b32 v69, 0xffff0000, v134
  v_lshlrev_b32 v68, 16, v134
  v_and_b32 v71, 0xffff0000, v135
  v_lshlrev_b32 v70, 16, v135
  s_nop 2
  ds_write_b128 v13, v[32:35] offset:0
  ds_write_b128 v13, v[36:39] offset:1088
  ds_write_b128 v13, v[40:43] offset:2176
  s_add_u32 s96, s46, 0x00ec0000
  buffer_load_dwordx4 v[168:171], v9, s[8:11], s96 offen offset:0 sc1
  ds_write_b128 v13, v[44:47] offset:3264
  ds_write_b128 v13, v[116:119] offset:4352
  buffer_load_dwordx4 v[172:175], v9, s[8:11], s96 offen offset:1024 sc1
  ds_write_b128 v13, v[120:123] offset:5440
  ds_write_b128 v13, v[124:127] offset:6528
  buffer_load_dwordx4 v[176:179], v9, s[8:11], s96 offen offset:2048 sc1
  ds_write_b128 v13, v[128:131] offset:7616
  s_waitcnt lgkmcnt(0)
  s_barrier
  buffer_load_dwordx4 v[180:183], v9, s[8:11], s96 offen offset:3072 sc1
  ds_read_b128 v[32:35], v14 offset:0
  ds_read_b128 v[36:39], v14 offset:512
  s_add_u32 s96, s46, 0x00ec1000
  buffer_load_dwordx4 v[184:187], v9, s[8:11], s96 offen offset:0 sc1
  ds_read_b128 v[40:43], v14 offset:8704
  ds_read_b128 v[44:47], v14 offset:9216
  buffer_load_dwordx4 v[188:191], v9, s[8:11], s96 offen offset:1024 sc1
  ds_read_b128 v[48:51], v14 offset:17408
  ds_read_b128 v[52:55], v14 offset:17920
  ds_read_b128 v[56:59], v14 offset:26112
  buffer_load_dwordx4 v[192:195], v9, s[8:11], s96 offen offset:2048 sc1
  ds_read_b128 v[60:63], v14 offset:26624
  s_waitcnt lgkmcnt(4)
  buffer_load_dwordx4 v[196:199], v9, s[8:11], s96 offen offset:3072 sc1
  v_pk_add_f32 v[32:33], v[32:33], v[40:41]
  v_pk_add_f32 v[34:35], v[34:35], v[42:43]
  s_add_u32 s96, s46, 0x00ec2000
  buffer_load_dwordx4 v[200:203], v9, s[8:11], s96 offen offset:0 sc1
  v_pk_add_f32 v[36:37], v[36:37], v[44:45]
  v_pk_add_f32 v[38:39], v[38:39], v[46:47]
  buffer_load_dwordx4 v[140:143], v9, s[8:11], s96 offen offset:1024 sc1
  s_waitcnt lgkmcnt(0)
  v_pk_add_f32 v[48:49], v[48:49], v[56:57]
  buffer_load_dwordx4 v[144:147], v9, s[8:11], s96 offen offset:2048 sc1
  v_pk_add_f32 v[50:51], v[50:51], v[58:59]
  v_pk_add_f32 v[52:53], v[52:53], v[60:61]
  buffer_load_dwordx4 v[148:151], v9, s[8:11], s96 offen offset:3072 sc1
  v_pk_add_f32 v[54:55], v[54:55], v[62:63]
  v_pk_add_f32 v[32:33], v[32:33], v[48:49]
  v_pk_add_f32 v[34:35], v[34:35], v[50:51]
  s_add_u32 s96, s46, 0x00ec3000
  buffer_load_dwordx4 v[152:155], v9, s[8:11], s96 offen offset:0 sc1
  v_pk_add_f32 v[36:37], v[36:37], v[52:53]
  v_pk_add_f32 v[38:39], v[38:39], v[54:55]
  buffer_load_dwordx4 v[84:87], v9, s[8:11], s96 offen offset:1024 sc1
  v_cvt_pk_bf16_f32 v32, 0, v32
  v_cvt_pk_bf16_f32 v33, 0, v33
  buffer_load_dwordx4 v[88:91], v9, s[8:11], s96 offen offset:2048 sc1
  v_cvt_pk_bf16_f32 v34, 0, v34
  v_cvt_pk_bf16_f32 v35, 0, v35
  buffer_load_dwordx4 v[92:95], v9, s[8:11], s96 offen offset:3072 sc1
  v_cvt_pk_bf16_f32 v36, 0, v36
  v_cvt_pk_bf16_f32 v37, 0, v37
  s_add_u32 s96, s46, 0x00ec4000
  buffer_load_dwordx4 v[96:99], v9, s[8:11], s96 offen offset:0 sc1
  v_cvt_pk_bf16_f32 v38, 0, v38
  v_cvt_pk_bf16_f32 v39, 0, v39
  buffer_load_dwordx4 v[100:103], v9, s[8:11], s96 offen offset:1024 sc1
  v_pk_add_f32 v[32:33], v[32:33], v[64:65]
  v_pk_add_f32 v[34:35], v[34:35], v[66:67]
  v_pk_add_f32 v[36:37], v[36:37], v[68:69]
  v_pk_add_f32 v[38:39], v[38:39], v[70:71]
  v_cvt_pk_bf16_f32 v80, v32, v33
  v_cvt_pk_bf16_f32 v81, v34, v35
  v_cvt_pk_bf16_f32 v82, v36, v37
  v_cvt_pk_bf16_f32 v83, v38, v39
  ds_write_b128 v17, v[80:83]
  s_lshl_b32 s3, s6, 10
  v_add_u32 v64, s3, v18
  s_add_u32 s98, s51, 0x00000000
  s_waitcnt lgkmcnt(0)
  ds_read_b64_tr_b16 v[72:73], v64 offset:0
  ds_read_b64_tr_b16 v[74:75], v64 offset:256
  s_barrier
  s_waitcnt vmcnt(15)
  v_max3_u32 v136, v168, v172, v176
  v_cmp_eq_u32 vcc, -1, v136
  s_and_b64 vcc, vcc, s[56:57]
  s_cbranch_scc1 H_r110
H_b110:
  v_mfma_f32_32x32x16_bf16 v[32:47], v[168:171], a[0:3], 0
  s_add_u32 s98, s47, 0x00b00000
  buffer_load_dwordx4 v[132:135], v16, s[8:11], s98 offen sc1
  v_mfma_f32_32x32x16_bf16 v[116:131], v[168:171], a[4:7], 0
  buffer_load_dwordx4 v[104:107], v9, s[8:11], s96 offen offset:2048 sc1
  v_mfma_f32_32x32x16_bf16 v[32:47], v[172:175], a[8:11], v[32:47]
  buffer_load_dwordx4 v[108:111], v9, s[8:11], s96 offen offset:3072 sc1
  v_mfma_f32_32x32x16_bf16 v[116:131], v[172:175], a[12:15], v[116:131]
  v_mfma_f32_32x32x16_bf16 v[32:47], v[176:179], a[16:19], v[32:47]
  s_waitcnt vmcnt(15)
  v_max3_u32 v136, v180, v184, v188
  v_cmp_eq_u32 vcc, -1, v136
  s_and_b64 vcc, vcc, s[56:57]
  s_cbranch_scc1 H_r111
H_b111:
  v_mfma_f32_32x32x16_bf16 v[116:131], v[176:179], a[20:23], v[116:131]
  s_add_u32 s96, s46, 0x00ec5000
  buffer_load_dwordx4 v[112:115], v9, s[8:11], s96 offen offset:0 sc1
  v_mfma_f32_32x32x16_bf16 v[32:47], v[180:183], a[24:27], v[32:47]
  buffer_load_dwordx4 v[160:163], v9, s[8:11], s96 offen offset:1024 sc1
  v_mfma_f32_32x32x16_bf16 v[116:131], v[180:183], a[28:31], v[116:131]
  v_mfma_f32_32x32x16_bf16 v[32:47], v[184:187], a[32:35], v[32:47]
  v_mfma_f32_32x32x16_bf16 v[116:131], v[184:187], a[36:39], v[116:131]
  s_waitcnt lgkmcnt(0)
  buffer_store_dwordx4 v[72:75], v15, s[16:19], s51 offen sc1
  v_mfma_f32_32x32x16_bf16 v[32:47], v[188:191], a[40:43], v[32:47]
  s_waitcnt vmcnt(15)
  v_max3_u32 v136, v192, v196, v200
  v_cmp_eq_u32 vcc, -1, v136
  s_and_b64 vcc, vcc, s[56:57]
  s_cbranch_scc1 H_r112
H_b112:
  v_mfma_f32_32x32x16_bf16 v[116:131], v[188:191], a[44:47], v[116:131]
  v_mfma_f32_32x32x16_bf16 v[32:47], v[192:195], a[48:51], v[32:47]
  v_mfma_f32_32x32x16_bf16 v[116:131], v[192:195], a[52:55], v[116:131]
  v_mfma_f32_32x32x16_bf16 v[32:47], v[196:199], a[56:59], v[32:47]
  v_mfma_f32_32x32x16_bf16 v[116:131], v[196:199], a[60:63], v[116:131]
  v_mfma_f32_32x32x16_bf16 v[32:47], v[200:203], a[64:67], v[32:47]
  s_waitcnt vmcnt(12)
  v_max3_u32 v136, v140, v144, v148
  v_cmp_eq_u32 vcc, -1, v136
  s_and_b64 vcc, vcc, s[56:57]
  s_cbranch_scc1 H_r113
H_b113:
  v_mfma_f32_32x32x16_bf16 v[116:131], v[200:203], a[68:71], v[116:131]
  v_mfma_f32_32x32x16_bf16 v[32:47], v[140:143], a[72:75], v[32:47]
  v_mfma_f32_32x32x16_bf16 v[116:131], v[140:143], a[76:79], v[116:131]
  v_mfma_f32_32x32x16_bf16 v[32:47], v[144:147], a[80:83], v[32:47]
  v_mfma_f32_32x32x16_bf16 v[116:131], v[144:147], a[84:87], v[116:131]
  v_mfma_f32_32x32x16_bf16 v[32:47], v[148:151], a[88:91], v[32:47]
  s_waitcnt vmcnt(9)
  v_max3_u32 v136, v152, v84, v88
  v_cmp_eq_u32 vcc, -1, v136
  s_and_b64 vcc, vcc, s[56:57]
  s_cbranch_scc1 H_r114
H_b114:
  v_mfma_f32_32x32x16_bf16 v[116:131], v[148:151], a[92:95], v[116:131]
  v_mfma_f32_32x32x16_bf16 v[32:47], v[152:155], a[96:99], v[32:47]
  v_mfma_f32_32x32x16_bf16 v[116:131], v[152:155], a[100:103], v[116:131]
  v_mfma_f32_32x32x16_bf16 v[32:47], v[84:87], a[104:107], v[32:47]
  v_mfma_f32_32x32x16_bf16 v[116:131], v[84:87], a[108:111], v[116:131]
  v_mfma_f32_32x32x16_bf16 v[32:47], v[88:91], a[112:115], v[32:47]
  s_waitcnt vmcnt(6)
  v_max3_u32 v136, v92, v96, v100
  v_cmp_eq_u32 vcc, -1, v136
  s_and_b64 vcc, vcc, s[56:57]
  s_cbranch_scc1 H_r115
H_b115:
  v_mfma_f32_32x32x16_bf16 v[116:131], v[88:91], a[116:119], v[116:131]
  v_mfma_f32_32x32x16_bf16 v[32:47], v[92:95], a[120:123], v[32:47]
  v_mfma_f32_32x32x16_bf16 v[116:131], v[92:95], a[124:127], v[116:131]
  v_mfma_f32_32x32x16_bf16 v[32:47], v[96:99], a[128:131], v[32:47]
  v_mfma_f32_32x32x16_bf16 v[116:131], v[96:99], a[132:135], v[116:131]
  v_mfma_f32_32x32x16_bf16 v[32:47], v[100:103], a[136:139], v[32:47]
  s_waitcnt vmcnt(1)
  v_max3_u32 v136, v104, v108, v112
  v_max_u32 v136, v136, v160
  v_cmp_eq_u32 vcc, -1, v136
  s_and_b64 vcc, vcc, s[56:57]
  s_cbranch_scc1 H_r116
H_b116:
  v_mfma_f32_32x32x16_bf16 v[116:131], v[100:103], a[140:143], v[116:131]
  v_mfma_f32_32x32x16_bf16 v[32:47], v[104:107], a[144:147], v[32:47]
  v_mfma_f32_32x32x16_bf16 v[116:131], v[104:107], a[148:151], v[116:131]
  v_mfma_f32_32x32x16_bf16 v[32:47], v[108:111], a[152:155], v[32:47]
  v_mfma_f32_32x32x16_bf16 v[116:131], v[108:111], a[156:159], v[116:131]
  v_mfma_f32_32x32x16_bf16 v[32:47], v[112:115], a[160:163], v[32:47]
  v_mfma_f32_32x32x16_bf16 v[116:131], v[112:115], a[164:167], v[116:131]
  v_mfma_f32_32x32x16_bf16 v[32:47], v[160:163], a[168:171], v[32:47]
  v_mfma_f32_32x32x16_bf16 v[116:131], v[160:163], a[172:175], v[116:131]
  v_and_b32 v65, 0xffff0000, v132
  v_lshlrev_b32 v64, 16, v132
  v_and_b32 v67, 0xffff0000, v133
  v_lshlrev_b32 v66, 16, v133
  v_and_b32 v69, 0xffff0000, v134
  v_lshlrev_b32 v68, 16, v134
  v_and_b32 v71, 0xffff0000, v135
  v_lshlrev_b32 v70, 16, v135
  s_nop 2
  ds_write_b128 v13, v[32:35] offset:0
  ds_write_b128 v13, v[36:39] offset:1088
  ds_write_b128 v13, v[40:43] offset:2176
  ds_write_b128 v13, v[44:47] offset:3264
  ds_write_b128 v13, v[116:119] offset:4352
  ds_write_b128 v13, v[120:123] offset:5440
  ds_write_b128 v13, v[124:127] offset:6528
  ds_write_b128 v13, v[128:131] offset:7616
  s_waitcnt lgkmcnt(0)
  s_barrier
  ds_read_b128 v[32:35], v14 offset:0
  ds_read_b128 v[36:39], v14 offset:512
  ds_read_b128 v[40:43], v14 offset:8704
  ds_read_b128 v[44:47], v14 offset:9216
  ds_read_b128 v[48:51], v14 offset:17408
  ds_read_b128 v[52:55], v14 offset:17920
  ds_read_b128 v[56:59], v14 offset:26112
  ds_read_b128 v[60:63], v14 offset:26624
  s_waitcnt lgkmcnt(4)
  v_pk_add_f32 v[32:33], v[32:33], v[40:41]
  v_pk_add_f32 v[34:35], v[34:35], v[42:43]
  v_pk_add_f32 v[36:37], v[36:37], v[44:45]
  v_pk_add_f32 v[38:39], v[38:39], v[46:47]
  s_waitcnt lgkmcnt(0)
  v_pk_add_f32 v[48:49], v[48:49], v[56:57]
  v_pk_add_f32 v[50:51], v[50:51], v[58:59]
  v_pk_add_f32 v[52:53], v[52:53], v[60:61]
  v_pk_add_f32 v[54:55], v[54:55], v[62:63]
  v_pk_add_f32 v[32:33], v[32:33], v[48:49]
  v_pk_add_f32 v[34:35], v[34:35], v[50:51]
  v_pk_add_f32 v[36:37], v[36:37], v[52:53]
  v_pk_add_f32 v[38:39], v[38:39], v[54:55]
  v_cvt_pk_bf16_f32 v32, 0, v32
  v_cvt_pk_bf16_f32 v33, 0, v33
  v_cvt_pk_bf16_f32 v34, 0, v34
  v_cvt_pk_bf16_f32 v35, 0, v35
  v_cvt_pk_bf16_f32 v36, 0, v36
  v_cvt_pk_bf16_f32 v37, 0, v37
  v_cvt_pk_bf16_f32 v38, 0, v38
  v_cvt_pk_bf16_f32 v39, 0, v39
  v_pk_add_f32 v[32:33], v[32:33], v[64:65]
  v_pk_add_f32 v[34:35], v[34:35], v[66:67]
  v_pk_add_f32 v[36:37], v[36:37], v[68:69]
  v_pk_add_f32 v[38:39], v[38:39], v[70:71]
  v_cvt_pk_bf16_f32 v80, v32, v33
  v_cvt_pk_bf16_f32 v81, v34, v35
  v_cvt_pk_bf16_f32 v82, v36, v37
  v_cvt_pk_bf16_f32 v83, v38, v39
  ds_write_b128 v17, v[80:83]
  s_lshl_b32 s3, s6, 10
  v_add_u32 v64, s3, v18
  s_add_u32 s98, s51, 0x00100000
  s_waitcnt lgkmcnt(0)
  ds_read_b64_tr_b16 v[72:73], v64 offset:0
  ds_read_b64_tr_b16 v[74:75], v64 offset:256
  s_waitcnt lgkmcnt(0)
  buffer_store_dwordx4 v[72:75], v15, s[16:19], s98 offen sc1
  s_or_b32 s3, s2, s6
  s_cbranch_scc1 B_fin
  v_mov_b32 v32, s72
  v_mov_b32 v33, 0
  s_mov_b32 s3, 0x01420000
  s_mov_b64 exec, 1
  buffer_store_dword v32, v33, s[8:11], s3 offen sc1
  s_mov_b64 exec, -1
B_fin:
  s_endpgm
P_idle:
  s_waitcnt vmcnt(0)
  s_branch P_ldd
P_idle2:
  s_waitcnt vmcnt(0)
  s_branch P_done
P_s0retry:
  s_sub_u32 s39, s39, 1
  s_cselect_b32 s56, 0, s56
  s_cselect_b32 s57, 0, s57
  s_mov_b64 exec, vcc
  s_add_u32 s3, s74, 0x01600000
  buffer_load_dwordx4 v[168:171], v82, s[8:11], s3 offen sc1
  s_add_u32 s3, s74, 0x01800000
  buffer_load_dwordx4 v[172:175], v82, s[8:11], s3 offen sc1
  s_add_u32 s3, s74, 0x01600000
  buffer_load_dwordx4 v[180:183], v83, s[8:11], s3 offen sc1
  s_add_u32 s3, s74, 0x01800000
  buffer_load_dwordx4 v[184:187], v83, s[8:11], s3 offen sc1
  s_mov_b32 s3, 0x01400000
  buffer_load_dwordx4 v[176:179], v16, s[8:11], s3 offen sc1
  s_mov_b32 s3, 0x01401000
  buffer_load_dwordx4 v[188:191], v16, s[8:11], s3 offen sc1
  s_mov_b32 s3, 0x01402000
  buffer_load_dwordx4 v[192:195], v16, s[8:11], s3 offen sc1
  s_mov_b32 s3, 0x01403000
  buffer_load_dwordx4 v[196:199], v16, s[8:11], s3 offen sc1
  s_mov_b64 exec, -1
  s_waitcnt vmcnt(0)
  s_branch P_s0chk
F_retry0:
  s_sub_u32 s39, s39, 1
  s_cselect_b32 s56, 0, s56
  s_cselect_b32 s57, 0, s57
  s_mov_b32 s3, 0x01440000
  buffer_load_dwordx2 v[140:141], v20, s[8:11], s3 offen sc1
  s_waitcnt vmcnt(0)
  s_branch F_chk0
F_retry1:
  s_sub_u32 s39, s39, 1
  s_cselect_b32 s56, 0, s56
  s_cselect_b32 s57, 0, s57
  s_mov_b32 s3, 0x01440000
  buffer_load_dwordx2 v[140:141], v20, s[8:11], s3 offen sc1
  s_waitcnt vmcnt(0)
  s_branch F_chk1
G_r00:
  s_add_u32 s89, s40, 0x00000000
  s_mov_b32 s94, 0x00000000
  s_call_b64 s[48:49], G_retry
  s_branch G_b00
S_0:
  s_waitcnt lgkmcnt(0)
  s_barrier
  ds_read_b128 v[160:163], v11 offset:0
  ds_read_b128 v[164:167], v11 offset:16
  s_add_u32 s98, s12, 0x00420000
  s_waitcnt lgkmcnt(0)
  v_add_f32 v160, v160, v161
  v_add_f32 v162, v162, v163
  v_add_f32 v164, v164, v165
  v_add_f32 v166, v166, v167
  v_add_f32 v160, v160, v162
  v_add_f32 v164, v164, v166
  v_mul_f32 v160, 0xbb000000, v160
  v_mul_f32 v164, 0x3b000000, v164
  v_cvt_pk_bf16_f32 v156, v160, v160
  v_fma_f32 v164, -v160, v160, v164
  v_cvt_pk_bf16_f32 v164, 0, |v164|
  v_add_f32 v164, 0x3727c5ac, v164
  v_cvt_pk_bf16_f32 v164, 0, v164
  v_sqrt_f32 v164, v164
  v_mov_b32 v157, v156
  v_cvt_pk_bf16_f32 v164, 0, v164
  v_rcp_f32 v160, v164
  v_mul_f32 v66, v164, v164
  v_mul_f32 v161, v160, v160
  v_mul_f32 v64, 0xc0135761, v160
  v_mul_f32 v161, 0x3d372713, v161
  v_mul_f32 v65, v161, v64
  v_mov_b32 v67, v156
  s_mov_b64 exec, s[70:71]
  buffer_store_dwordx4 v[64:67], v9, s[8:11], s98 offen sc1
  s_mov_b64 exec, -1
  s_waitcnt vmcnt(2)
  ds_read_b64_tr_b16 v[84:85], v24 offset:32768
  ds_read_b64_tr_b16 v[86:87], v24 offset:33024
  ds_read_b64_tr_b16 v[88:89], v24 offset:33792
  ds_read_b64_tr_b16 v[90:91], v24 offset:34048
  ds_read_b64_tr_b16 v[92:93], v24 offset:34816
  ds_read_b64_tr_b16 v[94:95], v24 offset:35072
  ds_read_b64_tr_b16 v[96:97], v24 offset:35840
  ds_read_b64_tr_b16 v[98:99], v24 offset:36096
  ds_read_b64_tr_b16 v[100:101], v24 offset:36864
  ds_read_b64_tr_b16 v[102:103], v24 offset:37120
  ds_read_b64_tr_b16 v[104:105], v24 offset:37888
  ds_read_b64_tr_b16 v[106:107], v24 offset:38144
  ds_read_b64_tr_b16 v[108:109], v24 offset:38912
  ds_read_b64_tr_b16 v[110:111], v24 offset:39168
  ds_read_b64_tr_b16 v[112:113], v24 offset:39936
  ds_read_b64_tr_b16 v[114:115], v24 offset:40192
  s_waitcnt lgkmcnt(0)
  v_mfma_f32_4x4x4_16b_bf16 v[140:143], v[84:85], v[84:85], 0
  v_mfma_f32_4x4x4_16b_bf16 v[144:147], v[22:23], v[84:85], 0
  v_mfma_f32_4x4x4_16b_bf16 v[148:151], v[86:87], v[86:87], 0
  v_mfma_f32_4x4x4_16b_bf16 v[152:155], v[22:23], v[86:87], 0
  v_mfma_f32_4x4x4_16b_bf16 v[140:143], v[88:89], v[88:89], v[140:143]
  v_mfma_f32_4x4x4_16b_bf16 v[144:147], v[22:23], v[88:89], v[144:147]
  v_mfma_f32_4x4x4_16b_bf16 v[148:151], v[90:91], v[90:91], v[148:151]
  v_mfma_f32_4x4x4_16b_bf16 v[152:155], v[22:23], v[90:91], v[152:155]
  v_mfma_f32_4x4x4_16b_bf16 v[140:143], v[92:93], v[92:93], v[140:143]
  v_mfma_f32_4x4x4_16b_bf16 v[144:147], v[22:23], v[92:93], v[144:147]
  v_mfma_f32_4x4x4_16b_bf16 v[148:151], v[94:95], v[94:95], v[148:151]
  v_mfma_f32_4x4x4_16b_bf16 v[152:155], v[22:23], v[94:95], v[152:155]
  v_mfma_f32_4x4x4_16b_bf16 v[140:143], v[96:97], v[96:97], v[140:143]
  v_mfma_f32_4x4x4_16b_bf16 v[144:147], v[22:23], v[96:97], v[144:147]
  v_mfma_f32_4x4x4_16b_bf16 v[148:151], v[98:99], v[98:99], v[148:151]
  v_mfma_f32_4x4x4_16b_bf16 v[152:155], v[22:23], v[98:99], v[152:155]
  v_mfma_f32_4x4x4_16b_bf16 v[140:143], v[100:101], v[100:101], v[140:143]
  v_mfma_f32_4x4x4_16b_bf16 v[144:147], v[22:23], v[100:101], v[144:147]
  v_mfma_f32_4x4x4_16b_bf16 v[148:151], v[102:103], v[102:103], v[148:151]
  v_mfma_f32_4x4x4_16b_bf16 v[152:155], v[22:23], v[102:103], v[152:155]
  v_mfma_f32_4x4x4_16b_bf16 v[140:143], v[104:105], v[104:105], v[140:143]
  v_mfma_f32_4x4x4_16b_bf16 v[144:147], v[22:23], v[104:105], v[144:147]
  v_mfma_f32_4x4x4_16b_bf16 v[148:151], v[106:107], v[106:107], v[148:151]
  v_mfma_f32_4x4x4_16b_bf16 v[152:155], v[22:23], v[106:107], v[152:155]
  v_mfma_f32_4x4x4_16b_bf16 v[140:143], v[108:109], v[108:109], v[140:143]
  v_mfma_f32_4x4x4_16b_bf16 v[144:147], v[22:23], v[108:109], v[144:147]
  v_mfma_f32_4x4x4_16b_bf16 v[148:151], v[110:111], v[110:111], v[148:151]
  v_mfma_f32_4x4x4_16b_bf16 v[152:155], v[22:23], v[110:111], v[152:155]
  v_mfma_f32_4x4x4_16b_bf16 v[140:143], v[112:113], v[112:113], v[140:143]
  v_mfma_f32_4x4x4_16b_bf16 v[144:147], v[22:23], v[112:113], v[144:147]
  v_mfma_f32_4x4x4_16b_bf16 v[148:151], v[114:115], v[114:115], v[148:151]
  v_mfma_f32_4x4x4_16b_bf16 v[152:155], v[22:23], v[114:115], v[152:155]
  s_nop 4
  v_add_f32 v140, v140, v148
  v_add_f32 v141, v141, v149
  v_add_f32 v142, v142, v150
  v_add_f32 v143, v143, v151
  v_add_f32 v144, v144, v152
  v_cndmask_b32 v140, v140, v141, s[62:63]
  v_cndmask_b32 v142, v142, v143, s[62:63]
  v_cndmask_b32 v140, v140, v142, s[64:65]
  s_nop 1
  v_permlane32_swap_b32 v144, v140
  s_nop 0
  v_add_f32 v144, v144, v140
  v_cmp_u_f32 vcc, v144, v144
  s_and_b64 vcc, vcc, s[56:57]
  s_cbranch_scc1 G_rs01
G_bs01:
  ds_write_b32 v10, v144 offset:1024
  s_waitcnt lgkmcnt(0)
  s_barrier
  ds_read_b128 v[160:163], v11 offset:1024
  ds_read_b128 v[164:167], v11 offset:1040
  s_add_u32 s98, s13, 0x00420000
  s_waitcnt lgkmcnt(0)
  v_add_f32 v160, v160, v161
  v_add_f32 v162, v162, v163
  v_add_f32 v164, v164, v165
  v_add_f32 v166, v166, v167
  v_add_f32 v160, v160, v162
  v_add_f32 v164, v164, v166
  v_mul_f32 v160, 0xbb000000, v160
  v_mul_f32 v164, 0x3b000000, v164
  v_cvt_pk_bf16_f32 v156, v160, v160
  v_fma_f32 v164, -v160, v160, v164
  v_cvt_pk_bf16_f32 v164, 0, |v164|
  v_add_f32 v164, 0x3727c5ac, v164
  v_cvt_pk_bf16_f32 v164, 0, v164
  v_sqrt_f32 v164, v164
  v_mov_b32 v157, v156
  v_cvt_pk_bf16_f32 v164, 0, v164
  v_rcp_f32 v160, v164
  v_mul_f32 v66, v164, v164
  v_mul_f32 v161, v160, v160
  v_mul_f32 v64, 0xc0135761, v160
  v_mul_f32 v161, 0x3d372713, v161
  v_mul_f32 v65, v161, v64
  v_mov_b32 v67, v156
  s_mov_b64 exec, s[70:71]
  buffer_store_dwordx4 v[64:67], v9, s[8:11], s98 offen sc1
  s_mov_b64 exec, -1
  s_add_u32 m0, s60, 0x00010000
  s_add_u32 s89, s42, 0x00100000
  buffer_load_dwordx4 v9, s[8:11], s89 offen offset:0 sc1 lds
  buffer_load_dwordx4 v9, s[8:11], s89 offen offset:1024 sc1 lds
  buffer_load_dwordx4 v9, s[8:11], s89 offen offset:2048 sc1 lds
  buffer_load_dwordx4 v9, s[8:11], s89 offen offset:3072 sc1 lds
  s_add_u32 m0, s60, 0x00011000
  s_add_u32 s89, s42, 0x00101000
  buffer_load_dwordx4 v9, s[8:11], s89 offen offset:0 sc1 lds
  buffer_load_dwordx4 v9, s[8:11], s89 offen offset:1024 sc1 lds
  buffer_load_dwordx4 v9, s[8:11], s89 offen offset:2048 sc1 lds
  buffer_load_dwordx4 v9, s[8:11], s89 offen offset:3072 sc1 lds
  s_add_u32 m0, s60, 0x00000000
  s_add_u32 s89, s40, 0x00100000
  buffer_load_dwordx4 v9, s[8:11], s89 offen offset:0 sc1 lds
  buffer_load_dwordx4 v9, s[8:11], s89 offen offset:1024 sc1 lds
  buffer_load_dwordx4 v9, s[8:11], s89 offen offset:2048 sc1 lds
  buffer_load_dwordx4 v9, s[8:11], s89 offen offset:3072 sc1 lds
  s_add_u32 m0, s60, 0x00001000
  s_add_u32 s89, s40, 0x00101000
  buffer_load_dwordx4 v9, s[8:11], s89 offen offset:0 sc1 lds
  buffer_load_dwordx4 v9, s[8:11], s89 offen offset:1024 sc1 lds
  buffer_load_dwordx4 v9, s[8:11], s89 offen offset:2048 sc1 lds
  buffer_load_dwordx4 v9, s[8:11], s89 offen offset:3072 sc1 lds
  s_add_u32 s97, s44, 0x006f4000
  buffer_store_dwordx4 v[200:203], v9, s[20:23], s97 offen sc1
  s_add_u32 s95, s55, 0x02200000
  buffer_load_dwordx4 a[0:3], v9, s[8:11], s95 offen offset:0 sc1
  buffer_load_dwordx4 a[4:7], v9, s[8:11], s95 offen offset:1024 sc1
  buffer_load_dwordx4 a[8:11], v9, s[8:11], s95 offen offset:2048 sc1
  buffer_load_dwordx4 a[12:15], v9, s[8:11], s95 offen offset:3072 sc1
  s_add_u32 s95, s55, 0x02201000
  buffer_load_dwordx4 a[16:19], v9, s[8:11], s95 offen offset:0 sc1
  buffer_load_dwordx4 a[20:23], v9, s[8:11], s95 offen offset:1024 sc1
  buffer_load_dwordx4 a[24:27], v9, s[8:11], s95 offen offset:2048 sc1
  buffer_load_dwordx4 a[28:31], v9, s[8:11], s95 offen offset:3072 sc1
  s_add_u32 s95, s55, 0x02202000
  buffer_load_dwordx4 a[32:35], v9, s[8:11], s95 offen offset:0 sc1
  buffer_load_dwordx4 a[36:39], v9, s[8:11], s95 offen offset:1024 sc1
  s_waitcnt vmcnt(19)
  ds_read_b64_tr_b16 v[84:85], v28 offset:0
  ds_read_b64_tr_b16 v[86:87], v28 offset:256
  ds_read_b64_tr_b16 v[88:89], v28 offset:1024
  ds_read_b64_tr_b16 v[90:91], v28 offset:1280
  ds_read_b64_tr_b16 v[92:93], v28 offset:2048
  ds_read_b64_tr_b16 v[94:95], v28 offset:2304
  ds_read_b64_tr_b16 v[96:97], v28 offset:3072
  ds_read_b64_tr_b16 v[98:99], v28 offset:3328
  ds_read_b64_tr_b16 v[100:101], v28 offset:4096
  ds_read_b64_tr_b16 v[102:103], v28 offset:4352
  ds_read_b64_tr_b16 v[104:105], v28 offset:5120
  ds_read_b64_tr_b16 v[106:107], v28 offset:5376
  ds_read_b64_tr_b16 v[108:109], v28 offset:6144
  ds_read_b64_tr_b16 v[110:111], v28 offset:6400
  ds_read_b64_tr_b16 v[112:113], v28 offset:7168
  ds_read_b64_tr_b16 v[114:115], v28 offset:7424
  s_waitcnt lgkmcnt(0)
  v_mfma_f32_4x4x4_16b_bf16 v[140:143], v[84:85], v[84:85], 0
  v_mfma_f32_4x4x4_16b_bf16 v[144:147], v[22:23], v[84:85], 0
  v_mfma_f32_4x4x4_16b_bf16 v[148:151], v[86:87], v[86:87], 0
  v_mfma_f32_4x4x4_16b_bf16 v[152:155], v[22:23], v[86:87], 0
  v_mfma_f32_4x4x4_16b_bf16 v[140:143], v[88:89], v[88:89], v[140:143]
  v_mfma_f32_4x4x4_16b_bf16 v[144:147], v[22:23], v[88:89], v[144:147]
  v_mfma_f32_4x4x4_16b_bf16 v[148:151], v[90:91], v[90:91], v[148:151]
  v_mfma_f32_4x4x4_16b_bf16 v[152:155], v[22:23], v[90:91], v[152:155]
  v_mfma_f32_4x4x4_16b_bf16 v[140:143], v[92:93], v[92:93], v[140:143]
  v_mfma_f32_4x4x4_16b_bf16 v[144:147], v[22:23], v[92:93], v[144:147]
  v_mfma_f32_4x4x4_16b_bf16 v[148:151], v[94:95], v[94:95], v[148:151]
  v_mfma_f32_4x4x4_16b_bf16 v[152:155], v[22:23], v[94:95], v[152:155]
  v_mfma_f32_4x4x4_16b_bf16 v[140:143], v[96:97], v[96:97], v[140:143]
  v_mfma_f32_4x4x4_16b_bf16 v[144:147], v[22:23], v[96:97], v[144:147]
  v_mfma_f32_4x4x4_16b_bf16 v[148:151], v[98:99], v[98:99], v[148:151]
  v_mfma_f32_4x4x4_16b_bf16 v[152:155], v[22:23], v[98:99], v[152:155]
  v_mfma_f32_4x4x4_16b_bf16 v[140:143], v[100:101], v[100:101], v[140:143]
  v_mfma_f32_4x4x4_16b_bf16 v[144:147], v[22:23], v[100:101], v[144:147]
  v_mfma_f32_4x4x4_16b_bf16 v[148:151], v[102:103], v[102:103], v[148:151]
  v_mfma_f32_4x4x4_16b_bf16 v[152:155], v[22:23], v[102:103], v[152:155]
  v_mfma_f32_4x4x4_16b_bf16 v[140:143], v[104:105], v[104:105], v[140:143]
  v_mfma_f32_4x4x4_16b_bf16 v[144:147], v[22:23], v[104:105], v[144:147]
  v_mfma_f32_4x4x4_16b_bf16 v[148:151], v[106:107], v[106:107], v[148:151]
  v_mfma_f32_4x4x4_16b_bf16 v[152:155], v[22:23], v[106:107], v[152:155]
  v_mfma_f32_4x4x4_16b_bf16 v[140:143], v[108:109], v[108:109], v[140:143]
  v_mfma_f32_4x4x4_16b_bf16 v[144:147], v[22:23], v[108:109], v[144:147]
  v_mfma_f32_4x4x4_16b_bf16 v[148:151], v[110:111], v[110:111], v[148:151]
  v_mfma_f32_4x4x4_16b_bf16 v[152:155], v[22:23], v[110:111], v[152:155]
  v_mfma_f32_4x4x4_16b_bf16 v[140:143], v[112:113], v[112:113], v[140:143]
  v_mfma_f32_4x4x4_16b_bf16 v[144:147], v[22:23], v[112:113], v[144:147]
  v_mfma_f32_4x4x4_16b_bf16 v[148:151], v[114:115], v[114:115], v[148:151]
  v_mfma_f32_4x4x4_16b_bf16 v[152:155], v[22:23], v[114:115], v[152:155]
  s_nop 4
  v_add_f32 v140, v140, v148
  v_add_f32 v141, v141, v149
  v_add_f32 v142, v142, v150
  v_add_f32 v143, v143, v151
  v_add_f32 v144, v144, v152
  v_cndmask_b32 v140, v140, v141, s[62:63]
  v_cndmask_b32 v142, v142, v143, s[62:63]
  v_cndmask_b32 v140, v140, v142, s[64:65]
  s_nop 1
  v_permlane32_swap_b32 v144, v140
  s_nop 0
  v_add_f32 v144, v144, v140
  v_cmp_u_f32 vcc, v144, v144
  s_and_b64 vcc, vcc, s[56:57]
  s_cbranch_scc1 G_rs02
G_bs02:
  ds_write_b32 v10, v144 offset:0
  s_waitcnt lgkmcnt(0)
  s_barrier
  ds_read_b128 v[160:163], v11 offset:0
  ds_read_b128 v[164:167], v11 offset:16
  s_add_u32 s98, s14, 0x00424000
  s_waitcnt lgkmcnt(0)
  v_add_f32 v160, v160, v161
  v_add_f32 v162, v162, v163
  v_add_f32 v164, v164, v165
  v_add_f32 v166, v166, v167
  v_add_f32 v160, v160, v162
  v_add_f32 v164, v164, v166
  v_mul_f32 v160, 0xbb000000, v160
  v_mul_f32 v164, 0x3b000000, v164
  v_cvt_pk_bf16_f32 v156, v160, v160
  v_fma_f32 v164, -v160, v160, v164
  v_cvt_pk_bf16_f32 v164, 0, |v164|
  v_add_f32 v164, 0x3727c5ac, v164
  v_cvt_pk_bf16_f32 v164, 0, v164
  v_sqrt_f32 v164, v164
  v_mov_b32 v157, v156
  v_cvt_pk_bf16_f32 v164, 0, v164
  v_rcp_f32 v160, v164
  v_mul_f32 v66, v164, v164
  v_mul_f32 v161, v160, v160
  v_mul_f32 v64, 0xc0135761, v160
  v_mul_f32 v161, 0x3d372713, v161
  v_mul_f32 v65, v161, v64
  v_mov_b32 v67, v156
  s_mov_b64 exec, s[70:71]
  buffer_store_dwordx4 v[64:67], v9, s[8:11], s98 offen sc1
  s_mov_b64 exec, -1
  s_add_u32 m0, s60, 0x00008000
  s_add_u32 s89, s41, 0x00100000
  buffer_load_dwordx4 v9, s[8:11], s89 offen offset:0 sc1 lds
  buffer_load_dwordx4 v9, s[8:11], s89 offen offset:1024 sc1 lds
  buffer_load_dwordx4 v9, s[8:11], s89 offen offset:2048 sc1 lds
  buffer_load_dwordx4 v9, s[8:11], s89 offen offset:3072 sc1 lds
  s_add_u32 m0, s60, 0x00009000
  s_add_u32 s89, s41, 0x00101000
  buffer_load_dwordx4 v9, s[8:11], s89 offen offset:0 sc1 lds
  buffer_load_dwordx4 v9, s[8:11], s89 offen offset:1024 sc1 lds
  buffer_load_dwordx4 v9, s[8:11], s89 offen offset:2048 sc1 lds
  buffer_load_dwordx4 v9, s[8:11], s89 offen offset:3072 sc1 lds
  s_add_u32 s97, s45, 0x006f4000
  buffer_store_dwordx4 v[200:203], v9, s[24:27], s97 offen sc1
  buffer_load_dwordx4 a[40:43], v9, s[8:11], s95 offen offset:2048 sc1
  buffer_load_dwordx4 a[44:47], v9, s[8:11], s95 offen offset:3072 sc1
  s_add_u32 s95, s55, 0x02203000
  buffer_load_dwordx4 a[48:51], v9, s[8:11], s95 offen offset:0 sc1
  buffer_load_dwordx4 a[52:55], v9, s[8:11], s95 offen offset:1024 sc1
  buffer_load_dwordx4 a[56:59], v9, s[8:11], s95 offen offset:2048 sc1
  buffer_load_dwordx4 a[60:63], v9, s[8:11], s95 offen offset:3072 sc1
  s_add_u32 s95, s55, 0x02204000
  buffer_load_dwordx4 a[64:67], v9, s[8:11], s95 offen offset:0 sc1
  buffer_load_dwordx4 a[68:71], v9, s[8:11], s95 offen offset:1024 sc1
  buffer_load_dwordx4 a[72:75], v9, s[8:11], s95 offen offset:2048 sc1
  buffer_load_dwordx4 a[76:79], v9, s[8:11], s95 offen offset:3072 sc1
  s_waitcnt vmcnt(31)
  ds_read_b64_tr_b16 v[84:85], v24 offset:0
  ds_read_b64_tr_b16 v[86:87], v24 offset:256
  ds_read_b64_tr_b16 v[88:89], v24 offset:1024
  ds_read_b64_tr_b16 v[90:91], v24 offset:1280
  ds_read_b64_tr_b16 v[92:93], v24 offset:2048
  ds_read_b64_tr_b16 v[94:95], v24 offset:2304
  ds_read_b64_tr_b16 v[96:97], v24 offset:3072
  ds_read_b64_tr_b16 v[98:99], v24 offset:3328
  ds_read_b64_tr_b16 v[100:101], v24 offset:4096
  ds_read_b64_tr_b16 v[102:103], v24 offset:4352
  ds_read_b64_tr_b16 v[104:105], v24 offset:5120
  ds_read_b64_tr_b16 v[106:107], v24 offset:5376
  ds_read_b64_tr_b16 v[108:109], v24 offset:6144
  ds_read_b64_tr_b16 v[110:111], v24 offset:6400
  ds_read_b64_tr_b16 v[112:113], v24 offset:7168
  ds_read_b64_tr_b16 v[114:115], v24 offset:7424
  s_waitcnt lgkmcnt(0)
  v_mfma_f32_4x4x4_16b_bf16 v[140:143], v[84:85], v[84:85], 0
  v_mfma_f32_4x4x4_16b_bf16 v[144:147], v[22:23], v[84:85], 0
  v_mfma_f32_4x4x4_16b_bf16 v[148:151], v[86:87], v[86:87], 0
  v_mfma_f32_4x4x4_16b_bf16 v[152:155], v[22:23], v[86:87], 0
  v_mfma_f32_4x4x4_16b_bf16 v[140:143], v[88:89], v[88:89], v[140:143]
  v_mfma_f32_4x4x4_16b_bf16 v[144:147], v[22:23], v[88:89], v[144:147]
  v_mfma_f32_4x4x4_16b_bf16 v[148:151], v[90:91], v[90:91], v[148:151]
  v_mfma_f32_4x4x4_16b_bf16 v[152:155], v[22:23], v[90:91], v[152:155]
  v_mfma_f32_4x4x4_16b_bf16 v[140:143], v[92:93], v[92:93], v[140:143]
  v_mfma_f32_4x4x4_16b_bf16 v[144:147], v[22:23], v[92:93], v[144:147]
  v_mfma_f32_4x4x4_16b_bf16 v[148:151], v[94:95], v[94:95], v[148:151]
  v_mfma_f32_4x4x4_16b_bf16 v[152:155], v[22:23], v[94:95], v[152:155]
  v_mfma_f32_4x4x4_16b_bf16 v[140:143], v[96:97], v[96:97], v[140:143]
  v_mfma_f32_4x4x4_16b_bf16 v[144:147], v[22:23], v[96:97], v[144:147]
  v_mfma_f32_4x4x4_16b_bf16 v[148:151], v[98:99], v[98:99], v[148:151]
  v_mfma_f32_4x4x4_16b_bf16 v[152:155], v[22:23], v[98:99], v[152:155]
  v_mfma_f32_4x4x4_16b_bf16 v[140:143], v[100:101], v[100:101], v[140:143]
  v_mfma_f32_4x4x4_16b_bf16 v[144:147], v[22:23], v[100:101], v[144:147]
  v_mfma_f32_4x4x4_16b_bf16 v[148:151], v[102:103], v[102:103], v[148:151]
  v_mfma_f32_4x4x4_16b_bf16 v[152:155], v[22:23], v[102:103], v[152:155]
  v_mfma_f32_4x4x4_16b_bf16 v[140:143], v[104:105], v[104:105], v[140:143]
  v_mfma_f32_4x4x4_16b_bf16 v[144:147], v[22:23], v[104:105], v[144:147]
  v_mfma_f32_4x4x4_16b_bf16 v[148:151], v[106:107], v[106:107], v[148:151]
  v_mfma_f32_4x4x4_16b_bf16 v[152:155], v[22:23], v[106:107], v[152:155]
  v_mfma_f32_4x4x4_16b_bf16 v[140:143], v[108:109], v[108:109], v[140:143]
  v_mfma_f32_4x4x4_16b_bf16 v[144:147], v[22:23], v[108:109], v[144:147]
  v_mfma_f32_4x4x4_16b_bf16 v[148:151], v[110:111], v[110:111], v[148:151]
  v_mfma_f32_4x4x4_16b_bf16 v[152:155], v[22:23], v[110:111], v[152:155]
  v_mfma_f32_4x4x4_16b_bf16 v[140:143], v[112:113], v[112:113], v[140:143]
  v_mfma_f32_4x4x4_16b_bf16 v[144:147], v[22:23], v[112:113], v[144:147]
  v_mfma_f32_4x4x4_16b_bf16 v[148:151], v[114:115], v[114:115], v[148:151]
  v_mfma_f32_4x4x4_16b_bf16 v[152:155], v[22:23], v[114:115], v[152:155]
  s_nop 4
  v_add_f32 v140, v140, v148
  v_add_f32 v141, v141, v149
  v_add_f32 v142, v142, v150
  v_add_f32 v143, v143, v151
  v_add_f32 v144, v144, v152
  v_cndmask_b32 v140, v140, v141, s[62:63]
  v_cndmask_b32 v142, v142, v143, s[62:63]
  v_cndmask_b32 v140, v140, v142, s[64:65]
  s_nop 1
  v_permlane32_swap_b32 v144, v140
  s_nop 0
  v_add_f32 v144, v144, v140
  v_cmp_u_f32 vcc, v144, v144
  s_and_b64 vcc, vcc, s[56:57]
  s_cbranch_scc1 G_rs03
G_bs03:
  ds_write_b32 v10, v144 offset:1024
  s_waitcnt lgkmcnt(0)
  s_barrier
  ds_read_b128 v[160:163], v11 offset:1024
  ds_read_b128 v[164:167], v11 offset:1040
  s_add_u32 s98, s12, 0x00424000
  s_waitcnt lgkmcnt(0)
  v_add_f32 v160, v160, v161
  v_add_f32 v162, v162, v163
  v_add_f32 v164, v164, v165
  v_add_f32 v166, v166, v167
  v_add_f32 v160, v160, v162
  v_add_f32 v164, v164, v166
  v_mul_f32 v160, 0xbb000000, v160
  v_mul_f32 v164, 0x3b000000, v164
  v_cvt_pk_bf16_f32 v156, v160, v160
  v_fma_f32 v164, -v160, v160, v164
  v_cvt_pk_bf16_f32 v164, 0, |v164|
  v_add_f32 v164, 0x3727c5ac, v164
  v_cvt_pk_bf16_f32 v164, 0, v164
  v_sqrt_f32 v164, v164
  v_mov_b32 v157, v156
  v_cvt_pk_bf16_f32 v164, 0, v164
  v_rcp_f32 v160, v164
  v_mul_f32 v66, v164, v164
  v_mul_f32 v161, v160, v160
  v_mul_f32 v64, 0xc0135761, v160
  v_mul_f32 v161, 0x3d372713, v161
  v_mul_f32 v65, v161, v64
  v_mov_b32 v67, v156
  s_mov_b64 exec, s[70:71]
  buffer_store_dwordx4 v[64:67], v9, s[8:11], s98 offen sc1
  s_mov_b64 exec, -1
  s_add_u32 s95, s55, 0x02205000
  buffer_load_dwordx4 a[80:83], v9, s[8:11], s95 offen offset:0 sc1
  buffer_load_dwordx4 a[84:87], v9, s[8:11], s95 offen offset:1024 sc1
  buffer_load_dwordx4 a[88:91], v9, s[8:11], s95 offen offset:2048 sc1
  buffer_load_dwordx4 a[92:95], v9, s[8:11], s95 offen offset:3072 sc1
  s_add_u32 s95, s55, 0x02206000
  buffer_load_dwordx4 a[96:99], v9, s[8:11], s95 offen offset:0 sc1
  buffer_load_dwordx4 a[100:103], v9, s[8:11], s95 offen offset:1024 sc1
  buffer_load_dwordx4 a[104:107], v9, s[8:11], s95 offen offset:2048 sc1
  buffer_load_dwordx4 a[108:111], v9, s[8:11], s95 offen offset:3072 sc1
  s_add_u32 s95, s55, 0x02207000
  buffer_load_dwordx4 a[112:115], v9, s[8:11], s95 offen offset:0 sc1
  s_add_u32 s97, s58, 0x00a00000
  buffer_store_dwordx4 v[200:203], v16, s[8:11], s97 offen sc1
  s_add_u32 s97, s58, 0x00b00000
  buffer_store_dwordx4 v[200:203], v16, s[8:11], s97 offen sc1
  s_waitcnt vmcnt(23)
  ds_read_b64_tr_b16 v[84:85], v24 offset:32768
  ds_read_b64_tr_b16 v[86:87], v24 offset:33024
  ds_read_b64_tr_b16 v[88:89], v24 offset:33792
  ds_read_b64_tr_b16 v[90:91], v24 offset:34048
  ds_read_b64_tr_b16 v[92:93], v24 offset:34816
  ds_read_b64_tr_b16 v[94:95], v24 offset:35072
  ds_read_b64_tr_b16 v[96:97], v24 offset:35840
  ds_read_b64_tr_b16 v[98:99], v24 offset:36096
  ds_read_b64_tr_b16 v[100:101], v24 offset:36864
  ds_read_b64_tr_b16 v[102:103], v24 offset:37120
  ds_read_b64_tr_b16 v[104:105], v24 offset:37888
  ds_read_b64_tr_b16 v[106:107], v24 offset:38144
  ds_read_b64_tr_b16 v[108:109], v24 offset:38912
  ds_read_b64_tr_b16 v[110:111], v24 offset:39168
  ds_read_b64_tr_b16 v[112:113], v24 offset:39936
  ds_read_b64_tr_b16 v[114:115], v24 offset:40192
  s_waitcnt lgkmcnt(0)
  v_mfma_f32_4x4x4_16b_bf16 v[140:143], v[84:85], v[84:85], 0
  v_mfma_f32_4x4x4_16b_bf16 v[144:147], v[22:23], v[84:85], 0
  v_mfma_f32_4x4x4_16b_bf16 v[148:151], v[86:87], v[86:87], 0
  v_mfma_f32_4x4x4_16b_bf16 v[152:155], v[22:23], v[86:87], 0
  v_mfma_f32_4x4x4_16b_bf16 v[140:143], v[88:89], v[88:89], v[140:143]
  v_mfma_f32_4x4x4_16b_bf16 v[144:147], v[22:23], v[88:89], v[144:147]
  v_mfma_f32_4x4x4_16b_bf16 v[148:151], v[90:91], v[90:91], v[148:151]
  v_mfma_f32_4x4x4_16b_bf16 v[152:155], v[22:23], v[90:91], v[152:155]
  v_mfma_f32_4x4x4_16b_bf16 v[140:143], v[92:93], v[92:93], v[140:143]
  v_mfma_f32_4x4x4_16b_bf16 v[144:147], v[22:23], v[92:93], v[144:147]
  v_mfma_f32_4x4x4_16b_bf16 v[148:151], v[94:95], v[94:95], v[148:151]
  v_mfma_f32_4x4x4_16b_bf16 v[152:155], v[22:23], v[94:95], v[152:155]
  v_mfma_f32_4x4x4_16b_bf16 v[140:143], v[96:97], v[96:97], v[140:143]
  v_mfma_f32_4x4x4_16b_bf16 v[144:147], v[22:23], v[96:97], v[144:147]
  v_mfma_f32_4x4x4_16b_bf16 v[148:151], v[98:99], v[98:99], v[148:151]
  v_mfma_f32_4x4x4_16b_bf16 v[152:155], v[22:23], v[98:99], v[152:155]
  v_mfma_f32_4x4x4_16b_bf16 v[140:143], v[100:101], v[100:101], v[140:143]
  v_mfma_f32_4x4x4_16b_bf16 v[144:147], v[22:23], v[100:101], v[144:147]
  v_mfma_f32_4x4x4_16b_bf16 v[148:151], v[102:103], v[102:103], v[148:151]
  v_mfma_f32_4x4x4_16b_bf16 v[152:155], v[22:23], v[102:103], v[152:155]
  v_mfma_f32_4x4x4_16b_bf16 v[140:143], v[104:105], v[104:105], v[140:143]
  v_mfma_f32_4x4x4_16b_bf16 v[144:147], v[22:23], v[104:105], v[144:147]
  v_mfma_f32_4x4x4_16b_bf16 v[148:151], v[106:107], v[106:107], v[148:151]
  v_mfma_f32_4x4x4_16b_bf16 v[152:155], v[22:23], v[106:107], v[152:155]
  v_mfma_f32_4x4x4_16b_bf16 v[140:143], v[108:109], v[108:109], v[140:143]
  v_mfma_f32_4x4x4_16b_bf16 v[144:147], v[22:23], v[108:109], v[144:147]
  v_mfma_f32_4x4x4_16b_bf16 v[148:151], v[110:111], v[110:111], v[148:151]
  v_mfma_f32_4x4x4_16b_bf16 v[152:155], v[22:23], v[110:111], v[152:155]
  v_mfma_f32_4x4x4_16b_bf16 v[140:143], v[112:113], v[112:113], v[140:143]
  v_mfma_f32_4x4x4_16b_bf16 v[144:147], v[22:23], v[112:113], v[144:147]
  v_mfma_f32_4x4x4_16b_bf16 v[148:151], v[114:115], v[114:115], v[148:151]
  v_mfma_f32_4x4x4_16b_bf16 v[152:155], v[22:23], v[114:115], v[152:155]
  s_nop 4
  v_add_f32 v140, v140, v148
  v_add_f32 v141, v141, v149
  v_add_f32 v142, v142, v150
  v_add_f32 v143, v143, v151
  v_add_f32 v144, v144, v152
  v_cndmask_b32 v140, v140, v141, s[62:63]
  v_cndmask_b32 v142, v142, v143, s[62:63]
  v_cndmask_b32 v140, v140, v142, s[64:65]
  s_nop 1
  v_permlane32_swap_b32 v144, v140
  s_nop 0
  v_add_f32 v144, v144, v140
  v_cmp_u_f32 vcc, v144, v144
  s_and_b64 vcc, vcc, s[56:57]
  s_cbranch_scc1 G_rs04
G_bs04:
  ds_write_b32 v10, v144 offset:0
  s_waitcnt lgkmcnt(0)
  s_barrier
  ds_read_b128 v[160:163], v11 offset:0
  ds_read_b128 v[164:167], v11 offset:16
  s_add_u32 s98, s13, 0x00424000
  s_waitcnt lgkmcnt(0)
  v_add_f32 v160, v160, v161
  v_add_f32 v162, v162, v163
  v_add_f32 v164, v164, v165
  v_add_f32 v166, v166, v167
  v_add_f32 v160, v160, v162
  v_add_f32 v164, v164, v166
  v_mul_f32 v160, 0xbb000000, v160
  v_mul_f32 v164, 0x3b000000, v164
  v_cvt_pk_bf16_f32 v156, v160, v160
  v_fma_f32 v164, -v160, v160, v164
  v_cvt_pk_bf16_f32 v164, 0, |v164|
  v_add_f32 v164, 0x3727c5ac, v164
  v_cvt_pk_bf16_f32 v164, 0, v164
  v_sqrt_f32 v164, v164
  v_mov_b32 v157, v156
  v_cvt_pk_bf16_f32 v164, 0, v164
  v_rcp_f32 v160, v164
  v_mul_f32 v66, v164, v164
  v_mul_f32 v161, v160, v160
  v_mul_f32 v64, 0xc0135761, v160
  v_mul_f32 v161, 0x3d372713, v161
  v_mul_f32 v65, v161, v64
  v_mov_b32 v67, v156
  s_mov_b64 exec, s[70:71]
  buffer_store_dwordx4 v[64:67], v9, s[8:11], s98 offen sc1
  s_mov_b64 exec, -1
  buffer_load_dwordx4 a[116:119], v9, s[8:11], s95 offen offset:1024 sc1
  buffer_load_dwordx4 a[120:123], v9, s[8:11], s95 offen offset:2048 sc1
  buffer_load_dwordx4 a[124:127], v9, s[8:11], s95 offen offset:3072 sc1
  s_add_u32 s95, s55, 0x02208000
  buffer_load_dwordx4 a[128:131], v9, s[8:11], s95 offen offset:0 sc1
  buffer_load_dwordx4 a[132:135], v9, s[8:11], s95 offen offset:1024 sc1
  buffer_load_dwordx4 a[136:139], v9, s[8:11], s95 offen offset:2048 sc1
  buffer_load_dwordx4 a[140:143], v9, s[8:11], s95 offen offset:3072 sc1
  s_add_u32 s95, s55, 0x02209000
  buffer_load_dwordx4 a[144:147], v9, s[8:11], s95 offen offset:0 sc1
  buffer_load_dwordx4 a[148:151], v9, s[8:11], s95 offen offset:1024 sc1
  buffer_load_dwordx4 a[152:155], v9, s[8:11], s95 offen offset:2048 sc1
  buffer_load_dwordx4 a[156:159], v9, s[8:11], s95 offen offset:3072 sc1
  s_add_u32 s97, s47, 0x00300000
  buffer_store_dwordx4 v[200:203], v16, s[8:11], s97 offen sc1
  s_add_u32 s95, s55, 0x0220a000
  buffer_load_dwordx4 a[160:163], v9, s[8:11], s95 offen offset:0 sc1
  buffer_load_dwordx4 a[164:167], v9, s[8:11], s95 offen offset:1024 sc1
  buffer_load_dwordx4 a[168:171], v9, s[8:11], s95 offen offset:2048 sc1
  buffer_load_dwordx4 a[172:175], v9, s[8:11], s95 offen offset:3072 sc1
  s_add_u32 s96, s46, 0x00434000
  buffer_load_dwordx4 v[168:171], v9, s[8:11], s96 offen offset:0 sc1
  buffer_load_dwordx4 v[172:175], v9, s[8:11], s96 offen offset:1024 sc1
  buffer_load_dwordx4 v[176:179], v9, s[8:11], s96 offen offset:2048 sc1
  buffer_load_dwordx4 v[180:183], v9, s[8:11], s96 offen offset:3072 sc1
  s_add_u32 s96, s46, 0x00435000
  buffer_load_dwordx4 v[184:187], v9, s[8:11], s96 offen offset:0 sc1
  buffer_load_dwordx4 v[188:191], v9, s[8:11], s96 offen offset:1024 sc1
  buffer_load_dwordx4 v[192:195], v9, s[8:11], s96 offen offset:2048 sc1
  buffer_load_dwordx4 v[196:199], v9, s[8:11], s96 offen offset:3072 sc1
  s_add_u32 s96, s46, 0x00436000
  buffer_load_dwordx4 v[200:203], v9, s[8:11], s96 offen offset:0 sc1
  buffer_load_dwordx4 v[140:143], v9, s[8:11], s96 offen offset:1024 sc1
  buffer_load_dwordx4 v[144:147], v9, s[8:11], s96 offen offset:2048 sc1
  buffer_load_dwordx4 v[148:151], v9, s[8:11], s96 offen offset:3072 sc1
  s_add_u32 s96, s46, 0x00437000
  buffer_load_dwordx4 v[152:155], v9, s[8:11], s96 offen offset:0 sc1
  buffer_load_dwordx4 v[84:87], v9, s[8:11], s96 offen offset:1024 sc1
  s_waitcnt vmcnt(0) lgkmcnt(0)
  s_branch G2_0
G_r01:
  s_add_u32 s89, s41, 0x00000000
  s_mov_b32 s94, 0x00008000
  s_call_b64 s[48:49], G_retry
  s_branch G_b01
T_r01:
  s_sub_u32 s39, s39, 1
  s_cselect_b32 s56, 0, s56
  s_cselect_b32 s57, 0, s57
  s_add_u32 s3, s13, 0x00420000
  buffer_load_dwordx4 v[68:71], v20, s[8:11], s3 offen sc1
  s_waitcnt vmcnt(0)
  s_branch T_b01
G_r02:
  s_add_u32 s89, s42, 0x00000000
  s_mov_b32 s94, 0x00010000
  s_call_b64 s[48:49], G_retry
  s_branch G_b02
T_r02:
  s_sub_u32 s39, s39, 1
  s_cselect_b32 s56, 0, s56
  s_cselect_b32 s57, 0, s57
  s_add_u32 s3, s14, 0x00420000
  buffer_load_dwordx4 v[64:67], v20, s[8:11], s3 offen sc1
  s_waitcnt vmcnt(0)
  s_branch T_b02
G_r03:
  s_add_u32 s89, s40, 0x00100000
  s_mov_b32 s94, 0x00000000
  s_call_b64 s[48:49], G_retry
  s_branch G_b03
T_r03:
  s_sub_u32 s39, s39, 1
  s_cselect_b32 s56, 0, s56
  s_cselect_b32 s57, 0, s57
  s_add_u32 s3, s12, 0x00424000
  buffer_load_dwordx4 v[68:71], v20, s[8:11], s3 offen sc1
  s_waitcnt vmcnt(0)
  s_branch T_b03
G_r04:
  s_add_u32 s89, s41, 0x00100000
  s_mov_b32 s94, 0x00008000
  s_call_b64 s[48:49], G_retry
  s_branch G_b04
T_r04:
  s_sub_u32 s39, s39, 1
  s_cselect_b32 s56, 0, s56
  s_cselect_b32 s57, 0, s57
  s_add_u32 s3, s13, 0x00424000
  buffer_load_dwordx4 v[64:67], v20, s[8:11], s3 offen sc1
  s_waitcnt vmcnt(0)
  s_branch T_b04
G_r05:
  s_add_u32 s89, s42, 0x00100000
  s_mov_b32 s94, 0x00010000
  s_call_b64 s[48:49], G_retry
  s_branch G_b05
T_r05:
  s_sub_u32 s39, s39, 1
  s_cselect_b32 s56, 0, s56
  s_cselect_b32 s57, 0, s57
  s_add_u32 s3, s14, 0x00424000
  buffer_load_dwordx4 v[68:71], v20, s[8:11], s3 offen sc1
  s_waitcnt vmcnt(0)
  s_branch T_b05
H_r000:
  s_add_u32 s54, s46, 0x00434000
  s_call_b64 s[48:49], H_retry0
  s_branch H_b000
H_r001:
  s_add_u32 s54, s46, 0x00434000
  s_call_b64 s[48:49], H_retry1
  s_branch H_b001
H_r002:
  s_add_u32 s54, s46, 0x00434000
  s_call_b64 s[48:49], H_retry2
  s_branch H_b002
H_r003:
  s_add_u32 s54, s46, 0x00434000
  s_call_b64 s[48:49], H_retry3
  s_branch H_b003
H_r004:
  s_add_u32 s54, s46, 0x00434000
  s_call_b64 s[48:49], H_retry4
  s_branch H_b004
H_r005:
  s_add_u32 s54, s46, 0x00434000
  s_call_b64 s[48:49], H_retry5
  s_branch H_b005
H_r006:
  s_add_u32 s54, s46, 0x00434000
  s_call_b64 s[48:49], H_retry6
  s_branch H_b006
H_r010:
  s_add_u32 s54, s46, 0x006f4000
  s_call_b64 s[48:49], H_retry0
  s_branch H_b010
H_r011:
  s_add_u32 s54, s46, 0x006f4000
  s_call_b64 s[48:49], H_retry1
  s_branch H_b011
H_r012:
  s_add_u32 s54, s46, 0x006f4000
  s_call_b64 s[48:49], H_retry2
  s_branch H_b012
H_r013:
  s_add_u32 s54, s46, 0x006f4000
  s_call_b64 s[48:49], H_retry3
  s_branch H_b013
H_r014:
  s_add_u32 s54, s46, 0x006f4000
  s_call_b64 s[48:49], H_retry4
  s_branch H_b014
H_r015:
  s_add_u32 s54, s46, 0x006f4000
  s_call_b64 s[48:49], H_retry5
  s_branch H_b015
H_r016:
  s_add_u32 s54, s46, 0x006f4000
  s_call_b64 s[48:49], H_retry6
  s_branch H_b016
CB_r0:
  s_sub_u32 s39, s39, 1
  s_cselect_b32 s56, 0, s56
  s_cselect_b32 s57, 0, s57
  buffer_load_dword v176, v5, s[8:11], s28 offen sc1
  buffer_load_dword v177, v5, s[8:11], s29 offen sc1
  buffer_load_dword v178, v5, s[8:11], s30 offen sc1
  buffer_load_dword v179, v5, s[8:11], s31 offen sc1
  buffer_load_dword v180, v5, s[8:11], s32 offen sc1
  buffer_load_dword v181, v5, s[8:11], s33 offen sc1
  buffer_load_dword v182, v5, s[8:11], s34 offen sc1
  buffer_load_dword v183, v5, s[8:11], s35 offen sc1
  s_waitcnt vmcnt(0)
  s_branch CB_c0
C_retry0:
  s_sub_u32 s39, s39, 1
  s_cselect_b32 s56, 0, s56
  s_cselect_b32 s57, 0, s57
  s_mov_b64 exec, vcc
  s_add_u32 s96, s36, 0x00200000
  buffer_load_dwordx4 v[168:171], v3, s[8:11], s96 offen sc1
  s_mov_b32 s3, 0x00430000
  buffer_load_dwordx4 v[172:175], v4, s[8:11], s3 offen sc1
  s_waitcnt vmcnt(0)
  s_branch C_chk0
CB_r1:
  s_sub_u32 s39, s39, 1
  s_cselect_b32 s56, 0, s56
  s_cselect_b32 s57, 0, s57
  buffer_load_dword v176, v5, s[8:11], s28 offen sc1
  buffer_load_dword v177, v5, s[8:11], s29 offen sc1
  buffer_load_dword v178, v5, s[8:11], s30 offen sc1
  buffer_load_dword v179, v5, s[8:11], s31 offen sc1
  buffer_load_dword v180, v5, s[8:11], s32 offen sc1
  buffer_load_dword v181, v5, s[8:11], s33 offen sc1
  buffer_load_dword v182, v5, s[8:11], s34 offen sc1
  buffer_load_dword v183, v5, s[8:11], s35 offen sc1
  s_waitcnt vmcnt(0)
  s_branch CB_c1
C_retry1:
  s_sub_u32 s39, s39, 1
  s_cselect_b32 s56, 0, s56
  s_cselect_b32 s57, 0, s57
  s_mov_b64 exec, vcc
  s_add_u32 s96, s36, 0x00300000
  buffer_load_dwordx4 v[168:171], v3, s[8:11], s96 offen sc1
  s_mov_b32 s3, 0x00432000
  buffer_load_dwordx4 v[172:175], v4, s[8:11], s3 offen sc1
  s_waitcnt vmcnt(0)
  s_branch C_chk1
G_r10:
  s_add_u32 s89, s40, 0x00a00000
  s_mov_b32 s94, 0x00000000
  s_call_b64 s[48:49], G_retry
  s_branch G_b10
S_1:
  s_waitcnt lgkmcnt(0)
  s_barrier
  ds_read_b128 v[160:163], v11 offset:0
  ds_read_b128 v[164:167], v11 offset:16
  s_add_u32 s98, s12, 0x00428000
  s_waitcnt lgkmcnt(0)
  v_add_f32 v160, v160, v161
  v_add_f32 v162, v162, v163
  v_add_f32 v164, v164, v165
  v_add_f32 v166, v166, v167
  v_add_f32 v160, v160, v162
  v_add_f32 v164, v164, v166
  v_mul_f32 v160, 0xbb000000, v160
  v_mul_f32 v164, 0x3b000000, v164
  v_cvt_pk_bf16_f32 v156, v160, v160
  v_fma_f32 v164, -v160, v160, v164
  v_cvt_pk_bf16_f32 v164, 0, |v164|
  v_add_f32 v164, 0x3727c5ac, v164
  v_cvt_pk_bf16_f32 v164, 0, v164
  v_sqrt_f32 v164, v164
  v_mov_b32 v157, v156
  v_cvt_pk_bf16_f32 v164, 0, v164
  v_rcp_f32 v160, v164
  v_mul_f32 v66, v164, v164
  v_mul_f32 v161, v160, v160
  v_mul_f32 v64, 0xc0135761, v160
  v_mul_f32 v161, 0x3d372713, v161
  v_mul_f32 v65, v161, v64
  v_mov_b32 v67, v156
  s_mov_b64 exec, s[70:71]
  buffer_store_dwordx4 v[64:67], v9, s[8:11], s98 offen sc1
  s_mov_b64 exec, -1
  s_waitcnt vmcnt(2)
  ds_read_b64_tr_b16 v[84:85], v24 offset:32768
  ds_read_b64_tr_b16 v[86:87], v24 offset:33024
  ds_read_b64_tr_b16 v[88:89], v24 offset:33792
  ds_read_b64_tr_b16 v[90:91], v24 offset:34048
  ds_read_b64_tr_b16 v[92:93], v24 offset:34816
  ds_read_b64_tr_b16 v[94:95], v24 offset:35072
  ds_read_b64_tr_b16 v[96:97], v24 offset:35840
  ds_read_b64_tr_b16 v[98:99], v24 offset:36096
  ds_read_b64_tr_b16 v[100:101], v24 offset:36864
  ds_read_b64_tr_b16 v[102:103], v24 offset:37120
  ds_read_b64_tr_b16 v[104:105], v24 offset:37888
  ds_read_b64_tr_b16 v[106:107], v24 offset:38144
  ds_read_b64_tr_b16 v[108:109], v24 offset:38912
  ds_read_b64_tr_b16 v[110:111], v24 offset:39168
  ds_read_b64_tr_b16 v[112:113], v24 offset:39936
  ds_read_b64_tr_b16 v[114:115], v24 offset:40192
  s_waitcnt lgkmcnt(0)
  v_mfma_f32_4x4x4_16b_bf16 v[140:143], v[84:85], v[84:85], 0
  v_mfma_f32_4x4x4_16b_bf16 v[144:147], v[22:23], v[84:85], 0
  v_mfma_f32_4x4x4_16b_bf16 v[148:151], v[86:87], v[86:87], 0
  v_mfma_f32_4x4x4_16b_bf16 v[152:155], v[22:23], v[86:87], 0
  v_mfma_f32_4x4x4_16b_bf16 v[140:143], v[88:89], v[88:89], v[140:143]
  v_mfma_f32_4x4x4_16b_bf16 v[144:147], v[22:23], v[88:89], v[144:147]
  v_mfma_f32_4x4x4_16b_bf16 v[148:151], v[90:91], v[90:91], v[148:151]
  v_mfma_f32_4x4x4_16b_bf16 v[152:155], v[22:23], v[90:91], v[152:155]
  v_mfma_f32_4x4x4_16b_bf16 v[140:143], v[92:93], v[92:93], v[140:143]
  v_mfma_f32_4x4x4_16b_bf16 v[144:147], v[22:23], v[92:93], v[144:147]
  v_mfma_f32_4x4x4_16b_bf16 v[148:151], v[94:95], v[94:95], v[148:151]
  v_mfma_f32_4x4x4_16b_bf16 v[152:155], v[22:23], v[94:95], v[152:155]
  v_mfma_f32_4x4x4_16b_bf16 v[140:143], v[96:97], v[96:97], v[140:143]
  v_mfma_f32_4x4x4_16b_bf16 v[144:147], v[22:23], v[96:97], v[144:147]
  v_mfma_f32_4x4x4_16b_bf16 v[148:151], v[98:99], v[98:99], v[148:151]
  v_mfma_f32_4x4x4_16b_bf16 v[152:155], v[22:23], v[98:99], v[152:155]
  v_mfma_f32_4x4x4_16b_bf16 v[140:143], v[100:101], v[100:101], v[140:143]
  v_mfma_f32_4x4x4_16b_bf16 v[144:147], v[22:23], v[100:101], v[144:147]
  v_mfma_f32_4x4x4_16b_bf16 v[148:151], v[102:103], v[102:103], v[148:151]
  v_mfma_f32_4x4x4_16b_bf16 v[152:155], v[22:23], v[102:103], v[152:155]
  v_mfma_f32_4x4x4_16b_bf16 v[140:143], v[104:105], v[104:105], v[140:143]
  v_mfma_f32_4x4x4_16b_bf16 v[144:147], v[22:23], v[104:105], v[144:147]
  v_mfma_f32_4x4x4_16b_bf16 v[148:151], v[106:107], v[106:107], v[148:151]
  v_mfma_f32_4x4x4_16b_bf16 v[152:155], v[22:23], v[106:107], v[152:155]
  v_mfma_f32_4x4x4_16b_bf16 v[140:143], v[108:109], v[108:109], v[140:143]
  v_mfma_f32_4x4x4_16b_bf16 v[144:147], v[22:23], v[108:109], v[144:147]
  v_mfma_f32_4x4x4_16b_bf16 v[148:151], v[110:111], v[110:111], v[148:151]
  v_mfma_f32_4x4x4_16b_bf16 v[152:155], v[22:23], v[110:111], v[152:155]
  v_mfma_f32_4x4x4_16b_bf16 v[140:143], v[112:113], v[112:113], v[140:143]
  v_mfma_f32_4x4x4_16b_bf16 v[144:147], v[22:23], v[112:113], v[144:147]
  v_mfma_f32_4x4x4_16b_bf16 v[148:151], v[114:115], v[114:115], v[148:151]
  v_mfma_f32_4x4x4_16b_bf16 v[152:155], v[22:23], v[114:115], v[152:155]
  s_nop 4
  v_add_f32 v140, v140, v148
  v_add_f32 v141, v141, v149
  v_add_f32 v142, v142, v150
  v_add_f32 v143, v143, v151
  v_add_f32 v144, v144, v152
  v_cndmask_b32 v140, v140, v141, s[62:63]
  v_cndmask_b32 v142, v142, v143, s[62:63]
  v_cndmask_b32 v140, v140, v142, s[64:65]
  s_nop 1
  v_permlane32_swap_b32 v144, v140
  s_nop 0
  v_add_f32 v144, v144, v140
  v_cmp_u_f32 vcc, v144, v144
  s_and_b64 vcc, vcc, s[56:57]
  s_cbranch_scc1 G_rs11
G_bs11:
  ds_write_b32 v10, v144 offset:1024
  s_waitcnt lgkmcnt(0)
  s_barrier
  ds_read_b128 v[160:163], v11 offset:1024
  ds_read_b128 v[164:167], v11 offset:1040
  s_add_u32 s98, s13, 0x00428000
  s_waitcnt lgkmcnt(0)
  v_add_f32 v160, v160, v161
  v_add_f32 v162, v162, v163
  v_add_f32 v164, v164, v165
  v_add_f32 v166, v166, v167
  v_add_f32 v160, v160, v162
  v_add_f32 v164, v164, v166
  v_mul_f32 v160, 0xbb000000, v160
  v_mul_f32 v164, 0x3b000000, v164
  v_cvt_pk_bf16_f32 v156, v160, v160
  v_fma_f32 v164, -v160, v160, v164
  v_cvt_pk_bf16_f32 v164, 0, |v164|
  v_add_f32 v164, 0x3727c5ac, v164
  v_cvt_pk_bf16_f32 v164, 0, v164
  v_sqrt_f32 v164, v164
  v_mov_b32 v157, v156
  v_cvt_pk_bf16_f32 v164, 0, v164
  v_rcp_f32 v160, v164
  v_mul_f32 v66, v164, v164
  v_mul_f32 v161, v160, v160
  v_mul_f32 v64, 0xc0135761, v160
  v_mul_f32 v161, 0x3d372713, v161
  v_mul_f32 v65, v161, v64
  v_mov_b32 v67, v156
  s_mov_b64 exec, s[70:71]
  buffer_store_dwordx4 v[64:67], v9, s[8:11], s98 offen sc1
  s_mov_b64 exec, -1
  s_add_u32 m0, s60, 0x00010000
  s_add_u32 s89, s42, 0x00b00000
  buffer_load_dwordx4 v9, s[8:11], s89 offen offset:0 sc1 lds
  buffer_load_dwordx4 v9, s[8:11], s89 offen offset:1024 sc1 lds
  buffer_load_dwordx4 v9, s[8:11], s89 offen offset:2048 sc1 lds
  buffer_load_dwordx4 v9, s[8:11], s89 offen offset:3072 sc1 lds
  s_add_u32 m0, s60, 0x00011000
  s_add_u32 s89, s42, 0x00b01000
  buffer_load_dwordx4 v9, s[8:11], s89 offen offset:0 sc1 lds
  buffer_load_dwordx4 v9, s[8:11], s89 offen offset:1024 sc1 lds
  buffer_load_dwordx4 v9, s[8:11], s89 offen offset:2048 sc1 lds
  buffer_load_dwordx4 v9, s[8:11], s89 offen offset:3072 sc1 lds
  s_add_u32 m0, s60, 0x00000000
  s_add_u32 s89, s40, 0x00b00000
  buffer_load_dwordx4 v9, s[8:11], s89 offen offset:0 sc1 lds
  buffer_load_dwordx4 v9, s[8:11], s89 offen offset:1024 sc1 lds
  buffer_load_dwordx4 v9, s[8:11], s89 offen offset:2048 sc1 lds
  buffer_load_dwordx4 v9, s[8:11], s89 offen offset:3072 sc1 lds
  s_add_u32 m0, s60, 0x00001000
  s_add_u32 s89, s40, 0x00b01000
  buffer_load_dwordx4 v9, s[8:11], s89 offen offset:0 sc1 lds
  buffer_load_dwordx4 v9, s[8:11], s89 offen offset:1024 sc1 lds
  buffer_load_dwordx4 v9, s[8:11], s89 offen offset:2048 sc1 lds
  buffer_load_dwordx4 v9, s[8:11], s89 offen offset:3072 sc1 lds
  s_add_u32 s97, s44, 0x00ec0000
  buffer_store_dwordx4 v[200:203], v9, s[20:23], s97 offen sc1
  s_waitcnt vmcnt(9)
  ds_read_b64_tr_b16 v[84:85], v28 offset:0
  ds_read_b64_tr_b16 v[86:87], v28 offset:256
  ds_read_b64_tr_b16 v[88:89], v28 offset:1024
  ds_read_b64_tr_b16 v[90:91], v28 offset:1280
  ds_read_b64_tr_b16 v[92:93], v28 offset:2048
  ds_read_b64_tr_b16 v[94:95], v28 offset:2304
  ds_read_b64_tr_b16 v[96:97], v28 offset:3072
  ds_read_b64_tr_b16 v[98:99], v28 offset:3328
  ds_read_b64_tr_b16 v[100:101], v28 offset:4096
  ds_read_b64_tr_b16 v[102:103], v28 offset:4352
  ds_read_b64_tr_b16 v[104:105], v28 offset:5120
  ds_read_b64_tr_b16 v[106:107], v28 offset:5376
  ds_read_b64_tr_b16 v[108:109], v28 offset:6144
  ds_read_b64_tr_b16 v[110:111], v28 offset:6400
  ds_read_b64_tr_b16 v[112:113], v28 offset:7168
  ds_read_b64_tr_b16 v[114:115], v28 offset:7424
  s_waitcnt lgkmcnt(0)
  v_mfma_f32_4x4x4_16b_bf16 v[140:143], v[84:85], v[84:85], 0
  v_mfma_f32_4x4x4_16b_bf16 v[144:147], v[22:23], v[84:85], 0
  v_mfma_f32_4x4x4_16b_bf16 v[148:151], v[86:87], v[86:87], 0
  v_mfma_f32_4x4x4_16b_bf16 v[152:155], v[22:23], v[86:87], 0
  v_mfma_f32_4x4x4_16b_bf16 v[140:143], v[88:89], v[88:89], v[140:143]
  v_mfma_f32_4x4x4_16b_bf16 v[144:147], v[22:23], v[88:89], v[144:147]
  v_mfma_f32_4x4x4_16b_bf16 v[148:151], v[90:91], v[90:91], v[148:151]
  v_mfma_f32_4x4x4_16b_bf16 v[152:155], v[22:23], v[90:91], v[152:155]
  v_mfma_f32_4x4x4_16b_bf16 v[140:143], v[92:93], v[92:93], v[140:143]
  v_mfma_f32_4x4x4_16b_bf16 v[144:147], v[22:23], v[92:93], v[144:147]
  v_mfma_f32_4x4x4_16b_bf16 v[148:151], v[94:95], v[94:95], v[148:151]
  v_mfma_f32_4x4x4_16b_bf16 v[152:155], v[22:23], v[94:95], v[152:155]
  v_mfma_f32_4x4x4_16b_bf16 v[140:143], v[96:97], v[96:97], v[140:143]
  v_mfma_f32_4x4x4_16b_bf16 v[144:147], v[22:23], v[96:97], v[144:147]
  v_mfma_f32_4x4x4_16b_bf16 v[148:151], v[98:99], v[98:99], v[148:151]
  v_mfma_f32_4x4x4_16b_bf16 v[152:155], v[22:23], v[98:99], v[152:155]
  v_mfma_f32_4x4x4_16b_bf16 v[140:143], v[100:101], v[100:101], v[140:143]
  v_mfma_f32_4x4x4_16b_bf16 v[144:147], v[22:23], v[100:101], v[144:147]
  v_mfma_f32_4x4x4_16b_bf16 v[148:151], v[102:103], v[102:103], v[148:151]
  v_mfma_f32_4x4x4_16b_bf16 v[152:155], v[22:23], v[102:103], v[152:155]
  v_mfma_f32_4x4x4_16b_bf16 v[140:143], v[104:105], v[104:105], v[140:143]
  v_mfma_f32_4x4x4_16b_bf16 v[144:147], v[22:23], v[104:105], v[144:147]
  v_mfma_f32_4x4x4_16b_bf16 v[148:151], v[106:107], v[106:107], v[148:151]
  v_mfma_f32_4x4x4_16b_bf16 v[152:155], v[22:23], v[106:107], v[152:155]
  v_mfma_f32_4x4x4_16b_bf16 v[140:143], v[108:109], v[108:109], v[140:143]
  v_mfma_f32_4x4x4_16b_bf16 v[144:147], v[22:23], v[108:109], v[144:147]
  v_mfma_f32_4x4x4_16b_bf16 v[148:151], v[110:111], v[110:111], v[148:151]
  v_mfma_f32_4x4x4_16b_bf16 v[152:155], v[22:23], v[110:111], v[152:155]
  v_mfma_f32_4x4x4_16b_bf16 v[140:143], v[112:113], v[112:113], v[140:143]
  v_mfma_f32_4x4x4_16b_bf16 v[144:147], v[22:23], v[112:113], v[144:147]
  v_mfma_f32_4x4x4_16b_bf16 v[148:151], v[114:115], v[114:115], v[148:151]
  v_mfma_f32_4x4x4_16b_bf16 v[152:155], v[22:23], v[114:115], v[152:155]
  s_nop 4
  v_add_f32 v140, v140, v148
  v_add_f32 v141, v141, v149
  v_add_f32 v142, v142, v150
  v_add_f32 v143, v143, v151
  v_add_f32 v144, v144, v152
  v_cndmask_b32 v140, v140, v141, s[62:63]
  v_cndmask_b32 v142, v142, v143, s[62:63]
  v_cndmask_b32 v140, v140, v142, s[64:65]
  s_nop 1
  v_permlane32_swap_b32 v144, v140
  s_nop 0
  v_add_f32 v144, v144, v140
  v_cmp_u_f32 vcc, v144, v144
  s_and_b64 vcc, vcc, s[56:57]
  s_cbranch_scc1 G_rs12
G_bs12:
  ds_write_b32 v10, v144 offset:0
  s_waitcnt lgkmcnt(0)
  s_barrier
  ds_read_b128 v[160:163], v11 offset:0
  ds_read_b128 v[164:167], v11 offset:16
  s_add_u32 s98, s14, 0x0042c000
  s_waitcnt lgkmcnt(0)
  v_add_f32 v160, v160, v161
  v_add_f32 v162, v162, v163
  v_add_f32 v164, v164, v165
  v_add_f32 v166, v166, v167
  v_add_f32 v160, v160, v162
  v_add_f32 v164, v164, v166
  v_mul_f32 v160, 0xbb000000, v160
  v_mul_f32 v164, 0x3b000000, v164
  v_cvt_pk_bf16_f32 v156, v160, v160
  v_fma_f32 v164, -v160, v160, v164
  v_cvt_pk_bf16_f32 v164, 0, |v164|
  v_add_f32 v164, 0x3727c5ac, v164
  v_cvt_pk_bf16_f32 v164, 0, v164
  v_sqrt_f32 v164, v164
  v_mov_b32 v157, v156
  v_cvt_pk_bf16_f32 v164, 0, v164
  v_rcp_f32 v160, v164
  v_mul_f32 v66, v164, v164
  v_mul_f32 v161, v160, v160
  v_mul_f32 v64, 0xc0135761, v160
  v_mul_f32 v161, 0x3d372713, v161
  v_mul_f32 v65, v161, v64
  v_mov_b32 v67, v156
  s_mov_b64 exec, s[70:71]
  buffer_store_dwordx4 v[64:67], v9, s[8:11], s98 offen sc1
  s_mov_b64 exec, -1
  s_add_u32 m0, s60, 0x00008000
  s_add_u32 s89, s41, 0x00b00000
  buffer_load_dwordx4 v9, s[8:11], s89 offen offset:0 sc1 lds
  buffer_load_dwordx4 v9, s[8:11], s89 offen offset:1024 sc1 lds
  buffer_load_dwordx4 v9, s[8:11], s89 offen offset:2048 sc1 lds
  buffer_load_dwordx4 v9, s[8:11], s89 offen offset:3072 sc1 lds
  s_add_u32 m0, s60, 0x00009000
  s_add_u32 s89, s41, 0x00b01000
  buffer_load_dwordx4 v9, s[8:11], s89 offen offset:0 sc1 lds
  buffer_load_dwordx4 v9, s[8:11], s89 offen offset:1024 sc1 lds
  buffer_load_dwordx4 v9, s[8:11], s89 offen offset:2048 sc1 lds
  buffer_load_dwordx4 v9, s[8:11], s89 offen offset:3072 sc1 lds
  s_add_u32 s97, s45, 0x00ec0000
  buffer_store_dwordx4 v[200:203], v9, s[24:27], s97 offen sc1
  s_waitcnt vmcnt(11)
  ds_read_b64_tr_b16 v[84:85], v24 offset:0
  ds_read_b64_tr_b16 v[86:87], v24 offset:256
  ds_read_b64_tr_b16 v[88:89], v24 offset:1024
  ds_read_b64_tr_b16 v[90:91], v24 offset:1280
  ds_read_b64_tr_b16 v[92:93], v24 offset:2048
  ds_read_b64_tr_b16 v[94:95], v24 offset:2304
  ds_read_b64_tr_b16 v[96:97], v24 offset:3072
  ds_read_b64_tr_b16 v[98:99], v24 offset:3328
  ds_read_b64_tr_b16 v[100:101], v24 offset:4096
  ds_read_b64_tr_b16 v[102:103], v24 offset:4352
  ds_read_b64_tr_b16 v[104:105], v24 offset:5120
  ds_read_b64_tr_b16 v[106:107], v24 offset:5376
  ds_read_b64_tr_b16 v[108:109], v24 offset:6144
  ds_read_b64_tr_b16 v[110:111], v24 offset:6400
  ds_read_b64_tr_b16 v[112:113], v24 offset:7168
  ds_read_b64_tr_b16 v[114:115], v24 offset:7424
  s_waitcnt lgkmcnt(0)
  v_mfma_f32_4x4x4_16b_bf16 v[140:143], v[84:85], v[84:85], 0
  v_mfma_f32_4x4x4_16b_bf16 v[144:147], v[22:23], v[84:85], 0
  v_mfma_f32_4x4x4_16b_bf16 v[148:151], v[86:87], v[86:87], 0
  v_mfma_f32_4x4x4_16b_bf16 v[152:155], v[22:23], v[86:87], 0
  v_mfma_f32_4x4x4_16b_bf16 v[140:143], v[88:89], v[88:89], v[140:143]
  v_mfma_f32_4x4x4_16b_bf16 v[144:147], v[22:23], v[88:89], v[144:147]
  v_mfma_f32_4x4x4_16b_bf16 v[148:151], v[90:91], v[90:91], v[148:151]
  v_mfma_f32_4x4x4_16b_bf16 v[152:155], v[22:23], v[90:91], v[152:155]
  v_mfma_f32_4x4x4_16b_bf16 v[140:143], v[92:93], v[92:93], v[140:143]
  v_mfma_f32_4x4x4_16b_bf16 v[144:147], v[22:23], v[92:93], v[144:147]
  v_mfma_f32_4x4x4_16b_bf16 v[148:151], v[94:95], v[94:95], v[148:151]
  v_mfma_f32_4x4x4_16b_bf16 v[152:155], v[22:23], v[94:95], v[152:155]
  v_mfma_f32_4x4x4_16b_bf16 v[140:143], v[96:97], v[96:97], v[140:143]
  v_mfma_f32_4x4x4_16b_bf16 v[144:147], v[22:23], v[96:97], v[144:147]
  v_mfma_f32_4x4x4_16b_bf16 v[148:151], v[98:99], v[98:99], v[148:151]
  v_mfma_f32_4x4x4_16b_bf16 v[152:155], v[22:23], v[98:99], v[152:155]
  v_mfma_f32_4x4x4_16b_bf16 v[140:143], v[100:101], v[100:101], v[140:143]
  v_mfma_f32_4x4x4_16b_bf16 v[144:147], v[22:23], v[100:101], v[144:147]
  v_mfma_f32_4x4x4_16b_bf16 v[148:151], v[102:103], v[102:103], v[148:151]
  v_mfma_f32_4x4x4_16b_bf16 v[152:155], v[22:23], v[102:103], v[152:155]
  v_mfma_f32_4x4x4_16b_bf16 v[140:143], v[104:105], v[104:105], v[140:143]
  v_mfma_f32_4x4x4_16b_bf16 v[144:147], v[22:23], v[104:105], v[144:147]
  v_mfma_f32_4x4x4_16b_bf16 v[148:151], v[106:107], v[106:107], v[148:151]
  v_mfma_f32_4x4x4_16b_bf16 v[152:155], v[22:23], v[106:107], v[152:155]
  v_mfma_f32_4x4x4_16b_bf16 v[140:143], v[108:109], v[108:109], v[140:143]
  v_mfma_f32_4x4x4_16b_bf16 v[144:147], v[22:23], v[108:109], v[144:147]
  v_mfma_f32_4x4x4_16b_bf16 v[148:151], v[110:111], v[110:111], v[148:151]
  v_mfma_f32_4x4x4_16b_bf16 v[152:155], v[22:23], v[110:111], v[152:155]
  v_mfma_f32_4x4x4_16b_bf16 v[140:143], v[112:113], v[112:113], v[140:143]
  v_mfma_f32_4x4x4_16b_bf16 v[144:147], v[22:23], v[112:113], v[144:147]
  v_mfma_f32_4x4x4_16b_bf16 v[148:151], v[114:115], v[114:115], v[148:151]
  v_mfma_f32_4x4x4_16b_bf16 v[152:155], v[22:23], v[114:115], v[152:155]
  s_nop 4
  v_add_f32 v140, v140, v148
  v_add_f32 v141, v141, v149
  v_add_f32 v142, v142, v150
  v_add_f32 v143, v143, v151
  v_add_f32 v144, v144, v152
  v_cndmask_b32 v140, v140, v141, s[62:63]
  v_cndmask_b32 v142, v142, v143, s[62:63]
  v_cndmask_b32 v140, v140, v142, s[64:65]
  s_nop 1
  v_permlane32_swap_b32 v144, v140
  s_nop 0
  v_add_f32 v144, v144, v140
  v_cmp_u_f32 vcc, v144, v144
  s_and_b64 vcc, vcc, s[56:57]
  s_cbranch_scc1 G_rs13
G_bs13:
  ds_write_b32 v10, v144 offset:1024
  s_waitcnt lgkmcnt(0)
  s_barrier
  ds_read_b128 v[160:163], v11 offset:1024
  ds_read_b128 v[164:167], v11 offset:1040
  s_add_u32 s98, s12, 0x0042c000
  s_waitcnt lgkmcnt(0)
  v_add_f32 v160, v160, v161
  v_add_f32 v162, v162, v163
  v_add_f32 v164, v164, v165
  v_add_f32 v166, v166, v167
  v_add_f32 v160, v160, v162
  v_add_f32 v164, v164, v166
  v_mul_f32 v160, 0xbb000000, v160
  v_mul_f32 v164, 0x3b000000, v164
  v_cvt_pk_bf16_f32 v156, v160, v160
  v_fma_f32 v164, -v160, v160, v164
  v_cvt_pk_bf16_f32 v164, 0, |v164|
  v_add_f32 v164, 0x3727c5ac, v164
  v_cvt_pk_bf16_f32 v164, 0, v164
  v_sqrt_f32 v164, v164
  v_mov_b32 v157, v156
  v_cvt_pk_bf16_f32 v164, 0, v164
  v_rcp_f32 v160, v164
  v_mul_f32 v66, v164, v164
  v_mul_f32 v161, v160, v160
  v_mul_f32 v64, 0xc0135761, v160
  v_mul_f32 v161, 0x3d372713, v161
  v_mul_f32 v65, v161, v64
  v_mov_b32 v67, v156
  s_mov_b64 exec, s[70:71]
  buffer_store_dwordx4 v[64:67], v9, s[8:11], s98 offen sc1
  s_mov_b64 exec, -1
  s_waitcnt vmcnt(2)
  ds_read_b64_tr_b16 v[84:85], v24 offset:32768
  ds_read_b64_tr_b16 v[86:87], v24 offset:33024
  ds_read_b64_tr_b16 v[88:89], v24 offset:33792
  ds_read_b64_tr_b16 v[90:91], v24 offset:34048
  ds_read_b64_tr_b16 v[92:93], v24 offset:34816
  ds_read_b64_tr_b16 v[94:95], v24 offset:35072
  ds_read_b64_tr_b16 v[96:97], v24 offset:35840
  ds_read_b64_tr_b16 v[98:99], v24 offset:36096
  ds_read_b64_tr_b16 v[100:101], v24 offset:36864
  ds_read_b64_tr_b16 v[102:103], v24 offset:37120
  ds_read_b64_tr_b16 v[104:105], v24 offset:37888
  ds_read_b64_tr_b16 v[106:107], v24 offset:38144
  ds_read_b64_tr_b16 v[108:109], v24 offset:38912
  ds_read_b64_tr_b16 v[110:111], v24 offset:39168
  ds_read_b64_tr_b16 v[112:113], v24 offset:39936
  ds_read_b64_tr_b16 v[114:115], v24 offset:40192
  s_waitcnt lgkmcnt(0)
  v_mfma_f32_4x4x4_16b_bf16 v[140:143], v[84:85], v[84:85], 0
  v_mfma_f32_4x4x4_16b_bf16 v[144:147], v[22:23], v[84:85], 0
  v_mfma_f32_4x4x4_16b_bf16 v[148:151], v[86:87], v[86:87], 0
  v_mfma_f32_4x4x4_16b_bf16 v[152:155], v[22:23], v[86:87], 0
  v_mfma_f32_4x4x4_16b_bf16 v[140:143], v[88:89], v[88:89], v[140:143]
  v_mfma_f32_4x4x4_16b_bf16 v[144:147], v[22:23], v[88:89], v[144:147]
  v_mfma_f32_4x4x4_16b_bf16 v[148:151], v[90:91], v[90:91], v[148:151]
  v_mfma_f32_4x4x4_16b_bf16 v[152:155], v[22:23], v[90:91], v[152:155]
  v_mfma_f32_4x4x4_16b_bf16 v[140:143], v[92:93], v[92:93], v[140:143]
  v_mfma_f32_4x4x4_16b_bf16 v[144:147], v[22:23], v[92:93], v[144:147]
  v_mfma_f32_4x4x4_16b_bf16 v[148:151], v[94:95], v[94:95], v[148:151]
  v_mfma_f32_4x4x4_16b_bf16 v[152:155], v[22:23], v[94:95], v[152:155]
  v_mfma_f32_4x4x4_16b_bf16 v[140:143], v[96:97], v[96:97], v[140:143]
  v_mfma_f32_4x4x4_16b_bf16 v[144:147], v[22:23], v[96:97], v[144:147]
  v_mfma_f32_4x4x4_16b_bf16 v[148:151], v[98:99], v[98:99], v[148:151]
  v_mfma_f32_4x4x4_16b_bf16 v[152:155], v[22:23], v[98:99], v[152:155]
  v_mfma_f32_4x4x4_16b_bf16 v[140:143], v[100:101], v[100:101], v[140:143]
  v_mfma_f32_4x4x4_16b_bf16 v[144:147], v[22:23], v[100:101], v[144:147]
  v_mfma_f32_4x4x4_16b_bf16 v[148:151], v[102:103], v[102:103], v[148:151]
  v_mfma_f32_4x4x4_16b_bf16 v[152:155], v[22:23], v[102:103], v[152:155]
  v_mfma_f32_4x4x4_16b_bf16 v[140:143], v[104:105], v[104:105], v[140:143]
  v_mfma_f32_4x4x4_16b_bf16 v[144:147], v[22:23], v[104:105], v[144:147]
  v_mfma_f32_4x4x4_16b_bf16 v[148:151], v[106:107], v[106:107], v[148:151]
  v_mfma_f32_4x4x4_16b_bf16 v[152:155], v[22:23], v[106:107], v[152:155]
  v_mfma_f32_4x4x4_16b_bf16 v[140:143], v[108:109], v[108:109], v[140:143]
  v_mfma_f32_4x4x4_16b_bf16 v[144:147], v[22:23], v[108:109], v[144:147]
  v_mfma_f32_4x4x4_16b_bf16 v[148:151], v[110:111], v[110:111], v[148:151]
  v_mfma_f32_4x4x4_16b_bf16 v[152:155], v[22:23], v[110:111], v[152:155]
  v_mfma_f32_4x4x4_16b_bf16 v[140:143], v[112:113], v[112:113], v[140:143]
  v_mfma_f32_4x4x4_16b_bf16 v[144:147], v[22:23], v[112:113], v[144:147]
  v_mfma_f32_4x4x4_16b_bf16 v[148:151], v[114:115], v[114:115], v[148:151]
  v_mfma_f32_4x4x4_16b_bf16 v[152:155], v[22:23], v[114:115], v[152:155]
  s_nop 4
  v_add_f32 v140, v140, v148
  v_add_f32 v141, v141, v149
  v_add_f32 v142, v142, v150
  v_add_f32 v143, v143, v151
  v_add_f32 v144, v144, v152
  v_cndmask_b32 v140, v140, v141, s[62:63]
  v_cndmask_b32 v142, v142, v143, s[62:63]
  v_cndmask_b32 v140, v140, v142, s[64:65]
  s_nop 1
  v_permlane32_swap_b32 v144, v140
  s_nop 0
  v_add_f32 v144, v144, v140
  v_cmp_u_f32 vcc, v144, v144
  s_and_b64 vcc, vcc, s[56:57]
  s_cbranch_scc1 G_rs14
G_bs14:
  ds_write_b32 v10, v144 offset:0
  s_waitcnt lgkmcnt(0)
  s_barrier
  ds_read_b128 v[160:163], v11 offset:0
  ds_read_b128 v[164:167], v11 offset:16
  s_add_u32 s98, s13, 0x0042c000
  s_waitcnt lgkmcnt(0)
  v_add_f32 v160, v160, v161
  v_add_f32 v162, v162, v163
  v_add_f32 v164, v164, v165
  v_add_f32 v166, v166, v167
  v_add_f32 v160, v160, v162
  v_add_f32 v164, v164, v166
  v_mul_f32 v160, 0xbb000000, v160
  v_mul_f32 v164, 0x3b000000, v164
  v_cvt_pk_bf16_f32 v156, v160, v160
  v_fma_f32 v164, -v160, v160, v164
  v_cvt_pk_bf16_f32 v164, 0, |v164|
  v_add_f32 v164, 0x3727c5ac, v164
  v_cvt_pk_bf16_f32 v164, 0, v164
  v_sqrt_f32 v164, v164
  v_mov_b32 v157, v156
  v_cvt_pk_bf16_f32 v164, 0, v164
  v_rcp_f32 v160, v164
  v_mul_f32 v66, v164, v164
  v_mul_f32 v161, v160, v160
  v_mul_f32 v64, 0xc0135761, v160
  v_mul_f32 v161, 0x3d372713, v161
  v_mul_f32 v65, v161, v64
  v_mov_b32 v67, v156
  s_mov_b64 exec, s[70:71]
  buffer_store_dwordx4 v[64:67], v9, s[8:11], s98 offen sc1
  s_mov_b64 exec, -1
  s_add_u32 s96, s46, 0x00c00000
  buffer_load_dwordx4 v[168:171], v9, s[8:11], s96 offen offset:0 sc1
  buffer_load_dwordx4 v[172:175], v9, s[8:11], s96 offen offset:1024 sc1
  buffer_load_dwordx4 v[176:179], v9, s[8:11], s96 offen offset:2048 sc1
  buffer_load_dwordx4 v[180:183], v9, s[8:11], s96 offen offset:3072 sc1
  s_add_u32 s96, s46, 0x00c01000
  buffer_load_dwordx4 v[184:187], v9, s[8:11], s96 offen offset:0 sc1
  buffer_load_dwordx4 v[188:191], v9, s[8:11], s96 offen offset:1024 sc1
  buffer_load_dwordx4 v[192:195], v9, s[8:11], s96 offen offset:2048 sc1
  buffer_load_dwordx4 v[196:199], v9, s[8:11], s96 offen offset:3072 sc1
  s_add_u32 s96, s46, 0x00c02000
  buffer_load_dwordx4 v[200:203], v9, s[8:11], s96 offen offset:0 sc1
  buffer_load_dwordx4 v[140:143], v9, s[8:11], s96 offen offset:1024 sc1
  buffer_load_dwordx4 v[144:147], v9, s[8:11], s96 offen offset:2048 sc1
  buffer_load_dwordx4 v[148:151], v9, s[8:11], s96 offen offset:3072 sc1
  s_add_u32 s96, s46, 0x00c03000
  buffer_load_dwordx4 v[152:155], v9, s[8:11], s96 offen offset:0 sc1
  buffer_load_dwordx4 v[84:87], v9, s[8:11], s96 offen offset:1024 sc1
  s_waitcnt vmcnt(0) lgkmcnt(0)
  s_branch G2_1
G_r11:
  s_add_u32 s89, s41, 0x00a00000
  s_mov_b32 s94, 0x00008000
  s_call_b64 s[48:49], G_retry
  s_branch G_b11
T_r11:
  s_sub_u32 s39, s39, 1
  s_cselect_b32 s56, 0, s56
  s_cselect_b32 s57, 0, s57
  s_add_u32 s3, s13, 0x00428000
  buffer_load_dwordx4 v[68:71], v20, s[8:11], s3 offen sc1
  s_waitcnt vmcnt(0)
  s_branch T_b11
G_r12:
  s_add_u32 s89, s42, 0x00a00000
  s_mov_b32 s94, 0x00010000
  s_call_b64 s[48:49], G_retry
  s_branch G_b12
T_r12:
  s_sub_u32 s39, s39, 1
  s_cselect_b32 s56, 0, s56
  s_cselect_b32 s57, 0, s57
  s_add_u32 s3, s14, 0x00428000
  buffer_load_dwordx4 v[64:67], v20, s[8:11], s3 offen sc1
  s_waitcnt vmcnt(0)
  s_branch T_b12
G_r13:
  s_add_u32 s89, s40, 0x00b00000
  s_mov_b32 s94, 0x00000000
  s_call_b64 s[48:49], G_retry
  s_branch G_b13
T_r13:
  s_sub_u32 s39, s39, 1
  s_cselect_b32 s56, 0, s56
  s_cselect_b32 s57, 0, s57
  s_add_u32 s3, s12, 0x0042c000
  buffer_load_dwordx4 v[68:71], v20, s[8:11], s3 offen sc1
  s_waitcnt vmcnt(0)
  s_branch T_b13
G_r14:
  s_add_u32 s89, s41, 0x00b00000
  s_mov_b32 s94, 0x00008000
  s_call_b64 s[48:49], G_retry
  s_branch G_b14
T_r14:
  s_sub_u32 s39, s39, 1
  s_cselect_b32 s56, 0, s56
  s_cselect_b32 s57, 0, s57
  s_add_u32 s3, s13, 0x0042c000
  buffer_load_dwordx4 v[64:67], v20, s[8:11], s3 offen sc1
  s_waitcnt vmcnt(0)
  s_branch T_b14
G_r15:
  s_add_u32 s89, s42, 0x00b00000
  s_mov_b32 s94, 0x00010000
  s_call_b64 s[48:49], G_retry
  s_branch G_b15
T_r15:
  s_sub_u32 s39, s39, 1
  s_cselect_b32 s56, 0, s56
  s_cselect_b32 s57, 0, s57
  s_add_u32 s3, s14, 0x0042c000
  buffer_load_dwordx4 v[68:71], v20, s[8:11], s3 offen sc1
  s_waitcnt vmcnt(0)
  s_branch T_b15
H_r100:
  s_add_u32 s54, s46, 0x00c00000
  s_call_b64 s[48:49], H_retry0
  s_branch H_b100
H_r101:
  s_add_u32 s54, s46, 0x00c00000
  s_call_b64 s[48:49], H_retry1
  s_branch H_b101
H_r102:
  s_add_u32 s54, s46, 0x00c00000
  s_call_b64 s[48:49], H_retry2
  s_branch H_b102
H_r103:
  s_add_u32 s54, s46, 0x00c00000
  s_call_b64 s[48:49], H_retry3
  s_branch H_b103
H_r104:
  s_add_u32 s54, s46, 0x00c00000
  s_call_b64 s[48:49], H_retry4
  s_branch H_b104
H_r105:
  s_add_u32 s54, s46, 0x00c00000
  s_call_b64 s[48:49], H_retry5
  s_branch H_b105
H_r106:
  s_add_u32 s54, s46, 0x00c00000
  s_call_b64 s[48:49], H_retry6
  s_branch H_b106
H_r110:
  s_add_u32 s54, s46, 0x00ec0000
  s_call_b64 s[48:49], H_retry0
  s_branch H_b110
H_r111:
  s_add_u32 s54, s46, 0x00ec0000
  s_call_b64 s[48:49], H_retry1
  s_branch H_b111
H_r112:
  s_add_u32 s54, s46, 0x00ec0000
  s_call_b64 s[48:49], H_retry2
  s_branch H_b112
H_r113:
  s_add_u32 s54, s46, 0x00ec0000
  s_call_b64 s[48:49], H_retry3
  s_branch H_b113
H_r114:
  s_add_u32 s54, s46, 0x00ec0000
  s_call_b64 s[48:49], H_retry4
  s_branch H_b114
H_r115:
  s_add_u32 s54, s46, 0x00ec0000
  s_call_b64 s[48:49], H_retry5
  s_branch H_b115
H_r116:
  s_add_u32 s54, s46, 0x00ec0000
  s_call_b64 s[48:49], H_retry6
  s_branch H_b116
G_rs01:
  s_add_u32 s89, s41, 0x00000000
  s_mov_b32 s94, 0x00008000
  s_call_b64 s[48:49], G_retry
  s_branch G_bs01
G_rs02:
  s_add_u32 s89, s42, 0x00100000
  s_mov_b32 s94, 0x00010000
  s_call_b64 s[48:49], G_retry
  s_branch G_bs02
G_rs03:
  s_add_u32 s89, s40, 0x00100000
  s_mov_b32 s94, 0x00000000
  s_call_b64 s[48:49], G_retry
  s_branch G_bs03
G_rs04:
  s_add_u32 s89, s41, 0x00100000
  s_mov_b32 s94, 0x00008000
  s_call_b64 s[48:49], G_retry
  s_branch G_bs04
G_rs11:
  s_add_u32 s89, s41, 0x00a00000
  s_mov_b32 s94, 0x00008000
  s_call_b64 s[48:49], G_retry
  s_branch G_bs11
G_rs12:
  s_add_u32 s89, s42, 0x00b00000
  s_mov_b32 s94, 0x00010000
  s_call_b64 s[48:49], G_retry
  s_branch G_bs12
G_rs13:
  s_add_u32 s89, s40, 0x00b00000
  s_mov_b32 s94, 0x00000000
  s_call_b64 s[48:49], G_retry
  s_branch G_bs13
G_rs14:
  s_add_u32 s89, s41, 0x00b00000
  s_mov_b32 s94, 0x00008000
  s_call_b64 s[48:49], G_retry
  s_branch G_bs14
G_retry:
  s_sub_u32 s39, s39, 1
  s_cselect_b32 s56, 0, s56
  s_cselect_b32 s57, 0, s57
  s_add_u32 m0, s94, s60
  v_add_u32 v140, s94, v24
  s_add_u32 s3, s89, 4096
  buffer_load_dwordx4 v9, s[8:11], s89 offen offset:0 sc1 lds
  buffer_load_dwordx4 v9, s[8:11], s89 offen offset:1024 sc1 lds
  buffer_load_dwordx4 v9, s[8:11], s89 offen offset:2048 sc1 lds
  buffer_load_dwordx4 v9, s[8:11], s89 offen offset:3072 sc1 lds
  s_add_u32 m0, m0, 4096
  s_nop 0
  buffer_load_dwordx4 v9, s[8:11], s3 offen offset:0 sc1 lds
  buffer_load_dwordx4 v9, s[8:11], s3 offen offset:1024 sc1 lds
  buffer_load_dwordx4 v9, s[8:11], s3 offen offset:2048 sc1 lds
  buffer_load_dwordx4 v9, s[8:11], s3 offen offset:3072 sc1 lds
  s_waitcnt vmcnt(0)
  ds_read_b64_tr_b16 v[84:85], v140 offset:0
  ds_read_b64_tr_b16 v[86:87], v140 offset:256
  ds_read_b64_tr_b16 v[88:89], v140 offset:1024
  ds_read_b64_tr_b16 v[90:91], v140 offset:1280
  ds_read_b64_tr_b16 v[92:93], v140 offset:2048
  ds_read_b64_tr_b16 v[94:95], v140 offset:2304
  ds_read_b64_tr_b16 v[96:97], v140 offset:3072
  ds_read_b64_tr_b16 v[98:99], v140 offset:3328
  ds_read_b64_tr_b16 v[100:101], v140 offset:4096
  ds_read_b64_tr_b16 v[102:103], v140 offset:4352
  ds_read_b64_tr_b16 v[104:105], v140 offset:5120
  ds_read_b64_tr_b16 v[106:107], v140 offset:5376
  ds_read_b64_tr_b16 v[108:109], v140 offset:6144
  ds_read_b64_tr_b16 v[110:111], v140 offset:6400
  ds_read_b64_tr_b16 v[112:113], v140 offset:7168
  ds_read_b64_tr_b16 v[114:115], v140 offset:7424
  s_waitcnt lgkmcnt(0)
  v_mfma_f32_4x4x4_16b_bf16 v[140:143], v[84:85], v[84:85], 0
  v_mfma_f32_4x4x4_16b_bf16 v[144:147], v[22:23], v[84:85], 0
  v_mfma_f32_4x4x4_16b_bf16 v[148:151], v[86:87], v[86:87], 0
  v_mfma_f32_4x4x4_16b_bf16 v[152:155], v[22:23], v[86:87], 0
  v_mfma_f32_4x4x4_16b_bf16 v[140:143], v[88:89], v[88:89], v[140:143]
  v_mfma_f32_4x4x4_16b_bf16 v[144:147], v[22:23], v[88:89], v[144:147]
  v_mfma_f32_4x4x4_16b_bf16 v[148:151], v[90:91], v[90:91], v[148:151]
  v_mfma_f32_4x4x4_16b_bf16 v[152:155], v[22:23], v[90:91], v[152:155]
  v_mfma_f32_4x4x4_16b_bf16 v[140:143], v[92:93], v[92:93], v[140:143]
  v_mfma_f32_4x4x4_16b_bf16 v[144:147], v[22:23], v[92:93], v[144:147]
  v_mfma_f32_4x4x4_16b_bf16 v[148:151], v[94:95], v[94:95], v[148:151]
  v_mfma_f32_4x4x4_16b_bf16 v[152:155], v[22:23], v[94:95], v[152:155]
  v_mfma_f32_4x4x4_16b_bf16 v[140:143], v[96:97], v[96:97], v[140:143]
  v_mfma_f32_4x4x4_16b_bf16 v[144:147], v[22:23], v[96:97], v[144:147]
  v_mfma_f32_4x4x4_16b_bf16 v[148:151], v[98:99], v[98:99], v[148:151]
  v_mfma_f32_4x4x4_16b_bf16 v[152:155], v[22:23], v[98:99], v[152:155]
  v_mfma_f32_4x4x4_16b_bf16 v[140:143], v[100:101], v[100:101], v[140:143]
  v_mfma_f32_4x4x4_16b_bf16 v[144:147], v[22:23], v[100:101], v[144:147]
  v_mfma_f32_4x4x4_16b_bf16 v[148:151], v[102:103], v[102:103], v[148:151]
  v_mfma_f32_4x4x4_16b_bf16 v[152:155], v[22:23], v[102:103], v[152:155]
  v_mfma_f32_4x4x4_16b_bf16 v[140:143], v[104:105], v[104:105], v[140:143]
  v_mfma_f32_4x4x4_16b_bf16 v[144:147], v[22:23], v[104:105], v[144:147]
  v_mfma_f32_4x4x4_16b_bf16 v[148:151], v[106:107], v[106:107], v[148:151]
  v_mfma_f32_4x4x4_16b_bf16 v[152:155], v[22:23], v[106:107], v[152:155]
  v_mfma_f32_4x4x4_16b_bf16 v[140:143], v[108:109], v[108:109], v[140:143]
  v_mfma_f32_4x4x4_16b_bf16 v[144:147], v[22:23], v[108:109], v[144:147]
  v_mfma_f32_4x4x4_16b_bf16 v[148:151], v[110:111], v[110:111], v[148:151]
  v_mfma_f32_4x4x4_16b_bf16 v[152:155], v[22:23], v[110:111], v[152:155]
  v_mfma_f32_4x4x4_16b_bf16 v[140:143], v[112:113], v[112:113], v[140:143]
  v_mfma_f32_4x4x4_16b_bf16 v[144:147], v[22:23], v[112:113], v[144:147]
  v_mfma_f32_4x4x4_16b_bf16 v[148:151], v[114:115], v[114:115], v[148:151]
  v_mfma_f32_4x4x4_16b_bf16 v[152:155], v[22:23], v[114:115], v[152:155]
  s_nop 4
  v_add_f32 v140, v140, v148
  v_add_f32 v141, v141, v149
  v_add_f32 v142, v142, v150
  v_add_f32 v143, v143, v151
  v_add_f32 v144, v144, v152
  v_cndmask_b32 v140, v140, v141, s[62:63]
  v_cndmask_b32 v142, v142, v143, s[62:63]
  v_cndmask_b32 v140, v140, v142, s[64:65]
  s_nop 1
  v_permlane32_swap_b32 v144, v140
  s_nop 0
  v_add_f32 v144, v144, v140
  v_cmp_u_f32 vcc, v144, v144
  s_and_b64 vcc, vcc, s[56:57]
  s_cbranch_scc1 G_retry
  s_setpc_b64 s[48:49]
H_retry0:
  s_waitcnt vmcnt(0)
  s_sub_u32 s39, s39, 1
  s_cselect_b32 s56, 0, s56
  s_cselect_b32 s57, 0, s57
  s_add_u32 s3, s54, 0
  v_cmp_eq_u32 vcc, -1, v168
  s_mov_b64 exec, vcc
  buffer_load_dwordx4 v[168:171], v9, s[8:11], s3 offen offset:0 sc1
  s_mov_b64 exec, -1
  v_cmp_eq_u32 vcc, -1, v172
  s_mov_b64 exec, vcc
  buffer_load_dwordx4 v[172:175], v9, s[8:11], s3 offen offset:1024 sc1
  s_mov_b64 exec, -1
  v_cmp_eq_u32 vcc, -1, v176
  s_mov_b64 exec, vcc
  buffer_load_dwordx4 v[176:179], v9, s[8:11], s3 offen offset:2048 sc1
  s_mov_b64 exec, -1
  v_cmp_eq_u32 vcc, -1, v180
  s_mov_b64 exec, vcc
  buffer_load_dwordx4 v[180:183], v9, s[8:11], s3 offen offset:3072 sc1
  s_mov_b64 exec, -1
  s_add_u32 s3, s54, 4096
  v_cmp_eq_u32 vcc, -1, v184
  s_mov_b64 exec, vcc
  buffer_load_dwordx4 v[184:187], v9, s[8:11], s3 offen offset:0 sc1
  s_mov_b64 exec, -1
  v_cmp_eq_u32 vcc, -1, v188
  s_mov_b64 exec, vcc
  buffer_load_dwordx4 v[188:191], v9, s[8:11], s3 offen offset:1024 sc1
  s_mov_b64 exec, -1
  v_cmp_eq_u32 vcc, -1, v192
  s_mov_b64 exec, vcc
  buffer_load_dwordx4 v[192:195], v9, s[8:11], s3 offen offset:2048 sc1
  s_mov_b64 exec, -1
  v_cmp_eq_u32 vcc, -1, v196
  s_mov_b64 exec, vcc
  buffer_load_dwordx4 v[196:199], v9, s[8:11], s3 offen offset:3072 sc1
  s_mov_b64 exec, -1
  s_add_u32 s3, s54, 8192
  v_cmp_eq_u32 vcc, -1, v200
  s_mov_b64 exec, vcc
  buffer_load_dwordx4 v[200:203], v9, s[8:11], s3 offen offset:0 sc1
  s_mov_b64 exec, -1
  v_cmp_eq_u32 vcc, -1, v140
  s_mov_b64 exec, vcc
  buffer_load_dwordx4 v[140:143], v9, s[8:11], s3 offen offset:1024 sc1
  s_mov_b64 exec, -1
  v_cmp_eq_u32 vcc, -1, v144
  s_mov_b64 exec, vcc
  buffer_load_dwordx4 v[144:147], v9, s[8:11], s3 offen offset:2048 sc1
  s_mov_b64 exec, -1
  v_cmp_eq_u32 vcc, -1, v148
  s_mov_b64 exec, vcc
  buffer_load_dwordx4 v[148:151], v9, s[8:11], s3 offen offset:3072 sc1
  s_mov_b64 exec, -1
  s_add_u32 s3, s54, 12288
  v_cmp_eq_u32 vcc, -1, v152
  s_mov_b64 exec, vcc
  buffer_load_dwordx4 v[152:155], v9, s[8:11], s3 offen offset:0 sc1
  s_mov_b64 exec, -1
  v_cmp_eq_u32 vcc, -1, v84
  s_mov_b64 exec, vcc
  buffer_load_dwordx4 v[84:87], v9, s[8:11], s3 offen offset:1024 sc1
  s_mov_b64 exec, -1
  v_cmp_eq_u32 vcc, -1, v88
  s_mov_b64 exec, vcc
  buffer_load_dwordx4 v[88:91], v9, s[8:11], s3 offen offset:2048 sc1
  s_mov_b64 exec, -1
  v_cmp_eq_u32 vcc, -1, v92
  s_mov_b64 exec, vcc
  buffer_load_dwordx4 v[92:95], v9, s[8:11], s3 offen offset:3072 sc1
  s_mov_b64 exec, -1
  s_add_u32 s3, s54, 16384
  v_cmp_eq_u32 vcc, -1, v96
  s_mov_b64 exec, vcc
  buffer_load_dwordx4 v[96:99], v9, s[8:11], s3 offen offset:0 sc1
  s_mov_b64 exec, -1
  v_cmp_eq_u32 vcc, -1, v100
  s_mov_b64 exec, vcc
  buffer_load_dwordx4 v[100:103], v9, s[8:11], s3 offen offset:1024 sc1
  s_mov_b64 exec, -1
  v_cmp_eq_u32 vcc, -1, v104
  s_mov_b64 exec, vcc
  buffer_load_dwordx4 v[104:107], v9, s[8:11], s3 offen offset:2048 sc1
  s_mov_b64 exec, -1
  v_cmp_eq_u32 vcc, -1, v108
  s_mov_b64 exec, vcc
  buffer_load_dwordx4 v[108:111], v9, s[8:11], s3 offen offset:3072 sc1
  s_mov_b64 exec, -1
  s_add_u32 s3, s54, 20480
  v_cmp_eq_u32 vcc, -1, v112
  s_mov_b64 exec, vcc
  buffer_load_dwordx4 v[112:115], v9, s[8:11], s3 offen offset:0 sc1
  s_mov_b64 exec, -1
  v_cmp_eq_u32 vcc, -1, v160
  s_mov_b64 exec, vcc
  buffer_load_dwordx4 v[160:163], v9, s[8:11], s3 offen offset:1024 sc1
  s_mov_b64 exec, -1
  s_waitcnt vmcnt(0)
  v_max3_u32 v136, v168, v172, v176
  v_cmp_eq_u32 vcc, -1, v136
  s_and_b64 vcc, vcc, s[56:57]
  s_cbranch_scc1 H_retry0
  s_setpc_b64 s[48:49]
H_retry1:
  s_waitcnt vmcnt(0)
  s_sub_u32 s39, s39, 1
  s_cselect_b32 s56, 0, s56
  s_cselect_b32 s57, 0, s57
  s_add_u32 s3, s54, 0
  v_cmp_eq_u32 vcc, -1, v180
  s_mov_b64 exec, vcc
  buffer_load_dwordx4 v[180:183], v9, s[8:11], s3 offen offset:3072 sc1
  s_mov_b64 exec, -1
  s_add_u32 s3, s54, 4096
  v_cmp_eq_u32 vcc, -1, v184
  s_mov_b64 exec, vcc
  buffer_load_dwordx4 v[184:187], v9, s[8:11], s3 offen offset:0 sc1
  s_mov_b64 exec, -1
  v_cmp_eq_u32 vcc, -1, v188
  s_mov_b64 exec, vcc
  buffer_load_dwordx4 v[188:191], v9, s[8:11], s3 offen offset:1024 sc1
  s_mov_b64 exec, -1
  v_cmp_eq_u32 vcc, -1, v192
  s_mov_b64 exec, vcc
  buffer_load_dwordx4 v[192:195], v9, s[8:11], s3 offen offset:2048 sc1
  s_mov_b64 exec, -1
  v_cmp_eq_u32 vcc, -1, v196
  s_mov_b64 exec, vcc
  buffer_load_dwordx4 v[196:199], v9, s[8:11], s3 offen offset:3072 sc1
  s_mov_b64 exec, -1
  s_add_u32 s3, s54, 8192
  v_cmp_eq_u32 vcc, -1, v200
  s_mov_b64 exec, vcc
  buffer_load_dwordx4 v[200:203], v9, s[8:11], s3 offen offset:0 sc1
  s_mov_b64 exec, -1
  v_cmp_eq_u32 vcc, -1, v140
  s_mov_b64 exec, vcc
  buffer_load_dwordx4 v[140:143], v9, s[8:11], s3 offen offset:1024 sc1
  s_mov_b64 exec, -1
  v_cmp_eq_u32 vcc, -1, v144
  s_mov_b64 exec, vcc
  buffer_load_dwordx4 v[144:147], v9, s[8:11], s3 offen offset:2048 sc1
  s_mov_b64 exec, -1
  v_cmp_eq_u32 vcc, -1, v148
  s_mov_b64 exec, vcc
  buffer_load_dwordx4 v[148:151], v9, s[8:11], s3 offen offset:3072 sc1
  s_mov_b64 exec, -1
  s_add_u32 s3, s54, 12288
  v_cmp_eq_u32 vcc, -1, v152
  s_mov_b64 exec, vcc
  buffer_load_dwordx4 v[152:155], v9, s[8:11], s3 offen offset:0 sc1
  s_mov_b64 exec, -1
  v_cmp_eq_u32 vcc, -1, v84
  s_mov_b64 exec, vcc
  buffer_load_dwordx4 v[84:87], v9, s[8:11], s3 offen offset:1024 sc1
  s_mov_b64 exec, -1
  v_cmp_eq_u32 vcc, -1, v88
  s_mov_b64 exec, vcc
  buffer_load_dwordx4 v[88:91], v9, s[8:11], s3 offen offset:2048 sc1
  s_mov_b64 exec, -1
  v_cmp_eq_u32 vcc, -1, v92
  s_mov_b64 exec, vcc
  buffer_load_dwordx4 v[92:95], v9, s[8:11], s3 offen offset:3072 sc1
  s_mov_b64 exec, -1
  s_add_u32 s3, s54, 16384
  v_cmp_eq_u32 vcc, -1, v96
  s_mov_b64 exec, vcc
  buffer_load_dwordx4 v[96:99], v9, s[8:11], s3 offen offset:0 sc1
  s_mov_b64 exec, -1
  v_cmp_eq_u32 vcc, -1, v100
  s_mov_b64 exec, vcc
  buffer_load_dwordx4 v[100:103], v9, s[8:11], s3 offen offset:1024 sc1
  s_mov_b64 exec, -1
  v_cmp_eq_u32 vcc, -1, v104
  s_mov_b64 exec, vcc
  buffer_load_dwordx4 v[104:107], v9, s[8:11], s3 offen offset:2048 sc1
  s_mov_b64 exec, -1
  v_cmp_eq_u32 vcc, -1, v108
  s_mov_b64 exec, vcc
  buffer_load_dwordx4 v[108:111], v9, s[8:11], s3 offen offset:3072 sc1
  s_mov_b64 exec, -1
  s_add_u32 s3, s54, 20480
  v_cmp_eq_u32 vcc, -1, v112
  s_mov_b64 exec, vcc
  buffer_load_dwordx4 v[112:115], v9, s[8:11], s3 offen offset:0 sc1
  s_mov_b64 exec, -1
  v_cmp_eq_u32 vcc, -1, v160
  s_mov_b64 exec, vcc
  buffer_load_dwordx4 v[160:163], v9, s[8:11], s3 offen offset:1024 sc1
  s_mov_b64 exec, -1
  s_waitcnt vmcnt(0)
  v_max3_u32 v136, v180, v184, v188
  v_cmp_eq_u32 vcc, -1, v136
  s_and_b64 vcc, vcc, s[56:57]
  s_cbranch_scc1 H_retry1
  s_setpc_b64 s[48:49]
H_retry2:
  s_waitcnt vmcnt(0)
  s_sub_u32 s39, s39, 1
  s_cselect_b32 s56, 0, s56
  s_cselect_b32 s57, 0, s57
  s_add_u32 s3, s54, 4096
  v_cmp_eq_u32 vcc, -1, v192
  s_mov_b64 exec, vcc
  buffer_load_dwordx4 v[192:195], v9, s[8:11], s3 offen offset:2048 sc1
  s_mov_b64 exec, -1
  v_cmp_eq_u32 vcc, -1, v196
  s_mov_b64 exec, vcc
  buffer_load_dwordx4 v[196:199], v9, s[8:11], s3 offen offset:3072 sc1
  s_mov_b64 exec, -1
  s_add_u32 s3, s54, 8192
  v_cmp_eq_u32 vcc, -1, v200
  s_mov_b64 exec, vcc
  buffer_load_dwordx4 v[200:203], v9, s[8:11], s3 offen offset:0 sc1
  s_mov_b64 exec, -1
  v_cmp_eq_u32 vcc, -1, v140
  s_mov_b64 exec, vcc
  buffer_load_dwordx4 v[140:143], v9, s[8:11], s3 offen offset:1024 sc1
  s_mov_b64 exec, -1
  v_cmp_eq_u32 vcc, -1, v144
  s_mov_b64 exec, vcc
  buffer_load_dwordx4 v[144:147], v9, s[8:11], s3 offen offset:2048 sc1
  s_mov_b64 exec, -1
  v_cmp_eq_u32 vcc, -1, v148
  s_mov_b64 exec, vcc
  buffer_load_dwordx4 v[148:151], v9, s[8:11], s3 offen offset:3072 sc1
  s_mov_b64 exec, -1
  s_add_u32 s3, s54, 12288
  v_cmp_eq_u32 vcc, -1, v152
  s_mov_b64 exec, vcc
  buffer_load_dwordx4 v[152:155], v9, s[8:11], s3 offen offset:0 sc1
  s_mov_b64 exec, -1
  v_cmp_eq_u32 vcc, -1, v84
  s_mov_b64 exec, vcc
  buffer_load_dwordx4 v[84:87], v9, s[8:11], s3 offen offset:1024 sc1
  s_mov_b64 exec, -1
  v_cmp_eq_u32 vcc, -1, v88
  s_mov_b64 exec, vcc
  buffer_load_dwordx4 v[88:91], v9, s[8:11], s3 offen offset:2048 sc1
  s_mov_b64 exec, -1
  v_cmp_eq_u32 vcc, -1, v92
  s_mov_b64 exec, vcc
  buffer_load_dwordx4 v[92:95], v9, s[8:11], s3 offen offset:3072 sc1
  s_mov_b64 exec, -1
  s_add_u32 s3, s54, 16384
  v_cmp_eq_u32 vcc, -1, v96
  s_mov_b64 exec, vcc
  buffer_load_dwordx4 v[96:99], v9, s[8:11], s3 offen offset:0 sc1
  s_mov_b64 exec, -1
  v_cmp_eq_u32 vcc, -1, v100
  s_mov_b64 exec, vcc
  buffer_load_dwordx4 v[100:103], v9, s[8:11], s3 offen offset:1024 sc1
  s_mov_b64 exec, -1
  v_cmp_eq_u32 vcc, -1, v104
  s_mov_b64 exec, vcc
  buffer_load_dwordx4 v[104:107], v9, s[8:11], s3 offen offset:2048 sc1
  s_mov_b64 exec, -1
  v_cmp_eq_u32 vcc, -1, v108
  s_mov_b64 exec, vcc
  buffer_load_dwordx4 v[108:111], v9, s[8:11], s3 offen offset:3072 sc1
  s_mov_b64 exec, -1
  s_add_u32 s3, s54, 20480
  v_cmp_eq_u32 vcc, -1, v112
  s_mov_b64 exec, vcc
  buffer_load_dwordx4 v[112:115], v9, s[8:11], s3 offen offset:0 sc1
  s_mov_b64 exec, -1
  v_cmp_eq_u32 vcc, -1, v160
  s_mov_b64 exec, vcc
  buffer_load_dwordx4 v[160:163], v9, s[8:11], s3 offen offset:1024 sc1
  s_mov_b64 exec, -1
  s_waitcnt vmcnt(0)
  v_max3_u32 v136, v192, v196, v200
  v_cmp_eq_u32 vcc, -1, v136
  s_and_b64 vcc, vcc, s[56:57]
  s_cbranch_scc1 H_retry2
  s_setpc_b64 s[48:49]
H_retry3:
  s_waitcnt vmcnt(0)
  s_sub_u32 s39, s39, 1
  s_cselect_b32 s56, 0, s56
  s_cselect_b32 s57, 0, s57
  s_add_u32 s3, s54, 8192
  v_cmp_eq_u32 vcc, -1, v140
  s_mov_b64 exec, vcc
  buffer_load_dwordx4 v[140:143], v9, s[8:11], s3 offen offset:1024 sc1
  s_mov_b64 exec, -1
  v_cmp_eq_u32 vcc, -1, v144
  s_mov_b64 exec, vcc
  buffer_load_dwordx4 v[144:147], v9, s[8:11], s3 offen offset:2048 sc1
  s_mov_b64 exec, -1
  v_cmp_eq_u32 vcc, -1, v148
  s_mov_b64 exec, vcc
  buffer_load_dwordx4 v[148:151], v9, s[8:11], s3 offen offset:3072 sc1
  s_mov_b64 exec, -1
  s_add_u32 s3, s54, 12288
  v_cmp_eq_u32 vcc, -1, v152
  s_mov_b64 exec, vcc
  buffer_load_dwordx4 v[152:155], v9, s[8:11], s3 offen offset:0 sc1
  s_mov_b64 exec, -1
  v_cmp_eq_u32 vcc, -1, v84
  s_mov_b64 exec, vcc
  buffer_load_dwordx4 v[84:87], v9, s[8:11], s3 offen offset:1024 sc1
  s_mov_b64 exec, -1
  v_cmp_eq_u32 vcc, -1, v88
  s_mov_b64 exec, vcc
  buffer_load_dwordx4 v[88:91], v9, s[8:11], s3 offen offset:2048 sc1
  s_mov_b64 exec, -1
  v_cmp_eq_u32 vcc, -1, v92
  s_mov_b64 exec, vcc
  buffer_load_dwordx4 v[92:95], v9, s[8:11], s3 offen offset:3072 sc1
  s_mov_b64 exec, -1
  s_add_u32 s3, s54, 16384
  v_cmp_eq_u32 vcc, -1, v96
  s_mov_b64 exec, vcc
  buffer_load_dwordx4 v[96:99], v9, s[8:11], s3 offen offset:0 sc1
  s_mov_b64 exec, -1
  v_cmp_eq_u32 vcc, -1, v100
  s_mov_b64 exec, vcc
  buffer_load_dwordx4 v[100:103], v9, s[8:11], s3 offen offset:1024 sc1
  s_mov_b64 exec, -1
  v_cmp_eq_u32 vcc, -1, v104
  s_mov_b64 exec, vcc
  buffer_load_dwordx4 v[104:107], v9, s[8:11], s3 offen offset:2048 sc1
  s_mov_b64 exec, -1
  v_cmp_eq_u32 vcc, -1, v108
  s_mov_b64 exec, vcc
  buffer_load_dwordx4 v[108:111], v9, s[8:11], s3 offen offset:3072 sc1
  s_mov_b64 exec, -1
  s_add_u32 s3, s54, 20480
  v_cmp_eq_u32 vcc, -1, v112
  s_mov_b64 exec, vcc
  buffer_load_dwordx4 v[112:115], v9, s[8:11], s3 offen offset:0 sc1
  s_mov_b64 exec, -1
  v_cmp_eq_u32 vcc, -1, v160
  s_mov_b64 exec, vcc
  buffer_load_dwordx4 v[160:163], v9, s[8:11], s3 offen offset:1024 sc1
  s_mov_b64 exec, -1
  s_waitcnt vmcnt(0)
  v_max3_u32 v136, v140, v144, v148
  v_cmp_eq_u32 vcc, -1, v136
  s_and_b64 vcc, vcc, s[56:57]
  s_cbranch_scc1 H_retry3
  s_setpc_b64 s[48:49]
H_retry4:
  s_waitcnt vmcnt(0)
  s_sub_u32 s39, s39, 1
  s_cselect_b32 s56, 0, s56
  s_cselect_b32 s57, 0, s57
  s_add_u32 s3, s54, 12288
  v_cmp_eq_u32 vcc, -1, v152
  s_mov_b64 exec, vcc
  buffer_load_dwordx4 v[152:155], v9, s[8:11], s3 offen offset:0 sc1
  s_mov_b64 exec, -1
  v_cmp_eq_u32 vcc, -1, v84
  s_mov_b64 exec, vcc
  buffer_load_dwordx4 v[84:87], v9, s[8:11], s3 offen offset:1024 sc1
  s_mov_b64 exec, -1
  v_cmp_eq_u32 vcc, -1, v88
  s_mov_b64 exec, vcc
  buffer_load_dwordx4 v[88:91], v9, s[8:11], s3 offen offset:2048 sc1
  s_mov_b64 exec, -1
  v_cmp_eq_u32 vcc, -1, v92
  s_mov_b64 exec, vcc
  buffer_load_dwordx4 v[92:95], v9, s[8:11], s3 offen offset:3072 sc1
  s_mov_b64 exec, -1
  s_add_u32 s3, s54, 16384
  v_cmp_eq_u32 vcc, -1, v96
  s_mov_b64 exec, vcc
  buffer_load_dwordx4 v[96:99], v9, s[8:11], s3 offen offset:0 sc1
  s_mov_b64 exec, -1
  v_cmp_eq_u32 vcc, -1, v100
  s_mov_b64 exec, vcc
  buffer_load_dwordx4 v[100:103], v9, s[8:11], s3 offen offset:1024 sc1
  s_mov_b64 exec, -1
  v_cmp_eq_u32 vcc, -1, v104
  s_mov_b64 exec, vcc
  buffer_load_dwordx4 v[104:107], v9, s[8:11], s3 offen offset:2048 sc1
  s_mov_b64 exec, -1
  v_cmp_eq_u32 vcc, -1, v108
  s_mov_b64 exec, vcc
  buffer_load_dwordx4 v[108:111], v9, s[8:11], s3 offen offset:3072 sc1
  s_mov_b64 exec, -1
  s_add_u32 s3, s54, 20480
  v_cmp_eq_u32 vcc, -1, v112
  s_mov_b64 exec, vcc
  buffer_load_dwordx4 v[112:115], v9, s[8:11], s3 offen offset:0 sc1
  s_mov_b64 exec, -1
  v_cmp_eq_u32 vcc, -1, v160
  s_mov_b64 exec, vcc
  buffer_load_dwordx4 v[160:163], v9, s[8:11], s3 offen offset:1024 sc1
  s_mov_b64 exec, -1
  s_waitcnt vmcnt(0)
  v_max3_u32 v136, v152, v84, v88
  v_cmp_eq_u32 vcc, -1, v136
  s_and_b64 vcc, vcc, s[56:57]
  s_cbranch_scc1 H_retry4
  s_setpc_b64 s[48:49]
H_retry5:
  s_waitcnt vmcnt(0)
  s_sub_u32 s39, s39, 1
  s_cselect_b32 s56, 0, s56
  s_cselect_b32 s57, 0, s57
  s_add_u32 s3, s54, 12288
  v_cmp_eq_u32 vcc, -1, v92
  s_mov_b64 exec, vcc
  buffer_load_dwordx4 v[92:95], v9, s[8:11], s3 offen offset:3072 sc1
  s_mov_b64 exec, -1
  s_add_u32 s3, s54, 16384
  v_cmp_eq_u32 vcc, -1, v96
  s_mov_b64 exec, vcc
  buffer_load_dwordx4 v[96:99], v9, s[8:11], s3 offen offset:0 sc1
  s_mov_b64 exec, -1
  v_cmp_eq_u32 vcc, -1, v100
  s_mov_b64 exec, vcc
  buffer_load_dwordx4 v[100:103], v9, s[8:11], s3 offen offset:1024 sc1
  s_mov_b64 exec, -1
  v_cmp_eq_u32 vcc, -1, v104
  s_mov_b64 exec, vcc
  buffer_load_dwordx4 v[104:107], v9, s[8:11], s3 offen offset:2048 sc1
  s_mov_b64 exec, -1
  v_cmp_eq_u32 vcc, -1, v108
  s_mov_b64 exec, vcc
  buffer_load_dwordx4 v[108:111], v9, s[8:11], s3 offen offset:3072 sc1
  s_mov_b64 exec, -1
  s_add_u32 s3, s54, 20480
  v_cmp_eq_u32 vcc, -1, v112
  s_mov_b64 exec, vcc
  buffer_load_dwordx4 v[112:115], v9, s[8:11], s3 offen offset:0 sc1
  s_mov_b64 exec, -1
  v_cmp_eq_u32 vcc, -1, v160
  s_mov_b64 exec, vcc
  buffer_load_dwordx4 v[160:163], v9, s[8:11], s3 offen offset:1024 sc1
  s_mov_b64 exec, -1
  s_waitcnt vmcnt(0)
  v_max3_u32 v136, v92, v96, v100
  v_cmp_eq_u32 vcc, -1, v136
  s_and_b64 vcc, vcc, s[56:57]
  s_cbranch_scc1 H_retry5
  s_setpc_b64 s[48:49]
H_retry6:
  s_waitcnt vmcnt(0)
  s_sub_u32 s39, s39, 1
  s_cselect_b32 s56, 0, s56
  s_cselect_b32 s57, 0, s57
  s_add_u32 s3, s54, 16384
  v_cmp_eq_u32 vcc, -1, v104
  s_mov_b64 exec, vcc
  buffer_load_dwordx4 v[104:107], v9, s[8:11], s3 offen offset:2048 sc1
  s_mov_b64 exec, -1
  v_cmp_eq_u32 vcc, -1, v108
  s_mov_b64 exec, vcc
  buffer_load_dwordx4 v[108:111], v9, s[8:11], s3 offen offset:3072 sc1
  s_mov_b64 exec, -1
  s_add_u32 s3, s54, 20480
  v_cmp_eq_u32 vcc, -1, v112
  s_mov_b64 exec, vcc
  buffer_load_dwordx4 v[112:115], v9, s[8:11], s3 offen offset:0 sc1
  s_mov_b64 exec, -1
  v_cmp_eq_u32 vcc, -1, v160
  s_mov_b64 exec, vcc
  buffer_load_dwordx4 v[160:163], v9, s[8:11], s3 offen offset:1024 sc1
  s_mov_b64 exec, -1
  s_waitcnt vmcnt(0)
  v_max3_u32 v136, v104, v108, v112
  v_max_u32 v136, v136, v160
  v_cmp_eq_u32 vcc, -1, v136
  s_and_b64 vcc, vcc, s[56:57]
  s_cbranch_scc1 H_retry6
  s_setpc_b64 s[48:49]
B_end:
  s_endpgm
.section .rodata,"a"
.p2align 6
.amdhsa_kernel interleave_layers__ssm_conv_s4__geglu_ffn__prompt_kernel
  .amdhsa_next_free_vgpr 512
  .amdhsa_next_free_sgpr 102
  .amdhsa_accum_offset 256
  .amdhsa_group_segment_fixed_size 0
  .amdhsa_kernarg_size 128
  .amdhsa_user_sgpr_count 2
  .amdhsa_user_sgpr_kernarg_segment_ptr 1
  .amdhsa_system_sgpr_workgroup_id_x 1
.end_amdhsa_kernel
```
